```python
import torch

def _softmax(x, axis=-1):
    return torch.softmax(x, dim=axis)

def _gelu(x):
    return torch.nn.functional.gelu(x, approximate='tanh')

def _silu(x):
    return torch.nn.functional.silu(x)

def _sigmoid(x):
    return torch.sigmoid(x)

def _layernorm(x, axis=-1, eps=1e-05):
    m = x.mean(dim=axis, keepdim=True)
    v = x.var(dim=axis, keepdim=True, unbiased=False)
    return (x - m) / torch.sqrt(v + eps)

def _scatter_add(tgt, idx, src, axis=0):
    return tgt.clone().index_add_(axis, idx, src)

def _segment_sum(src, seg, n):
    out = torch.zeros((n,) + src.shape[1:], dtype=src.dtype)
    return out.index_add_(0, seg, src)

def _pad(x, pw):
    flat = tuple((v for pair in reversed(pw) for v in pair))
    return torch.nn.functional.pad(x, flat)
kernel_name = 'adaLN_cond__sliding_block__swiglu_ffn__prompt'

def setup_inputs():

    _w = lambda a: (lambda t: t.to(torch.bfloat16) if t.is_floating_point() else t)(torch.as_tensor(a))

    def _A_setup():
        B, S, D = (1, 2048, 640)
        return {'x': _w((lambda *s: torch.randn(*s, dtype=torch.bfloat16) * 0.05)(B, S, D)), 'wqkv': _w((lambda *s: torch.randn(*s, dtype=torch.bfloat16) * 0.05)(D, 3 * D)), 'wo': _w((lambda *s: torch.randn(*s, dtype=torch.bfloat16) * 0.05)(D, D))}
    _A_in = _A_setup()

    def _B_setup():
        B, S, D, F = (1, 2048, 640, 1536)
        return {'x': _w((lambda *s: torch.randn(*s, dtype=torch.bfloat16) * 0.05)(B, S, D)), 'w_gate': _w((lambda *s: torch.randn(*s, dtype=torch.bfloat16) * 0.05)(D, F)), 'w_up': _w((lambda *s: torch.randn(*s, dtype=torch.bfloat16) * 0.05)(D, F)), 'w_down': _w((lambda *s: torch.randn(*s, dtype=torch.bfloat16) * 0.05)(F, D))}
    _B_in = _B_setup()
    return {'A_x': _A_in['x'], 'A_wqkv': _A_in['wqkv'], 'A_wo': _A_in['wo'], 'B_x': _B_in['x'], 'B_w_gate': _B_in['w_gate'], 'B_w_up': _B_in['w_up'], 'B_w_down': _B_in['w_down'], 'c': _w((lambda *s: torch.randn(*s, dtype=torch.bfloat16) * 0.1)(1, 640) * 8.0), 'w_mod': _w((lambda *s: torch.randn(*s, dtype=torch.bfloat16) * 0.1)(640, 6 * 640) * 640 ** (-0.5) * 8.0)}

def reference(A_x, A_wqkv, A_wo, B_x, B_w_gate, B_w_up, B_w_down, c, w_mod):

    def _A_ref(x, wqkv, wo):
        B, S, D = x.shape
        H = 32
        Dh = D // H
        W = 256
        qkv = (lambda x, *d: x.permute(*d))((x @ wqkv).reshape(B, S, 3, H, Dh), 2, 0, 3, 1, 4)
        q, k, v = (qkv[0], qkv[1], qkv[2])
        scores = torch.einsum('bhqd,bhkd->bhqk', q, k) * Dh ** (-0.5)
        idx = torch.arange(S)
        mask = (idx[:, None] - idx[None, :] >= 0) & (idx[:, None] - idx[None, :] < W)
        scores = torch.where(mask[None, None], scores, -1000000000.0)
        p = _softmax(scores, axis=-1)
        o = torch.einsum('bhqk,bhkd->bhqd', p, v)
        return (lambda x, *d: x.permute(*d))(o, 0, 2, 1, 3).reshape(B, S, D) @ wo

    def _B_ref(x, w_gate, w_up, w_down):
        g = _silu(x @ w_gate)
        u = x @ w_up
        return g * u @ w_down
    x = A_x
    mod = (_silu(c) @ w_mod).reshape(c.shape[0], 6, 1, -1)
    sa, ca, ga, sb, cb, gb = (mod[:, 0].clone(), mod[:, 1].clone(), mod[:, 2].clone(), mod[:, 3].clone(), mod[:, 4].clone(), mod[:, 5].clone())
    h = _layernorm(x, axis=-1) * (1 + ca) + sa
    x = x + ga * _A_ref(h, A_wqkv, A_wo)
    h = _layernorm(x, axis=-1) * (1 + cb) + sb
    x = x + gb * _B_ref(h, B_w_gate, B_w_up, B_w_down)
    return x
```

```asm
; @launch kernel=adaLN_cond__sliding_block__swiglu_ffn__prompt_kernel grid=(256,1,1) block=(512,1,1) lds=163840
.amdgcn_target "amdgcn-amd-amdhsa--gfx950"
.text
.globl adaLN_cond__sliding_block__swiglu_ffn__prompt_kernel
.p2align 8
.type adaLN_cond__sliding_block__swiglu_ffn__prompt_kernel,@function
adaLN_cond__sliding_block__swiglu_ffn__prompt_kernel:
    s_cmp_ge_u32 s2, 256
    s_cbranch_scc1 L_mega_end
    s_load_dwordx2 s[84:85], s[0:1], 88
    s_load_dwordx2 s[86:87], s[0:1], 0
    s_load_dwordx4 s[88:91], s[0:1], 8
    s_load_dwordx4 s[92:95], s[0:1], 32
    s_load_dwordx2 s[96:97], s[0:1], 48
    s_load_dwordx2 s[98:99], s[0:1], 72
    s_load_dwordx2 s[80:81], s[0:1], 80
    s_load_dwordx4 s[76:79], s[0:1], 56
    s_memrealtime s[4:5]
    v_lshrrev_b32 v1, 6, v0
    v_and_b32 v2, 63, v0
    v_readfirstlane_b32 s3, v1
    s_waitcnt vmcnt(0) lgkmcnt(0)
    s_mov_b32 s12, s84
    s_and_b32 s13, s85, 0xffff
    s_mov_b32 s14, 29884416
    s_mov_b32 s15, 0x00020000
    s_add_u32 s6, s2, s3
    s_cmp_lg_u32 s6, 0
    s_cbranch_scc1 L_notag
    s_or_b32 s4, s4, 1
    v_mov_b32 v250, 0
    v_mov_b32 v251, s4
    s_mov_b64 exec, 1
    global_store_dword v250, v251, s[80:81] sc1
    s_mov_b64 exec, -1
L_notag:
    s_nop 1
    s_getpc_b64 s[4:5]
L_pcref:
    s_lshr_b32 s6, s2, 3
    s_cmp_lg_u32 s6, 31
    s_cbranch_scc1 L_nopfc
    v_lshlrev_b32 v250, 7, v0
    v_cmp_gt_u32 vcc, L_mega_end-L_pcref, v250
    s_and_saveexec_b64 s[6:7], vcc
    s_cbranch_execz L_nopfc2
    global_load_dword v249, v250, s[4:5]
L_nopfc2:
    s_mov_b64 exec, -1
L_nopfc:
    s_and_b32 s20, s2, 7
    s_lshr_b32 s21, s2, 3
    s_and_b32 s22, s20, 3
    s_lshl_b32 s22, s22, 2
    s_and_b32 s23, s21, 3
    s_add_u32 s22, s22, s23
    s_lshr_b32 s23, s20, 2
    s_lshl_b32 s23, s23, 3
    s_lshr_b32 s21, s21, 2
    s_add_u32 s23, s23, s21
    s_mov_b32 s24, s3
    s_mov_b32 s30, 0xffff0000
    v_lshrrev_b32 v20, 5, v2
    v_lshlrev_b32 v5, 4, v2
    s_cmp_ge_u32 s24, 4
    s_cbranch_scc1 L_p1_prod
    s_cmp_ge_u32 s23, 15
    s_cbranch_scc1 L_p1_idle
    s_mov_b32 s8, s88
    s_and_b32 s9, s89, 0xffff
    s_mov_b32 s10, 2457600
    s_mov_b32 s11, 0x00020000
    v_lshrrev_b32 v13, 4, v2
    v_and_b32 v14, 15, v2
    v_lshlrev_b32 v15, 2, v13
    v_xor_b32 v14, v14, v15
    v_mul_u32_u24 v13, 3840, v13
    v_lshl_add_u32 v13, v14, 4, v13
    s_mul_i32 s40, s24, 61440
    s_lshl_b32 s41, s23, 8
    s_add_u32 s40, s40, s41
    s_lshl_b32 s41, s24, 12
    v_mov_b32 v250, 0
    global_load_dword v252, v250, s[80:81] sc1
    s_mov_b32 s82, 0x200000
    v_mov_b32 v250, 0
L_tg_cons:
    s_waitcnt vmcnt(0)
    v_readfirstlane_b32 s83, v252
    s_nop 3
    s_cmp_lg_u32 s83, 0
    s_cbranch_scc1 L_tgd_cons
    global_load_dword v252, v250, s[80:81] sc1
    s_sub_u32 s82, s82, 1
    s_cmp_lg_u32 s82, 0
    s_cbranch_scc1 L_tg_cons
L_tgd_cons:
    v_mov_b32 v250, 163824
    v_mov_b32 v251, 0
    ds_write_b32 v250, v251
    s_waitcnt lgkmcnt(0)
    s_barrier
    s_add_u32 m0, s41, 0
    s_add_u32 s42, s40, 0
    buffer_load_dwordx4 v13, s[8:11], s42 offen lds
    s_add_u32 m0, s41, 1024
    s_add_u32 s42, s40, 15360
    buffer_load_dwordx4 v13, s[8:11], s42 offen lds
    s_add_u32 m0, s41, 2048
    s_add_u32 s42, s40, 30720
    buffer_load_dwordx4 v13, s[8:11], s42 offen lds
    s_add_u32 m0, s41, 3072
    s_add_u32 s42, s40, 46080
    buffer_load_dwordx4 v13, s[8:11], s42 offen lds
    s_add_u32 m0, s41, 16384
    s_add_u32 s42, s40, 245760
    buffer_load_dwordx4 v13, s[8:11], s42 offen lds
    s_add_u32 m0, s41, 17408
    s_add_u32 s42, s40, 261120
    buffer_load_dwordx4 v13, s[8:11], s42 offen lds
    s_add_u32 m0, s41, 18432
    s_add_u32 s42, s40, 276480
    buffer_load_dwordx4 v13, s[8:11], s42 offen lds
    s_add_u32 m0, s41, 19456
    s_add_u32 s42, s40, 291840
    buffer_load_dwordx4 v13, s[8:11], s42 offen lds
    v_mov_b32 v250, 163824
L_p1_cspin:
    ds_read_b32 v251, v250
    s_waitcnt lgkmcnt(0)
    v_readfirstlane_b32 s82, v251
    s_nop 3
    s_cmp_lg_u32 s82, 0
    s_cbranch_scc1 L_p1_cgo
    s_sleep 2
    s_branch L_p1_cspin
L_p1_cgo:
    s_add_u32 m0, s41, 32768
    s_add_u32 s42, s40, 491520
    buffer_load_dwordx4 v13, s[8:11], s42 offen lds
    s_add_u32 m0, s41, 33792
    s_add_u32 s42, s40, 506880
    buffer_load_dwordx4 v13, s[8:11], s42 offen lds
    s_add_u32 m0, s41, 34816
    s_add_u32 s42, s40, 522240
    buffer_load_dwordx4 v13, s[8:11], s42 offen lds
    s_add_u32 m0, s41, 35840
    s_add_u32 s42, s40, 537600
    buffer_load_dwordx4 v13, s[8:11], s42 offen lds
    s_lshr_b32 s25, s24, 1
    s_and_b32 s26, s24, 1
    v_bfe_u32 v21, v2, 4, 1
    v_bfe_u32 v22, v2, 2, 2
    v_and_b32 v23, 3, v2
    v_lshlrev_b32 v24, 11, v20
    v_lshl_add_u32 v24, v22, 8, v24
    v_lshl_add_u32 v24, v21, 5, v24
    v_lshl_add_u32 v24, v23, 3, v24
    s_lshl_b32 s27, s26, 1
    s_add_u32 s28, s27, 0
    v_xor_b32 v25, s28, v22
    v_lshl_add_u32 v8, v25, 6, v24
    v_add_u32 v9, 65536, v8
    s_add_u32 s28, s27, 1
    v_xor_b32 v25, s28, v22
    v_lshl_add_u32 v10, v25, 6, v24
    v_add_u32 v11, 65536, v10
    s_lshl_b32 s27, s25, 11
    s_add_u32 s27, s27, 98304
    v_add_u32 v12, s27, v5
    v_mov_b32 v32, 0
    v_mov_b32 v33, 0
    v_mov_b32 v34, 0
    v_mov_b32 v35, 0
    v_mov_b32 v36, 0
    v_mov_b32 v37, 0
    v_mov_b32 v38, 0
    v_mov_b32 v39, 0
    v_mov_b32 v40, 0
    v_mov_b32 v41, 0
    v_mov_b32 v42, 0
    v_mov_b32 v43, 0
    v_mov_b32 v44, 0
    v_mov_b32 v45, 0
    v_mov_b32 v46, 0
    v_mov_b32 v47, 0
    v_mov_b32 v48, 0
    v_mov_b32 v49, 0
    v_mov_b32 v50, 0
    v_mov_b32 v51, 0
    v_mov_b32 v52, 0
    v_mov_b32 v53, 0
    v_mov_b32 v54, 0
    v_mov_b32 v55, 0
    v_mov_b32 v56, 0
    v_mov_b32 v57, 0
    v_mov_b32 v58, 0
    v_mov_b32 v59, 0
    v_mov_b32 v60, 0
    v_mov_b32 v61, 0
    v_mov_b32 v62, 0
    v_mov_b32 v63, 0
    v_mov_b32 v64, 0
    v_mov_b32 v65, 0
    v_mov_b32 v66, 0
    v_mov_b32 v67, 0
    v_mov_b32 v68, 0
    v_mov_b32 v69, 0
    v_mov_b32 v70, 0
    v_mov_b32 v71, 0
    v_mov_b32 v72, 0
    v_mov_b32 v73, 0
    v_mov_b32 v74, 0
    v_mov_b32 v75, 0
    v_mov_b32 v76, 0
    v_mov_b32 v77, 0
    v_mov_b32 v78, 0
    v_mov_b32 v79, 0
    v_mov_b32 v80, 0
    v_mov_b32 v81, 0
    v_mov_b32 v82, 0
    v_mov_b32 v83, 0
    v_mov_b32 v84, 0
    v_mov_b32 v85, 0
    v_mov_b32 v86, 0
    v_mov_b32 v87, 0
    v_mov_b32 v88, 0
    v_mov_b32 v89, 0
    v_mov_b32 v90, 0
    v_mov_b32 v91, 0
    v_mov_b32 v92, 0
    v_mov_b32 v93, 0
    v_mov_b32 v94, 0
    v_mov_b32 v95, 0
    s_waitcnt vmcnt(8)
    s_barrier
    ds_read_b128 v[128:131], v12 offset:0
    ds_read_b64_tr_b16 v[144:145], v8 offset:0
    ds_read_b64_tr_b16 v[146:147], v8 offset:1024
    ds_read_b128 v[132:135], v12 offset:1024
    ds_read_b64_tr_b16 v[148:149], v10 offset:0
    ds_read_b64_tr_b16 v[150:151], v10 offset:1024
    s_cmp_ge_u32 s23, 10
    s_cbranch_scc1 L_p1_v
    s_waitcnt lgkmcnt(3)
    v_mfma_f32_32x32x16_bf16 v[32:47], v[144:147], v[128:131], v[32:47]
    ds_read_b128 v[136:139], v12 offset:4096
    ds_read_b64_tr_b16 v[156:157], v8 offset:4096
    s_waitcnt lgkmcnt(4)
    v_mfma_f32_32x32x16_bf16 v[64:79], v[144:147], v[132:135], v[64:79]
    ds_read_b64_tr_b16 v[158:159], v8 offset:5120
    ds_read_b128 v[140:143], v12 offset:5120
    s_waitcnt lgkmcnt(4)
    v_mfma_f32_32x32x16_bf16 v[48:63], v[148:151], v[128:131], v[48:63]
    ds_read_b64_tr_b16 v[160:161], v10 offset:4096
    ds_read_b64_tr_b16 v[162:163], v10 offset:5120
    v_mfma_f32_32x32x16_bf16 v[80:95], v[148:151], v[132:135], v[80:95]
    s_add_u32 m0, s41, 49152
    s_add_u32 s42, s40, 737280
    buffer_load_dwordx4 v13, s[8:11], s42 offen lds
    s_add_u32 m0, s41, 50176
    s_add_u32 s42, s40, 752640
    buffer_load_dwordx4 v13, s[8:11], s42 offen lds
    s_waitcnt lgkmcnt(3)
    v_mfma_f32_32x32x16_bf16 v[32:47], v[156:159], v[136:139], v[32:47]
    ds_read_b128 v[128:131], v12 offset:8192
    ds_read_b64_tr_b16 v[144:145], v8 offset:8192
    s_waitcnt lgkmcnt(4)
    v_mfma_f32_32x32x16_bf16 v[64:79], v[156:159], v[140:143], v[64:79]
    ds_read_b64_tr_b16 v[146:147], v8 offset:9216
    ds_read_b128 v[132:135], v12 offset:9216
    s_waitcnt lgkmcnt(4)
    v_mfma_f32_32x32x16_bf16 v[48:63], v[160:163], v[136:139], v[48:63]
    ds_read_b64_tr_b16 v[148:149], v10 offset:8192
    ds_read_b64_tr_b16 v[150:151], v10 offset:9216
    v_mfma_f32_32x32x16_bf16 v[80:95], v[160:163], v[140:143], v[80:95]
    s_add_u32 m0, s41, 51200
    s_add_u32 s42, s40, 768000
    buffer_load_dwordx4 v13, s[8:11], s42 offen lds
    s_add_u32 m0, s41, 52224
    s_add_u32 s42, s40, 783360
    buffer_load_dwordx4 v13, s[8:11], s42 offen lds
    s_waitcnt lgkmcnt(3)
    v_mfma_f32_32x32x16_bf16 v[32:47], v[144:147], v[128:131], v[32:47]
    ds_read_b128 v[136:139], v12 offset:12288
    ds_read_b64_tr_b16 v[156:157], v8 offset:12288
    s_waitcnt lgkmcnt(4)
    v_mfma_f32_32x32x16_bf16 v[64:79], v[144:147], v[132:135], v[64:79]
    ds_read_b64_tr_b16 v[158:159], v8 offset:13312
    ds_read_b128 v[140:143], v12 offset:13312
    s_waitcnt lgkmcnt(4)
    v_mfma_f32_32x32x16_bf16 v[48:63], v[148:151], v[128:131], v[48:63]
    ds_read_b64_tr_b16 v[160:161], v10 offset:12288
    ds_read_b64_tr_b16 v[162:163], v10 offset:13312
    v_mfma_f32_32x32x16_bf16 v[80:95], v[148:151], v[132:135], v[80:95]
    s_waitcnt vmcnt(8)
    s_waitcnt lgkmcnt(0)
    s_barrier
    v_mfma_f32_32x32x16_bf16 v[32:47], v[156:159], v[136:139], v[32:47]
    ds_read_b128 v[128:131], v12 offset:16384
    ds_read_b64_tr_b16 v[144:145], v8 offset:16384
    v_mfma_f32_32x32x16_bf16 v[64:79], v[156:159], v[140:143], v[64:79]
    ds_read_b64_tr_b16 v[146:147], v8 offset:17408
    ds_read_b128 v[132:135], v12 offset:17408
    v_mfma_f32_32x32x16_bf16 v[48:63], v[160:163], v[136:139], v[48:63]
    ds_read_b64_tr_b16 v[148:149], v10 offset:16384
    ds_read_b64_tr_b16 v[150:151], v10 offset:17408
    v_mfma_f32_32x32x16_bf16 v[80:95], v[160:163], v[140:143], v[80:95]
    s_add_u32 m0, s41, 65536
    s_add_u32 s42, s40, 983040
    buffer_load_dwordx4 v13, s[8:11], s42 offen lds
    s_add_u32 m0, s41, 66560
    s_add_u32 s42, s40, 998400
    buffer_load_dwordx4 v13, s[8:11], s42 offen lds
    s_waitcnt lgkmcnt(3)
    v_mfma_f32_32x32x16_bf16 v[32:47], v[144:147], v[128:131], v[32:47]
    ds_read_b128 v[136:139], v12 offset:20480
    ds_read_b64_tr_b16 v[156:157], v8 offset:20480
    s_waitcnt lgkmcnt(4)
    v_mfma_f32_32x32x16_bf16 v[64:79], v[144:147], v[132:135], v[64:79]
    ds_read_b64_tr_b16 v[158:159], v8 offset:21504
    ds_read_b128 v[140:143], v12 offset:21504
    s_waitcnt lgkmcnt(4)
    v_mfma_f32_32x32x16_bf16 v[48:63], v[148:151], v[128:131], v[48:63]
    ds_read_b64_tr_b16 v[160:161], v10 offset:20480
    ds_read_b64_tr_b16 v[162:163], v10 offset:21504
    v_mfma_f32_32x32x16_bf16 v[80:95], v[148:151], v[132:135], v[80:95]
    s_add_u32 m0, s41, 67584
    s_add_u32 s42, s40, 1013760
    buffer_load_dwordx4 v13, s[8:11], s42 offen lds
    s_add_u32 m0, s41, 68608
    s_add_u32 s42, s40, 1029120
    buffer_load_dwordx4 v13, s[8:11], s42 offen lds
    s_waitcnt lgkmcnt(3)
    v_mfma_f32_32x32x16_bf16 v[32:47], v[156:159], v[136:139], v[32:47]
    ds_read_b128 v[128:131], v12 offset:24576
    ds_read_b64_tr_b16 v[144:145], v8 offset:24576
    s_waitcnt lgkmcnt(4)
    v_mfma_f32_32x32x16_bf16 v[64:79], v[156:159], v[140:143], v[64:79]
    ds_read_b64_tr_b16 v[146:147], v8 offset:25600
    ds_read_b128 v[132:135], v12 offset:25600
    s_waitcnt lgkmcnt(4)
    v_mfma_f32_32x32x16_bf16 v[48:63], v[160:163], v[136:139], v[48:63]
    ds_read_b64_tr_b16 v[148:149], v10 offset:24576
    ds_read_b64_tr_b16 v[150:151], v10 offset:25600
    v_mfma_f32_32x32x16_bf16 v[80:95], v[160:163], v[140:143], v[80:95]
    s_waitcnt lgkmcnt(3)
    v_mfma_f32_32x32x16_bf16 v[32:47], v[144:147], v[128:131], v[32:47]
    ds_read_b128 v[136:139], v12 offset:28672
    ds_read_b64_tr_b16 v[156:157], v8 offset:28672
    s_waitcnt lgkmcnt(4)
    v_mfma_f32_32x32x16_bf16 v[64:79], v[144:147], v[132:135], v[64:79]
    ds_read_b64_tr_b16 v[158:159], v8 offset:29696
    ds_read_b128 v[140:143], v12 offset:29696
    s_waitcnt lgkmcnt(4)
    v_mfma_f32_32x32x16_bf16 v[48:63], v[148:151], v[128:131], v[48:63]
    ds_read_b64_tr_b16 v[160:161], v10 offset:28672
    ds_read_b64_tr_b16 v[162:163], v10 offset:29696
    v_mfma_f32_32x32x16_bf16 v[80:95], v[148:151], v[132:135], v[80:95]
    s_waitcnt vmcnt(8)
    s_waitcnt lgkmcnt(0)
    s_barrier
    v_mfma_f32_32x32x16_bf16 v[32:47], v[156:159], v[136:139], v[32:47]
    ds_read_b128 v[128:131], v12 offset:32768
    ds_read_b64_tr_b16 v[144:145], v8 offset:32768
    v_mfma_f32_32x32x16_bf16 v[64:79], v[156:159], v[140:143], v[64:79]
    ds_read_b64_tr_b16 v[146:147], v8 offset:33792
    ds_read_b128 v[132:135], v12 offset:33792
    v_mfma_f32_32x32x16_bf16 v[48:63], v[160:163], v[136:139], v[48:63]
    ds_read_b64_tr_b16 v[148:149], v10 offset:32768
    ds_read_b64_tr_b16 v[150:151], v10 offset:33792
    v_mfma_f32_32x32x16_bf16 v[80:95], v[160:163], v[140:143], v[80:95]
    s_add_u32 m0, s41, 81920
    s_add_u32 s42, s40, 1228800
    buffer_load_dwordx4 v13, s[8:11], s42 offen lds
    s_add_u32 m0, s41, 82944
    s_add_u32 s42, s40, 1244160
    buffer_load_dwordx4 v13, s[8:11], s42 offen lds
    s_waitcnt lgkmcnt(3)
    v_mfma_f32_32x32x16_bf16 v[32:47], v[144:147], v[128:131], v[32:47]
    ds_read_b128 v[136:139], v12 offset:36864
    ds_read_b64_tr_b16 v[156:157], v8 offset:36864
    s_waitcnt lgkmcnt(4)
    v_mfma_f32_32x32x16_bf16 v[64:79], v[144:147], v[132:135], v[64:79]
    ds_read_b64_tr_b16 v[158:159], v8 offset:37888
    ds_read_b128 v[140:143], v12 offset:37888
    s_waitcnt lgkmcnt(4)
    v_mfma_f32_32x32x16_bf16 v[48:63], v[148:151], v[128:131], v[48:63]
    ds_read_b64_tr_b16 v[160:161], v10 offset:36864
    ds_read_b64_tr_b16 v[162:163], v10 offset:37888
    v_mfma_f32_32x32x16_bf16 v[80:95], v[148:151], v[132:135], v[80:95]
    s_add_u32 m0, s41, 83968
    s_add_u32 s42, s40, 1259520
    buffer_load_dwordx4 v13, s[8:11], s42 offen lds
    s_add_u32 m0, s41, 84992
    s_add_u32 s42, s40, 1274880
    buffer_load_dwordx4 v13, s[8:11], s42 offen lds
    s_waitcnt lgkmcnt(3)
    v_mfma_f32_32x32x16_bf16 v[32:47], v[156:159], v[136:139], v[32:47]
    ds_read_b128 v[128:131], v12 offset:40960
    ds_read_b64_tr_b16 v[144:145], v8 offset:40960
    s_waitcnt lgkmcnt(4)
    v_mfma_f32_32x32x16_bf16 v[64:79], v[156:159], v[140:143], v[64:79]
    ds_read_b64_tr_b16 v[146:147], v8 offset:41984
    ds_read_b128 v[132:135], v12 offset:41984
    s_waitcnt lgkmcnt(4)
    v_mfma_f32_32x32x16_bf16 v[48:63], v[160:163], v[136:139], v[48:63]
    ds_read_b64_tr_b16 v[148:149], v10 offset:40960
    ds_read_b64_tr_b16 v[150:151], v10 offset:41984
    v_mfma_f32_32x32x16_bf16 v[80:95], v[160:163], v[140:143], v[80:95]
    s_waitcnt lgkmcnt(3)
    v_mfma_f32_32x32x16_bf16 v[32:47], v[144:147], v[128:131], v[32:47]
    ds_read_b128 v[136:139], v12 offset:45056
    ds_read_b64_tr_b16 v[156:157], v8 offset:45056
    s_waitcnt lgkmcnt(4)
    v_mfma_f32_32x32x16_bf16 v[64:79], v[144:147], v[132:135], v[64:79]
    ds_read_b64_tr_b16 v[158:159], v8 offset:46080
    ds_read_b128 v[140:143], v12 offset:46080
    s_waitcnt lgkmcnt(4)
    v_mfma_f32_32x32x16_bf16 v[48:63], v[148:151], v[128:131], v[48:63]
    ds_read_b64_tr_b16 v[160:161], v10 offset:45056
    ds_read_b64_tr_b16 v[162:163], v10 offset:46080
    v_mfma_f32_32x32x16_bf16 v[80:95], v[148:151], v[132:135], v[80:95]
    s_waitcnt vmcnt(8)
    s_waitcnt lgkmcnt(0)
    s_barrier
    v_mfma_f32_32x32x16_bf16 v[32:47], v[156:159], v[136:139], v[32:47]
    ds_read_b128 v[128:131], v12 offset:0
    ds_read_b64_tr_b16 v[144:145], v8 offset:49152
    v_mfma_f32_32x32x16_bf16 v[64:79], v[156:159], v[140:143], v[64:79]
    ds_read_b64_tr_b16 v[146:147], v8 offset:50176
    ds_read_b128 v[132:135], v12 offset:1024
    v_mfma_f32_32x32x16_bf16 v[48:63], v[160:163], v[136:139], v[48:63]
    ds_read_b64_tr_b16 v[148:149], v10 offset:49152
    ds_read_b64_tr_b16 v[150:151], v10 offset:50176
    v_mfma_f32_32x32x16_bf16 v[80:95], v[160:163], v[140:143], v[80:95]
    s_add_u32 m0, s41, 0
    s_add_u32 s42, s40, 1474560
    buffer_load_dwordx4 v13, s[8:11], s42 offen lds
    s_add_u32 m0, s41, 1024
    s_add_u32 s42, s40, 1489920
    buffer_load_dwordx4 v13, s[8:11], s42 offen lds
    s_waitcnt lgkmcnt(3)
    v_mfma_f32_32x32x16_bf16 v[32:47], v[144:147], v[128:131], v[32:47]
    ds_read_b128 v[136:139], v12 offset:4096
    ds_read_b64_tr_b16 v[156:157], v8 offset:53248
    s_waitcnt lgkmcnt(4)
    v_mfma_f32_32x32x16_bf16 v[64:79], v[144:147], v[132:135], v[64:79]
    ds_read_b64_tr_b16 v[158:159], v8 offset:54272
    ds_read_b128 v[140:143], v12 offset:5120
    s_waitcnt lgkmcnt(4)
    v_mfma_f32_32x32x16_bf16 v[48:63], v[148:151], v[128:131], v[48:63]
    ds_read_b64_tr_b16 v[160:161], v10 offset:53248
    ds_read_b64_tr_b16 v[162:163], v10 offset:54272
    v_mfma_f32_32x32x16_bf16 v[80:95], v[148:151], v[132:135], v[80:95]
    s_add_u32 m0, s41, 2048
    s_add_u32 s42, s40, 1505280
    buffer_load_dwordx4 v13, s[8:11], s42 offen lds
    s_add_u32 m0, s41, 3072
    s_add_u32 s42, s40, 1520640
    buffer_load_dwordx4 v13, s[8:11], s42 offen lds
    s_waitcnt lgkmcnt(3)
    v_mfma_f32_32x32x16_bf16 v[32:47], v[156:159], v[136:139], v[32:47]
    ds_read_b128 v[128:131], v12 offset:8192
    ds_read_b64_tr_b16 v[144:145], v8 offset:57344
    s_waitcnt lgkmcnt(4)
    v_mfma_f32_32x32x16_bf16 v[64:79], v[156:159], v[140:143], v[64:79]
    ds_read_b64_tr_b16 v[146:147], v8 offset:58368
    ds_read_b128 v[132:135], v12 offset:9216
    s_waitcnt lgkmcnt(4)
    v_mfma_f32_32x32x16_bf16 v[48:63], v[160:163], v[136:139], v[48:63]
    ds_read_b64_tr_b16 v[148:149], v10 offset:57344
    ds_read_b64_tr_b16 v[150:151], v10 offset:58368
    v_mfma_f32_32x32x16_bf16 v[80:95], v[160:163], v[140:143], v[80:95]
    s_waitcnt lgkmcnt(3)
    v_mfma_f32_32x32x16_bf16 v[32:47], v[144:147], v[128:131], v[32:47]
    ds_read_b128 v[136:139], v12 offset:12288
    ds_read_b64_tr_b16 v[156:157], v8 offset:61440
    s_waitcnt lgkmcnt(4)
    v_mfma_f32_32x32x16_bf16 v[64:79], v[144:147], v[132:135], v[64:79]
    ds_read_b64_tr_b16 v[158:159], v8 offset:62464
    ds_read_b128 v[140:143], v12 offset:13312
    s_waitcnt lgkmcnt(4)
    v_mfma_f32_32x32x16_bf16 v[48:63], v[148:151], v[128:131], v[48:63]
    ds_read_b64_tr_b16 v[160:161], v10 offset:61440
    ds_read_b64_tr_b16 v[162:163], v10 offset:62464
    v_mfma_f32_32x32x16_bf16 v[80:95], v[148:151], v[132:135], v[80:95]
    s_waitcnt vmcnt(8)
    s_waitcnt lgkmcnt(0)
    s_barrier
    v_mfma_f32_32x32x16_bf16 v[32:47], v[156:159], v[136:139], v[32:47]
    ds_read_b128 v[128:131], v12 offset:16384
    ds_read_b64_tr_b16 v[144:145], v9 offset:0
    v_mfma_f32_32x32x16_bf16 v[64:79], v[156:159], v[140:143], v[64:79]
    ds_read_b64_tr_b16 v[146:147], v9 offset:1024
    ds_read_b128 v[132:135], v12 offset:17408
    v_mfma_f32_32x32x16_bf16 v[48:63], v[160:163], v[136:139], v[48:63]
    ds_read_b64_tr_b16 v[148:149], v11 offset:0
    ds_read_b64_tr_b16 v[150:151], v11 offset:1024
    v_mfma_f32_32x32x16_bf16 v[80:95], v[160:163], v[140:143], v[80:95]
    s_add_u32 m0, s41, 16384
    s_add_u32 s42, s40, 1720320
    buffer_load_dwordx4 v13, s[8:11], s42 offen lds
    s_add_u32 m0, s41, 17408
    s_add_u32 s42, s40, 1735680
    buffer_load_dwordx4 v13, s[8:11], s42 offen lds
    s_waitcnt lgkmcnt(3)
    v_mfma_f32_32x32x16_bf16 v[32:47], v[144:147], v[128:131], v[32:47]
    ds_read_b128 v[136:139], v12 offset:20480
    ds_read_b64_tr_b16 v[156:157], v9 offset:4096
    s_waitcnt lgkmcnt(4)
    v_mfma_f32_32x32x16_bf16 v[64:79], v[144:147], v[132:135], v[64:79]
    ds_read_b64_tr_b16 v[158:159], v9 offset:5120
    ds_read_b128 v[140:143], v12 offset:21504
    s_waitcnt lgkmcnt(4)
    v_mfma_f32_32x32x16_bf16 v[48:63], v[148:151], v[128:131], v[48:63]
    ds_read_b64_tr_b16 v[160:161], v11 offset:4096
    ds_read_b64_tr_b16 v[162:163], v11 offset:5120
    v_mfma_f32_32x32x16_bf16 v[80:95], v[148:151], v[132:135], v[80:95]
    s_add_u32 m0, s41, 18432
    s_add_u32 s42, s40, 1751040
    buffer_load_dwordx4 v13, s[8:11], s42 offen lds
    s_add_u32 m0, s41, 19456
    s_add_u32 s42, s40, 1766400
    buffer_load_dwordx4 v13, s[8:11], s42 offen lds
    s_waitcnt lgkmcnt(3)
    v_mfma_f32_32x32x16_bf16 v[32:47], v[156:159], v[136:139], v[32:47]
    ds_read_b128 v[128:131], v12 offset:24576
    ds_read_b64_tr_b16 v[144:145], v9 offset:8192
    s_waitcnt lgkmcnt(4)
    v_mfma_f32_32x32x16_bf16 v[64:79], v[156:159], v[140:143], v[64:79]
    ds_read_b64_tr_b16 v[146:147], v9 offset:9216
    ds_read_b128 v[132:135], v12 offset:25600
    s_waitcnt lgkmcnt(4)
    v_mfma_f32_32x32x16_bf16 v[48:63], v[160:163], v[136:139], v[48:63]
    ds_read_b64_tr_b16 v[148:149], v11 offset:8192
    ds_read_b64_tr_b16 v[150:151], v11 offset:9216
    v_mfma_f32_32x32x16_bf16 v[80:95], v[160:163], v[140:143], v[80:95]
    s_waitcnt lgkmcnt(3)
    v_mfma_f32_32x32x16_bf16 v[32:47], v[144:147], v[128:131], v[32:47]
    ds_read_b128 v[136:139], v12 offset:28672
    ds_read_b64_tr_b16 v[156:157], v9 offset:12288
    s_waitcnt lgkmcnt(4)
    v_mfma_f32_32x32x16_bf16 v[64:79], v[144:147], v[132:135], v[64:79]
    ds_read_b64_tr_b16 v[158:159], v9 offset:13312
    ds_read_b128 v[140:143], v12 offset:29696
    s_waitcnt lgkmcnt(4)
    v_mfma_f32_32x32x16_bf16 v[48:63], v[148:151], v[128:131], v[48:63]
    ds_read_b64_tr_b16 v[160:161], v11 offset:12288
    ds_read_b64_tr_b16 v[162:163], v11 offset:13312
    v_mfma_f32_32x32x16_bf16 v[80:95], v[148:151], v[132:135], v[80:95]
    s_waitcnt vmcnt(8)
    s_waitcnt lgkmcnt(0)
    s_barrier
    v_mfma_f32_32x32x16_bf16 v[32:47], v[156:159], v[136:139], v[32:47]
    ds_read_b128 v[128:131], v12 offset:32768
    ds_read_b64_tr_b16 v[144:145], v9 offset:16384
    v_mfma_f32_32x32x16_bf16 v[64:79], v[156:159], v[140:143], v[64:79]
    ds_read_b64_tr_b16 v[146:147], v9 offset:17408
    ds_read_b128 v[132:135], v12 offset:33792
    v_mfma_f32_32x32x16_bf16 v[48:63], v[160:163], v[136:139], v[48:63]
    ds_read_b64_tr_b16 v[148:149], v11 offset:16384
    ds_read_b64_tr_b16 v[150:151], v11 offset:17408
    v_mfma_f32_32x32x16_bf16 v[80:95], v[160:163], v[140:143], v[80:95]
    s_add_u32 m0, s41, 32768
    s_add_u32 s42, s40, 1966080
    buffer_load_dwordx4 v13, s[8:11], s42 offen lds
    s_add_u32 m0, s41, 33792
    s_add_u32 s42, s40, 1981440
    buffer_load_dwordx4 v13, s[8:11], s42 offen lds
    s_waitcnt lgkmcnt(3)
    v_mfma_f32_32x32x16_bf16 v[32:47], v[144:147], v[128:131], v[32:47]
    ds_read_b128 v[136:139], v12 offset:36864
    ds_read_b64_tr_b16 v[156:157], v9 offset:20480
    s_waitcnt lgkmcnt(4)
    v_mfma_f32_32x32x16_bf16 v[64:79], v[144:147], v[132:135], v[64:79]
    ds_read_b64_tr_b16 v[158:159], v9 offset:21504
    ds_read_b128 v[140:143], v12 offset:37888
    s_waitcnt lgkmcnt(4)
    v_mfma_f32_32x32x16_bf16 v[48:63], v[148:151], v[128:131], v[48:63]
    ds_read_b64_tr_b16 v[160:161], v11 offset:20480
    ds_read_b64_tr_b16 v[162:163], v11 offset:21504
    v_mfma_f32_32x32x16_bf16 v[80:95], v[148:151], v[132:135], v[80:95]
    s_add_u32 m0, s41, 34816
    s_add_u32 s42, s40, 1996800
    buffer_load_dwordx4 v13, s[8:11], s42 offen lds
    s_add_u32 m0, s41, 35840
    s_add_u32 s42, s40, 2012160
    buffer_load_dwordx4 v13, s[8:11], s42 offen lds
    s_waitcnt lgkmcnt(3)
    v_mfma_f32_32x32x16_bf16 v[32:47], v[156:159], v[136:139], v[32:47]
    ds_read_b128 v[128:131], v12 offset:40960
    ds_read_b64_tr_b16 v[144:145], v9 offset:24576
    s_waitcnt lgkmcnt(4)
    v_mfma_f32_32x32x16_bf16 v[64:79], v[156:159], v[140:143], v[64:79]
    ds_read_b64_tr_b16 v[146:147], v9 offset:25600
    ds_read_b128 v[132:135], v12 offset:41984
    s_waitcnt lgkmcnt(4)
    v_mfma_f32_32x32x16_bf16 v[48:63], v[160:163], v[136:139], v[48:63]
    ds_read_b64_tr_b16 v[148:149], v11 offset:24576
    ds_read_b64_tr_b16 v[150:151], v11 offset:25600
    v_mfma_f32_32x32x16_bf16 v[80:95], v[160:163], v[140:143], v[80:95]
    s_waitcnt lgkmcnt(3)
    v_mfma_f32_32x32x16_bf16 v[32:47], v[144:147], v[128:131], v[32:47]
    ds_read_b128 v[136:139], v12 offset:45056
    ds_read_b64_tr_b16 v[156:157], v9 offset:28672
    s_waitcnt lgkmcnt(4)
    v_mfma_f32_32x32x16_bf16 v[64:79], v[144:147], v[132:135], v[64:79]
    ds_read_b64_tr_b16 v[158:159], v9 offset:29696
    ds_read_b128 v[140:143], v12 offset:46080
    s_waitcnt lgkmcnt(4)
    v_mfma_f32_32x32x16_bf16 v[48:63], v[148:151], v[128:131], v[48:63]
    ds_read_b64_tr_b16 v[160:161], v11 offset:28672
    ds_read_b64_tr_b16 v[162:163], v11 offset:29696
    v_mfma_f32_32x32x16_bf16 v[80:95], v[148:151], v[132:135], v[80:95]
    s_waitcnt vmcnt(8)
    s_waitcnt lgkmcnt(0)
    s_barrier
    v_mfma_f32_32x32x16_bf16 v[32:47], v[156:159], v[136:139], v[32:47]
    ds_read_b128 v[128:131], v12 offset:0
    ds_read_b64_tr_b16 v[144:145], v8 offset:0
    v_mfma_f32_32x32x16_bf16 v[64:79], v[156:159], v[140:143], v[64:79]
    ds_read_b64_tr_b16 v[146:147], v8 offset:1024
    ds_read_b128 v[132:135], v12 offset:1024
    v_mfma_f32_32x32x16_bf16 v[48:63], v[160:163], v[136:139], v[48:63]
    ds_read_b64_tr_b16 v[148:149], v10 offset:0
    ds_read_b64_tr_b16 v[150:151], v10 offset:1024
    v_mfma_f32_32x32x16_bf16 v[80:95], v[160:163], v[140:143], v[80:95]
    s_add_u32 m0, s41, 49152
    s_add_u32 s42, s40, 2211840
    buffer_load_dwordx4 v13, s[8:11], s42 offen lds
    s_add_u32 m0, s41, 50176
    s_add_u32 s42, s40, 2227200
    buffer_load_dwordx4 v13, s[8:11], s42 offen lds
    s_waitcnt lgkmcnt(3)
    v_mfma_f32_32x32x16_bf16 v[32:47], v[144:147], v[128:131], v[32:47]
    ds_read_b128 v[136:139], v12 offset:4096
    ds_read_b64_tr_b16 v[156:157], v8 offset:4096
    s_waitcnt lgkmcnt(4)
    v_mfma_f32_32x32x16_bf16 v[64:79], v[144:147], v[132:135], v[64:79]
    ds_read_b64_tr_b16 v[158:159], v8 offset:5120
    ds_read_b128 v[140:143], v12 offset:5120
    s_waitcnt lgkmcnt(4)
    v_mfma_f32_32x32x16_bf16 v[48:63], v[148:151], v[128:131], v[48:63]
    ds_read_b64_tr_b16 v[160:161], v10 offset:4096
    ds_read_b64_tr_b16 v[162:163], v10 offset:5120
    v_mfma_f32_32x32x16_bf16 v[80:95], v[148:151], v[132:135], v[80:95]
    s_add_u32 m0, s41, 51200
    s_add_u32 s42, s40, 2242560
    buffer_load_dwordx4 v13, s[8:11], s42 offen lds
    s_add_u32 m0, s41, 52224
    s_add_u32 s42, s40, 2257920
    buffer_load_dwordx4 v13, s[8:11], s42 offen lds
    s_waitcnt lgkmcnt(3)
    v_mfma_f32_32x32x16_bf16 v[32:47], v[156:159], v[136:139], v[32:47]
    ds_read_b128 v[128:131], v12 offset:8192
    ds_read_b64_tr_b16 v[144:145], v8 offset:8192
    s_waitcnt lgkmcnt(4)
    v_mfma_f32_32x32x16_bf16 v[64:79], v[156:159], v[140:143], v[64:79]
    ds_read_b64_tr_b16 v[146:147], v8 offset:9216
    ds_read_b128 v[132:135], v12 offset:9216
    s_waitcnt lgkmcnt(4)
    v_mfma_f32_32x32x16_bf16 v[48:63], v[160:163], v[136:139], v[48:63]
    ds_read_b64_tr_b16 v[148:149], v10 offset:8192
    ds_read_b64_tr_b16 v[150:151], v10 offset:9216
    v_mfma_f32_32x32x16_bf16 v[80:95], v[160:163], v[140:143], v[80:95]
    s_waitcnt lgkmcnt(3)
    v_mfma_f32_32x32x16_bf16 v[32:47], v[144:147], v[128:131], v[32:47]
    ds_read_b128 v[136:139], v12 offset:12288
    ds_read_b64_tr_b16 v[156:157], v8 offset:12288
    s_waitcnt lgkmcnt(4)
    v_mfma_f32_32x32x16_bf16 v[64:79], v[144:147], v[132:135], v[64:79]
    ds_read_b64_tr_b16 v[158:159], v8 offset:13312
    ds_read_b128 v[140:143], v12 offset:13312
    s_waitcnt lgkmcnt(4)
    v_mfma_f32_32x32x16_bf16 v[48:63], v[148:151], v[128:131], v[48:63]
    ds_read_b64_tr_b16 v[160:161], v10 offset:12288
    ds_read_b64_tr_b16 v[162:163], v10 offset:13312
    v_mfma_f32_32x32x16_bf16 v[80:95], v[148:151], v[132:135], v[80:95]
    s_waitcnt vmcnt(8)
    s_waitcnt lgkmcnt(0)
    s_barrier
    v_mfma_f32_32x32x16_bf16 v[32:47], v[156:159], v[136:139], v[32:47]
    ds_read_b128 v[128:131], v12 offset:16384
    ds_read_b64_tr_b16 v[144:145], v8 offset:16384
    v_mfma_f32_32x32x16_bf16 v[64:79], v[156:159], v[140:143], v[64:79]
    ds_read_b64_tr_b16 v[146:147], v8 offset:17408
    ds_read_b128 v[132:135], v12 offset:17408
    v_mfma_f32_32x32x16_bf16 v[48:63], v[160:163], v[136:139], v[48:63]
    ds_read_b64_tr_b16 v[148:149], v10 offset:16384
    ds_read_b64_tr_b16 v[150:151], v10 offset:17408
    v_mfma_f32_32x32x16_bf16 v[80:95], v[160:163], v[140:143], v[80:95]
    s_waitcnt lgkmcnt(3)
    v_mfma_f32_32x32x16_bf16 v[32:47], v[144:147], v[128:131], v[32:47]
    ds_read_b128 v[136:139], v12 offset:20480
    ds_read_b64_tr_b16 v[156:157], v8 offset:20480
    s_waitcnt lgkmcnt(4)
    v_mfma_f32_32x32x16_bf16 v[64:79], v[144:147], v[132:135], v[64:79]
    ds_read_b64_tr_b16 v[158:159], v8 offset:21504
    ds_read_b128 v[140:143], v12 offset:21504
    s_waitcnt lgkmcnt(4)
    v_mfma_f32_32x32x16_bf16 v[48:63], v[148:151], v[128:131], v[48:63]
    ds_read_b64_tr_b16 v[160:161], v10 offset:20480
    ds_read_b64_tr_b16 v[162:163], v10 offset:21504
    v_mfma_f32_32x32x16_bf16 v[80:95], v[148:151], v[132:135], v[80:95]
    s_waitcnt lgkmcnt(3)
    v_mfma_f32_32x32x16_bf16 v[32:47], v[156:159], v[136:139], v[32:47]
    ds_read_b128 v[128:131], v12 offset:24576
    ds_read_b64_tr_b16 v[144:145], v8 offset:24576
    s_waitcnt lgkmcnt(4)
    v_mfma_f32_32x32x16_bf16 v[64:79], v[156:159], v[140:143], v[64:79]
    ds_read_b64_tr_b16 v[146:147], v8 offset:25600
    ds_read_b128 v[132:135], v12 offset:25600
    s_waitcnt lgkmcnt(4)
    v_mfma_f32_32x32x16_bf16 v[48:63], v[160:163], v[136:139], v[48:63]
    ds_read_b64_tr_b16 v[148:149], v10 offset:24576
    ds_read_b64_tr_b16 v[150:151], v10 offset:25600
    v_mfma_f32_32x32x16_bf16 v[80:95], v[160:163], v[140:143], v[80:95]
    s_waitcnt lgkmcnt(3)
    v_mfma_f32_32x32x16_bf16 v[32:47], v[144:147], v[128:131], v[32:47]
    ds_read_b128 v[136:139], v12 offset:28672
    ds_read_b64_tr_b16 v[156:157], v8 offset:28672
    s_waitcnt lgkmcnt(4)
    v_mfma_f32_32x32x16_bf16 v[64:79], v[144:147], v[132:135], v[64:79]
    ds_read_b64_tr_b16 v[158:159], v8 offset:29696
    ds_read_b128 v[140:143], v12 offset:29696
    s_waitcnt lgkmcnt(4)
    v_mfma_f32_32x32x16_bf16 v[48:63], v[148:151], v[128:131], v[48:63]
    ds_read_b64_tr_b16 v[160:161], v10 offset:28672
    ds_read_b64_tr_b16 v[162:163], v10 offset:29696
    v_mfma_f32_32x32x16_bf16 v[80:95], v[148:151], v[132:135], v[80:95]
    s_waitcnt vmcnt(4)
    s_waitcnt lgkmcnt(0)
    s_barrier
    v_mfma_f32_32x32x16_bf16 v[32:47], v[156:159], v[136:139], v[32:47]
    ds_read_b128 v[128:131], v12 offset:32768
    ds_read_b64_tr_b16 v[144:145], v8 offset:32768
    v_mfma_f32_32x32x16_bf16 v[64:79], v[156:159], v[140:143], v[64:79]
    ds_read_b64_tr_b16 v[146:147], v8 offset:33792
    ds_read_b128 v[132:135], v12 offset:33792
    v_mfma_f32_32x32x16_bf16 v[48:63], v[160:163], v[136:139], v[48:63]
    ds_read_b64_tr_b16 v[148:149], v10 offset:32768
    ds_read_b64_tr_b16 v[150:151], v10 offset:33792
    v_mfma_f32_32x32x16_bf16 v[80:95], v[160:163], v[140:143], v[80:95]
    s_waitcnt lgkmcnt(3)
    v_mfma_f32_32x32x16_bf16 v[32:47], v[144:147], v[128:131], v[32:47]
    ds_read_b128 v[136:139], v12 offset:36864
    ds_read_b64_tr_b16 v[156:157], v8 offset:36864
    s_waitcnt lgkmcnt(4)
    v_mfma_f32_32x32x16_bf16 v[64:79], v[144:147], v[132:135], v[64:79]
    ds_read_b64_tr_b16 v[158:159], v8 offset:37888
    ds_read_b128 v[140:143], v12 offset:37888
    s_waitcnt lgkmcnt(4)
    v_mfma_f32_32x32x16_bf16 v[48:63], v[148:151], v[128:131], v[48:63]
    ds_read_b64_tr_b16 v[160:161], v10 offset:36864
    ds_read_b64_tr_b16 v[162:163], v10 offset:37888
    v_mfma_f32_32x32x16_bf16 v[80:95], v[148:151], v[132:135], v[80:95]
    s_waitcnt lgkmcnt(3)
    v_mfma_f32_32x32x16_bf16 v[32:47], v[156:159], v[136:139], v[32:47]
    ds_read_b128 v[128:131], v12 offset:40960
    ds_read_b64_tr_b16 v[144:145], v8 offset:40960
    s_waitcnt lgkmcnt(4)
    v_mfma_f32_32x32x16_bf16 v[64:79], v[156:159], v[140:143], v[64:79]
    ds_read_b64_tr_b16 v[146:147], v8 offset:41984
    ds_read_b128 v[132:135], v12 offset:41984
    s_waitcnt lgkmcnt(4)
    v_mfma_f32_32x32x16_bf16 v[48:63], v[160:163], v[136:139], v[48:63]
    ds_read_b64_tr_b16 v[148:149], v10 offset:40960
    ds_read_b64_tr_b16 v[150:151], v10 offset:41984
    v_mfma_f32_32x32x16_bf16 v[80:95], v[160:163], v[140:143], v[80:95]
    s_waitcnt lgkmcnt(3)
    v_mfma_f32_32x32x16_bf16 v[32:47], v[144:147], v[128:131], v[32:47]
    ds_read_b128 v[136:139], v12 offset:45056
    ds_read_b64_tr_b16 v[156:157], v8 offset:45056
    s_waitcnt lgkmcnt(4)
    v_mfma_f32_32x32x16_bf16 v[64:79], v[144:147], v[132:135], v[64:79]
    ds_read_b64_tr_b16 v[158:159], v8 offset:46080
    ds_read_b128 v[140:143], v12 offset:46080
    s_waitcnt lgkmcnt(4)
    v_mfma_f32_32x32x16_bf16 v[48:63], v[148:151], v[128:131], v[48:63]
    ds_read_b64_tr_b16 v[160:161], v10 offset:45056
    ds_read_b64_tr_b16 v[162:163], v10 offset:46080
    v_mfma_f32_32x32x16_bf16 v[80:95], v[148:151], v[132:135], v[80:95]
    s_waitcnt vmcnt(0)
    s_waitcnt lgkmcnt(0)
    s_barrier
    v_mfma_f32_32x32x16_bf16 v[32:47], v[156:159], v[136:139], v[32:47]
    ds_read_b128 v[128:131], v12 offset:0
    ds_read_b64_tr_b16 v[144:145], v8 offset:49152
    v_mfma_f32_32x32x16_bf16 v[64:79], v[156:159], v[140:143], v[64:79]
    ds_read_b64_tr_b16 v[146:147], v8 offset:50176
    ds_read_b128 v[132:135], v12 offset:1024
    v_mfma_f32_32x32x16_bf16 v[48:63], v[160:163], v[136:139], v[48:63]
    ds_read_b64_tr_b16 v[148:149], v10 offset:49152
    ds_read_b64_tr_b16 v[150:151], v10 offset:50176
    v_mfma_f32_32x32x16_bf16 v[80:95], v[160:163], v[140:143], v[80:95]
    s_waitcnt lgkmcnt(3)
    v_mfma_f32_32x32x16_bf16 v[32:47], v[144:147], v[128:131], v[32:47]
    ds_read_b128 v[136:139], v12 offset:4096
    ds_read_b64_tr_b16 v[156:157], v8 offset:53248
    s_waitcnt lgkmcnt(4)
    v_mfma_f32_32x32x16_bf16 v[64:79], v[144:147], v[132:135], v[64:79]
    ds_read_b64_tr_b16 v[158:159], v8 offset:54272
    ds_read_b128 v[140:143], v12 offset:5120
    s_waitcnt lgkmcnt(4)
    v_mfma_f32_32x32x16_bf16 v[48:63], v[148:151], v[128:131], v[48:63]
    ds_read_b64_tr_b16 v[160:161], v10 offset:53248
    ds_read_b64_tr_b16 v[162:163], v10 offset:54272
    v_mfma_f32_32x32x16_bf16 v[80:95], v[148:151], v[132:135], v[80:95]
    s_waitcnt lgkmcnt(3)
    v_mfma_f32_32x32x16_bf16 v[32:47], v[156:159], v[136:139], v[32:47]
    ds_read_b128 v[128:131], v12 offset:8192
    ds_read_b64_tr_b16 v[144:145], v8 offset:57344
    s_waitcnt lgkmcnt(4)
    v_mfma_f32_32x32x16_bf16 v[64:79], v[156:159], v[140:143], v[64:79]
    ds_read_b64_tr_b16 v[146:147], v8 offset:58368
    ds_read_b128 v[132:135], v12 offset:9216
    s_waitcnt lgkmcnt(4)
    v_mfma_f32_32x32x16_bf16 v[48:63], v[160:163], v[136:139], v[48:63]
    ds_read_b64_tr_b16 v[148:149], v10 offset:57344
    ds_read_b64_tr_b16 v[150:151], v10 offset:58368
    v_mfma_f32_32x32x16_bf16 v[80:95], v[160:163], v[140:143], v[80:95]
    s_waitcnt lgkmcnt(3)
    v_mfma_f32_32x32x16_bf16 v[32:47], v[144:147], v[128:131], v[32:47]
    ds_read_b128 v[136:139], v12 offset:12288
    ds_read_b64_tr_b16 v[156:157], v8 offset:61440
    s_waitcnt lgkmcnt(4)
    v_mfma_f32_32x32x16_bf16 v[64:79], v[144:147], v[132:135], v[64:79]
    ds_read_b64_tr_b16 v[158:159], v8 offset:62464
    ds_read_b128 v[140:143], v12 offset:13312
    s_waitcnt lgkmcnt(4)
    v_mfma_f32_32x32x16_bf16 v[48:63], v[148:151], v[128:131], v[48:63]
    ds_read_b64_tr_b16 v[160:161], v10 offset:61440
    ds_read_b64_tr_b16 v[162:163], v10 offset:62464
    v_mfma_f32_32x32x16_bf16 v[80:95], v[148:151], v[132:135], v[80:95]
    s_waitcnt lgkmcnt(3)
    v_mfma_f32_32x32x16_bf16 v[32:47], v[156:159], v[136:139], v[32:47]
    s_waitcnt lgkmcnt(2)
    v_mfma_f32_32x32x16_bf16 v[64:79], v[156:159], v[140:143], v[64:79]
    s_waitcnt lgkmcnt(0)
    v_mfma_f32_32x32x16_bf16 v[48:63], v[160:163], v[136:139], v[48:63]
    v_mfma_f32_32x32x16_bf16 v[80:95], v[160:163], v[140:143], v[80:95]
    s_cmp_ge_u32 s23, 5
    s_cselect_b32 s29, 2703360, 0
    s_cselect_b32 s31, 5, 0
    s_add_u32 s29, s29, 2686976
    s_sub_u32 s31, s23, s31
    s_lshl_b32 s31, s31, 12
    s_lshl_b32 s32, s26, 11
    s_add_u32 s29, s29, s31
    s_add_u32 s29, s29, s32
    s_lshl_b32 s32, s22, 3
    s_lshl_b32 s33, s25, 2
    s_add_u32 s32, s32, s33
    s_mul_i32 s32, s32, 20480
    s_add_u32 s29, s29, s32
    s_add_u32 s31, s29, 40960
    v_bfe_u32 v3, v2, 4, 1
    v_mul_u32_u24 v4, 20480, v3
    v_and_b32 v3, 15, v2
    v_lshl_add_u32 v4, v3, 4, v4
    v_lshl_add_u32 v4, v20, 8, v4
    v_cvt_pk_bf16_f32 v168, v32, v33
    v_cvt_pk_bf16_f32 v169, v34, v35
    v_cvt_pk_bf16_f32 v170, v36, v37
    v_cvt_pk_bf16_f32 v171, v38, v39
    s_nop 0
    v_permlane32_swap_b32 v168, v170
    v_permlane32_swap_b32 v169, v171
    buffer_store_dwordx4 v[168:171], v4, s[12:15], s29 offen offset:0 sc1
    v_cvt_pk_bf16_f32 v172, v40, v41
    v_cvt_pk_bf16_f32 v173, v42, v43
    v_cvt_pk_bf16_f32 v174, v44, v45
    v_cvt_pk_bf16_f32 v175, v46, v47
    s_nop 0
    v_permlane32_swap_b32 v172, v174
    v_permlane32_swap_b32 v173, v175
    buffer_store_dwordx4 v[172:175], v4, s[12:15], s29 offen offset:512 sc1
    v_cvt_pk_bf16_f32 v176, v64, v65
    v_cvt_pk_bf16_f32 v177, v66, v67
    v_cvt_pk_bf16_f32 v178, v68, v69
    v_cvt_pk_bf16_f32 v179, v70, v71
    s_nop 0
    v_permlane32_swap_b32 v176, v178
    v_permlane32_swap_b32 v177, v179
    buffer_store_dwordx4 v[176:179], v4, s[12:15], s31 offen offset:0 sc1
    v_cvt_pk_bf16_f32 v180, v72, v73
    v_cvt_pk_bf16_f32 v181, v74, v75
    v_cvt_pk_bf16_f32 v182, v76, v77
    v_cvt_pk_bf16_f32 v183, v78, v79
    s_nop 0
    v_permlane32_swap_b32 v180, v182
    v_permlane32_swap_b32 v181, v183
    buffer_store_dwordx4 v[180:183], v4, s[12:15], s31 offen offset:512 sc1
    v_cvt_pk_bf16_f32 v168, v48, v49
    v_cvt_pk_bf16_f32 v169, v50, v51
    v_cvt_pk_bf16_f32 v170, v52, v53
    v_cvt_pk_bf16_f32 v171, v54, v55
    s_nop 0
    v_permlane32_swap_b32 v168, v170
    v_permlane32_swap_b32 v169, v171
    buffer_store_dwordx4 v[168:171], v4, s[12:15], s29 offen offset:1024 sc1
    v_cvt_pk_bf16_f32 v172, v56, v57
    v_cvt_pk_bf16_f32 v173, v58, v59
    v_cvt_pk_bf16_f32 v174, v60, v61
    v_cvt_pk_bf16_f32 v175, v62, v63
    s_nop 0
    v_permlane32_swap_b32 v172, v174
    v_permlane32_swap_b32 v173, v175
    buffer_store_dwordx4 v[172:175], v4, s[12:15], s29 offen offset:1536 sc1
    v_cvt_pk_bf16_f32 v176, v80, v81
    v_cvt_pk_bf16_f32 v177, v82, v83
    v_cvt_pk_bf16_f32 v178, v84, v85
    v_cvt_pk_bf16_f32 v179, v86, v87
    s_nop 0
    v_permlane32_swap_b32 v176, v178
    v_permlane32_swap_b32 v177, v179
    buffer_store_dwordx4 v[176:179], v4, s[12:15], s31 offen offset:1024 sc1
    v_cvt_pk_bf16_f32 v180, v88, v89
    v_cvt_pk_bf16_f32 v181, v90, v91
    v_cvt_pk_bf16_f32 v182, v92, v93
    v_cvt_pk_bf16_f32 v183, v94, v95
    s_nop 0
    v_permlane32_swap_b32 v180, v182
    v_permlane32_swap_b32 v181, v183
    buffer_store_dwordx4 v[180:183], v4, s[12:15], s31 offen offset:1536 sc1
    s_branch L_p1_done
L_p1_v:
    s_waitcnt lgkmcnt(3)
    v_mfma_f32_32x32x16_bf16 v[32:47], v[128:131], v[144:147], v[32:47]
    ds_read_b128 v[136:139], v12 offset:4096
    ds_read_b64_tr_b16 v[156:157], v8 offset:4096
    s_waitcnt lgkmcnt(4)
    v_mfma_f32_32x32x16_bf16 v[64:79], v[132:135], v[144:147], v[64:79]
    ds_read_b64_tr_b16 v[158:159], v8 offset:5120
    ds_read_b128 v[140:143], v12 offset:5120
    s_waitcnt lgkmcnt(4)
    v_mfma_f32_32x32x16_bf16 v[48:63], v[128:131], v[148:151], v[48:63]
    ds_read_b64_tr_b16 v[160:161], v10 offset:4096
    ds_read_b64_tr_b16 v[162:163], v10 offset:5120
    v_mfma_f32_32x32x16_bf16 v[80:95], v[132:135], v[148:151], v[80:95]
    s_add_u32 m0, s41, 49152
    s_add_u32 s42, s40, 737280
    buffer_load_dwordx4 v13, s[8:11], s42 offen lds
    s_add_u32 m0, s41, 50176
    s_add_u32 s42, s40, 752640
    buffer_load_dwordx4 v13, s[8:11], s42 offen lds
    s_waitcnt lgkmcnt(3)
    v_mfma_f32_32x32x16_bf16 v[32:47], v[136:139], v[156:159], v[32:47]
    ds_read_b128 v[128:131], v12 offset:8192
    ds_read_b64_tr_b16 v[144:145], v8 offset:8192
    s_waitcnt lgkmcnt(4)
    v_mfma_f32_32x32x16_bf16 v[64:79], v[140:143], v[156:159], v[64:79]
    ds_read_b64_tr_b16 v[146:147], v8 offset:9216
    ds_read_b128 v[132:135], v12 offset:9216
    s_waitcnt lgkmcnt(4)
    v_mfma_f32_32x32x16_bf16 v[48:63], v[136:139], v[160:163], v[48:63]
    ds_read_b64_tr_b16 v[148:149], v10 offset:8192
    ds_read_b64_tr_b16 v[150:151], v10 offset:9216
    v_mfma_f32_32x32x16_bf16 v[80:95], v[140:143], v[160:163], v[80:95]
    s_add_u32 m0, s41, 51200
    s_add_u32 s42, s40, 768000
    buffer_load_dwordx4 v13, s[8:11], s42 offen lds
    s_add_u32 m0, s41, 52224
    s_add_u32 s42, s40, 783360
    buffer_load_dwordx4 v13, s[8:11], s42 offen lds
    s_waitcnt lgkmcnt(3)
    v_mfma_f32_32x32x16_bf16 v[32:47], v[128:131], v[144:147], v[32:47]
    ds_read_b128 v[136:139], v12 offset:12288
    ds_read_b64_tr_b16 v[156:157], v8 offset:12288
    s_waitcnt lgkmcnt(4)
    v_mfma_f32_32x32x16_bf16 v[64:79], v[132:135], v[144:147], v[64:79]
    ds_read_b64_tr_b16 v[158:159], v8 offset:13312
    ds_read_b128 v[140:143], v12 offset:13312
    s_waitcnt lgkmcnt(4)
    v_mfma_f32_32x32x16_bf16 v[48:63], v[128:131], v[148:151], v[48:63]
    ds_read_b64_tr_b16 v[160:161], v10 offset:12288
    ds_read_b64_tr_b16 v[162:163], v10 offset:13312
    v_mfma_f32_32x32x16_bf16 v[80:95], v[132:135], v[148:151], v[80:95]
    s_waitcnt vmcnt(8)
    s_waitcnt lgkmcnt(0)
    s_barrier
    v_mfma_f32_32x32x16_bf16 v[32:47], v[136:139], v[156:159], v[32:47]
    ds_read_b128 v[128:131], v12 offset:16384
    ds_read_b64_tr_b16 v[144:145], v8 offset:16384
    v_mfma_f32_32x32x16_bf16 v[64:79], v[140:143], v[156:159], v[64:79]
    ds_read_b64_tr_b16 v[146:147], v8 offset:17408
    ds_read_b128 v[132:135], v12 offset:17408
    v_mfma_f32_32x32x16_bf16 v[48:63], v[136:139], v[160:163], v[48:63]
    ds_read_b64_tr_b16 v[148:149], v10 offset:16384
    ds_read_b64_tr_b16 v[150:151], v10 offset:17408
    v_mfma_f32_32x32x16_bf16 v[80:95], v[140:143], v[160:163], v[80:95]
    s_add_u32 m0, s41, 65536
    s_add_u32 s42, s40, 983040
    buffer_load_dwordx4 v13, s[8:11], s42 offen lds
    s_add_u32 m0, s41, 66560
    s_add_u32 s42, s40, 998400
    buffer_load_dwordx4 v13, s[8:11], s42 offen lds
    s_waitcnt lgkmcnt(3)
    v_mfma_f32_32x32x16_bf16 v[32:47], v[128:131], v[144:147], v[32:47]
    ds_read_b128 v[136:139], v12 offset:20480
    ds_read_b64_tr_b16 v[156:157], v8 offset:20480
    s_waitcnt lgkmcnt(4)
    v_mfma_f32_32x32x16_bf16 v[64:79], v[132:135], v[144:147], v[64:79]
    ds_read_b64_tr_b16 v[158:159], v8 offset:21504
    ds_read_b128 v[140:143], v12 offset:21504
    s_waitcnt lgkmcnt(4)
    v_mfma_f32_32x32x16_bf16 v[48:63], v[128:131], v[148:151], v[48:63]
    ds_read_b64_tr_b16 v[160:161], v10 offset:20480
    ds_read_b64_tr_b16 v[162:163], v10 offset:21504
    v_mfma_f32_32x32x16_bf16 v[80:95], v[132:135], v[148:151], v[80:95]
    s_add_u32 m0, s41, 67584
    s_add_u32 s42, s40, 1013760
    buffer_load_dwordx4 v13, s[8:11], s42 offen lds
    s_add_u32 m0, s41, 68608
    s_add_u32 s42, s40, 1029120
    buffer_load_dwordx4 v13, s[8:11], s42 offen lds
    s_waitcnt lgkmcnt(3)
    v_mfma_f32_32x32x16_bf16 v[32:47], v[136:139], v[156:159], v[32:47]
    ds_read_b128 v[128:131], v12 offset:24576
    ds_read_b64_tr_b16 v[144:145], v8 offset:24576
    s_waitcnt lgkmcnt(4)
    v_mfma_f32_32x32x16_bf16 v[64:79], v[140:143], v[156:159], v[64:79]
    ds_read_b64_tr_b16 v[146:147], v8 offset:25600
    ds_read_b128 v[132:135], v12 offset:25600
    s_waitcnt lgkmcnt(4)
    v_mfma_f32_32x32x16_bf16 v[48:63], v[136:139], v[160:163], v[48:63]
    ds_read_b64_tr_b16 v[148:149], v10 offset:24576
    ds_read_b64_tr_b16 v[150:151], v10 offset:25600
    v_mfma_f32_32x32x16_bf16 v[80:95], v[140:143], v[160:163], v[80:95]
    s_waitcnt lgkmcnt(3)
    v_mfma_f32_32x32x16_bf16 v[32:47], v[128:131], v[144:147], v[32:47]
    ds_read_b128 v[136:139], v12 offset:28672
    ds_read_b64_tr_b16 v[156:157], v8 offset:28672
    s_waitcnt lgkmcnt(4)
    v_mfma_f32_32x32x16_bf16 v[64:79], v[132:135], v[144:147], v[64:79]
    ds_read_b64_tr_b16 v[158:159], v8 offset:29696
    ds_read_b128 v[140:143], v12 offset:29696
    s_waitcnt lgkmcnt(4)
    v_mfma_f32_32x32x16_bf16 v[48:63], v[128:131], v[148:151], v[48:63]
    ds_read_b64_tr_b16 v[160:161], v10 offset:28672
    ds_read_b64_tr_b16 v[162:163], v10 offset:29696
    v_mfma_f32_32x32x16_bf16 v[80:95], v[132:135], v[148:151], v[80:95]
    s_waitcnt vmcnt(8)
    s_waitcnt lgkmcnt(0)
    s_barrier
    v_mfma_f32_32x32x16_bf16 v[32:47], v[136:139], v[156:159], v[32:47]
    ds_read_b128 v[128:131], v12 offset:32768
    ds_read_b64_tr_b16 v[144:145], v8 offset:32768
    v_mfma_f32_32x32x16_bf16 v[64:79], v[140:143], v[156:159], v[64:79]
    ds_read_b64_tr_b16 v[146:147], v8 offset:33792
    ds_read_b128 v[132:135], v12 offset:33792
    v_mfma_f32_32x32x16_bf16 v[48:63], v[136:139], v[160:163], v[48:63]
    ds_read_b64_tr_b16 v[148:149], v10 offset:32768
    ds_read_b64_tr_b16 v[150:151], v10 offset:33792
    v_mfma_f32_32x32x16_bf16 v[80:95], v[140:143], v[160:163], v[80:95]
    s_add_u32 m0, s41, 81920
    s_add_u32 s42, s40, 1228800
    buffer_load_dwordx4 v13, s[8:11], s42 offen lds
    s_add_u32 m0, s41, 82944
    s_add_u32 s42, s40, 1244160
    buffer_load_dwordx4 v13, s[8:11], s42 offen lds
    s_waitcnt lgkmcnt(3)
    v_mfma_f32_32x32x16_bf16 v[32:47], v[128:131], v[144:147], v[32:47]
    ds_read_b128 v[136:139], v12 offset:36864
    ds_read_b64_tr_b16 v[156:157], v8 offset:36864
    s_waitcnt lgkmcnt(4)
    v_mfma_f32_32x32x16_bf16 v[64:79], v[132:135], v[144:147], v[64:79]
    ds_read_b64_tr_b16 v[158:159], v8 offset:37888
    ds_read_b128 v[140:143], v12 offset:37888
    s_waitcnt lgkmcnt(4)
    v_mfma_f32_32x32x16_bf16 v[48:63], v[128:131], v[148:151], v[48:63]
    ds_read_b64_tr_b16 v[160:161], v10 offset:36864
    ds_read_b64_tr_b16 v[162:163], v10 offset:37888
    v_mfma_f32_32x32x16_bf16 v[80:95], v[132:135], v[148:151], v[80:95]
    s_add_u32 m0, s41, 83968
    s_add_u32 s42, s40, 1259520
    buffer_load_dwordx4 v13, s[8:11], s42 offen lds
    s_add_u32 m0, s41, 84992
    s_add_u32 s42, s40, 1274880
    buffer_load_dwordx4 v13, s[8:11], s42 offen lds
    s_waitcnt lgkmcnt(3)
    v_mfma_f32_32x32x16_bf16 v[32:47], v[136:139], v[156:159], v[32:47]
    ds_read_b128 v[128:131], v12 offset:40960
    ds_read_b64_tr_b16 v[144:145], v8 offset:40960
    s_waitcnt lgkmcnt(4)
    v_mfma_f32_32x32x16_bf16 v[64:79], v[140:143], v[156:159], v[64:79]
    ds_read_b64_tr_b16 v[146:147], v8 offset:41984
    ds_read_b128 v[132:135], v12 offset:41984
    s_waitcnt lgkmcnt(4)
    v_mfma_f32_32x32x16_bf16 v[48:63], v[136:139], v[160:163], v[48:63]
    ds_read_b64_tr_b16 v[148:149], v10 offset:40960
    ds_read_b64_tr_b16 v[150:151], v10 offset:41984
    v_mfma_f32_32x32x16_bf16 v[80:95], v[140:143], v[160:163], v[80:95]
    s_waitcnt lgkmcnt(3)
    v_mfma_f32_32x32x16_bf16 v[32:47], v[128:131], v[144:147], v[32:47]
    ds_read_b128 v[136:139], v12 offset:45056
    ds_read_b64_tr_b16 v[156:157], v8 offset:45056
    s_waitcnt lgkmcnt(4)
    v_mfma_f32_32x32x16_bf16 v[64:79], v[132:135], v[144:147], v[64:79]
    ds_read_b64_tr_b16 v[158:159], v8 offset:46080
    ds_read_b128 v[140:143], v12 offset:46080
    s_waitcnt lgkmcnt(4)
    v_mfma_f32_32x32x16_bf16 v[48:63], v[128:131], v[148:151], v[48:63]
    ds_read_b64_tr_b16 v[160:161], v10 offset:45056
    ds_read_b64_tr_b16 v[162:163], v10 offset:46080
    v_mfma_f32_32x32x16_bf16 v[80:95], v[132:135], v[148:151], v[80:95]
    s_waitcnt vmcnt(8)
    s_waitcnt lgkmcnt(0)
    s_barrier
    v_mfma_f32_32x32x16_bf16 v[32:47], v[136:139], v[156:159], v[32:47]
    ds_read_b128 v[128:131], v12 offset:0
    ds_read_b64_tr_b16 v[144:145], v8 offset:49152
    v_mfma_f32_32x32x16_bf16 v[64:79], v[140:143], v[156:159], v[64:79]
    ds_read_b64_tr_b16 v[146:147], v8 offset:50176
    ds_read_b128 v[132:135], v12 offset:1024
    v_mfma_f32_32x32x16_bf16 v[48:63], v[136:139], v[160:163], v[48:63]
    ds_read_b64_tr_b16 v[148:149], v10 offset:49152
    ds_read_b64_tr_b16 v[150:151], v10 offset:50176
    v_mfma_f32_32x32x16_bf16 v[80:95], v[140:143], v[160:163], v[80:95]
    s_add_u32 m0, s41, 0
    s_add_u32 s42, s40, 1474560
    buffer_load_dwordx4 v13, s[8:11], s42 offen lds
    s_add_u32 m0, s41, 1024
    s_add_u32 s42, s40, 1489920
    buffer_load_dwordx4 v13, s[8:11], s42 offen lds
    s_waitcnt lgkmcnt(3)
    v_mfma_f32_32x32x16_bf16 v[32:47], v[128:131], v[144:147], v[32:47]
    ds_read_b128 v[136:139], v12 offset:4096
    ds_read_b64_tr_b16 v[156:157], v8 offset:53248
    s_waitcnt lgkmcnt(4)
    v_mfma_f32_32x32x16_bf16 v[64:79], v[132:135], v[144:147], v[64:79]
    ds_read_b64_tr_b16 v[158:159], v8 offset:54272
    ds_read_b128 v[140:143], v12 offset:5120
    s_waitcnt lgkmcnt(4)
    v_mfma_f32_32x32x16_bf16 v[48:63], v[128:131], v[148:151], v[48:63]
    ds_read_b64_tr_b16 v[160:161], v10 offset:53248
    ds_read_b64_tr_b16 v[162:163], v10 offset:54272
    v_mfma_f32_32x32x16_bf16 v[80:95], v[132:135], v[148:151], v[80:95]
    s_add_u32 m0, s41, 2048
    s_add_u32 s42, s40, 1505280
    buffer_load_dwordx4 v13, s[8:11], s42 offen lds
    s_add_u32 m0, s41, 3072
    s_add_u32 s42, s40, 1520640
    buffer_load_dwordx4 v13, s[8:11], s42 offen lds
    s_waitcnt lgkmcnt(3)
    v_mfma_f32_32x32x16_bf16 v[32:47], v[136:139], v[156:159], v[32:47]
    ds_read_b128 v[128:131], v12 offset:8192
    ds_read_b64_tr_b16 v[144:145], v8 offset:57344
    s_waitcnt lgkmcnt(4)
    v_mfma_f32_32x32x16_bf16 v[64:79], v[140:143], v[156:159], v[64:79]
    ds_read_b64_tr_b16 v[146:147], v8 offset:58368
    ds_read_b128 v[132:135], v12 offset:9216
    s_waitcnt lgkmcnt(4)
    v_mfma_f32_32x32x16_bf16 v[48:63], v[136:139], v[160:163], v[48:63]
    ds_read_b64_tr_b16 v[148:149], v10 offset:57344
    ds_read_b64_tr_b16 v[150:151], v10 offset:58368
    v_mfma_f32_32x32x16_bf16 v[80:95], v[140:143], v[160:163], v[80:95]
    s_waitcnt lgkmcnt(3)
    v_mfma_f32_32x32x16_bf16 v[32:47], v[128:131], v[144:147], v[32:47]
    ds_read_b128 v[136:139], v12 offset:12288
    ds_read_b64_tr_b16 v[156:157], v8 offset:61440
    s_waitcnt lgkmcnt(4)
    v_mfma_f32_32x32x16_bf16 v[64:79], v[132:135], v[144:147], v[64:79]
    ds_read_b64_tr_b16 v[158:159], v8 offset:62464
    ds_read_b128 v[140:143], v12 offset:13312
    s_waitcnt lgkmcnt(4)
    v_mfma_f32_32x32x16_bf16 v[48:63], v[128:131], v[148:151], v[48:63]
    ds_read_b64_tr_b16 v[160:161], v10 offset:61440
    ds_read_b64_tr_b16 v[162:163], v10 offset:62464
    v_mfma_f32_32x32x16_bf16 v[80:95], v[132:135], v[148:151], v[80:95]
    s_waitcnt vmcnt(8)
    s_waitcnt lgkmcnt(0)
    s_barrier
    v_mfma_f32_32x32x16_bf16 v[32:47], v[136:139], v[156:159], v[32:47]
    ds_read_b128 v[128:131], v12 offset:16384
    ds_read_b64_tr_b16 v[144:145], v9 offset:0
    v_mfma_f32_32x32x16_bf16 v[64:79], v[140:143], v[156:159], v[64:79]
    ds_read_b64_tr_b16 v[146:147], v9 offset:1024
    ds_read_b128 v[132:135], v12 offset:17408
    v_mfma_f32_32x32x16_bf16 v[48:63], v[136:139], v[160:163], v[48:63]
    ds_read_b64_tr_b16 v[148:149], v11 offset:0
    ds_read_b64_tr_b16 v[150:151], v11 offset:1024
    v_mfma_f32_32x32x16_bf16 v[80:95], v[140:143], v[160:163], v[80:95]
    s_add_u32 m0, s41, 16384
    s_add_u32 s42, s40, 1720320
    buffer_load_dwordx4 v13, s[8:11], s42 offen lds
    s_add_u32 m0, s41, 17408
    s_add_u32 s42, s40, 1735680
    buffer_load_dwordx4 v13, s[8:11], s42 offen lds
    s_waitcnt lgkmcnt(3)
    v_mfma_f32_32x32x16_bf16 v[32:47], v[128:131], v[144:147], v[32:47]
    ds_read_b128 v[136:139], v12 offset:20480
    ds_read_b64_tr_b16 v[156:157], v9 offset:4096
    s_waitcnt lgkmcnt(4)
    v_mfma_f32_32x32x16_bf16 v[64:79], v[132:135], v[144:147], v[64:79]
    ds_read_b64_tr_b16 v[158:159], v9 offset:5120
    ds_read_b128 v[140:143], v12 offset:21504
    s_waitcnt lgkmcnt(4)
    v_mfma_f32_32x32x16_bf16 v[48:63], v[128:131], v[148:151], v[48:63]
    ds_read_b64_tr_b16 v[160:161], v11 offset:4096
    ds_read_b64_tr_b16 v[162:163], v11 offset:5120
    v_mfma_f32_32x32x16_bf16 v[80:95], v[132:135], v[148:151], v[80:95]
    s_add_u32 m0, s41, 18432
    s_add_u32 s42, s40, 1751040
    buffer_load_dwordx4 v13, s[8:11], s42 offen lds
    s_add_u32 m0, s41, 19456
    s_add_u32 s42, s40, 1766400
    buffer_load_dwordx4 v13, s[8:11], s42 offen lds
    s_waitcnt lgkmcnt(3)
    v_mfma_f32_32x32x16_bf16 v[32:47], v[136:139], v[156:159], v[32:47]
    ds_read_b128 v[128:131], v12 offset:24576
    ds_read_b64_tr_b16 v[144:145], v9 offset:8192
    s_waitcnt lgkmcnt(4)
    v_mfma_f32_32x32x16_bf16 v[64:79], v[140:143], v[156:159], v[64:79]
    ds_read_b64_tr_b16 v[146:147], v9 offset:9216
    ds_read_b128 v[132:135], v12 offset:25600
    s_waitcnt lgkmcnt(4)
    v_mfma_f32_32x32x16_bf16 v[48:63], v[136:139], v[160:163], v[48:63]
    ds_read_b64_tr_b16 v[148:149], v11 offset:8192
    ds_read_b64_tr_b16 v[150:151], v11 offset:9216
    v_mfma_f32_32x32x16_bf16 v[80:95], v[140:143], v[160:163], v[80:95]
    s_waitcnt lgkmcnt(3)
    v_mfma_f32_32x32x16_bf16 v[32:47], v[128:131], v[144:147], v[32:47]
    ds_read_b128 v[136:139], v12 offset:28672
    ds_read_b64_tr_b16 v[156:157], v9 offset:12288
    s_waitcnt lgkmcnt(4)
    v_mfma_f32_32x32x16_bf16 v[64:79], v[132:135], v[144:147], v[64:79]
    ds_read_b64_tr_b16 v[158:159], v9 offset:13312
    ds_read_b128 v[140:143], v12 offset:29696
    s_waitcnt lgkmcnt(4)
    v_mfma_f32_32x32x16_bf16 v[48:63], v[128:131], v[148:151], v[48:63]
    ds_read_b64_tr_b16 v[160:161], v11 offset:12288
    ds_read_b64_tr_b16 v[162:163], v11 offset:13312
    v_mfma_f32_32x32x16_bf16 v[80:95], v[132:135], v[148:151], v[80:95]
    s_waitcnt vmcnt(8)
    s_waitcnt lgkmcnt(0)
    s_barrier
    v_mfma_f32_32x32x16_bf16 v[32:47], v[136:139], v[156:159], v[32:47]
    ds_read_b128 v[128:131], v12 offset:32768
    ds_read_b64_tr_b16 v[144:145], v9 offset:16384
    v_mfma_f32_32x32x16_bf16 v[64:79], v[140:143], v[156:159], v[64:79]
    ds_read_b64_tr_b16 v[146:147], v9 offset:17408
    ds_read_b128 v[132:135], v12 offset:33792
    v_mfma_f32_32x32x16_bf16 v[48:63], v[136:139], v[160:163], v[48:63]
    ds_read_b64_tr_b16 v[148:149], v11 offset:16384
    ds_read_b64_tr_b16 v[150:151], v11 offset:17408
    v_mfma_f32_32x32x16_bf16 v[80:95], v[140:143], v[160:163], v[80:95]
    s_add_u32 m0, s41, 32768
    s_add_u32 s42, s40, 1966080
    buffer_load_dwordx4 v13, s[8:11], s42 offen lds
    s_add_u32 m0, s41, 33792
    s_add_u32 s42, s40, 1981440
    buffer_load_dwordx4 v13, s[8:11], s42 offen lds
    s_waitcnt lgkmcnt(3)
    v_mfma_f32_32x32x16_bf16 v[32:47], v[128:131], v[144:147], v[32:47]
    ds_read_b128 v[136:139], v12 offset:36864
    ds_read_b64_tr_b16 v[156:157], v9 offset:20480
    s_waitcnt lgkmcnt(4)
    v_mfma_f32_32x32x16_bf16 v[64:79], v[132:135], v[144:147], v[64:79]
    ds_read_b64_tr_b16 v[158:159], v9 offset:21504
    ds_read_b128 v[140:143], v12 offset:37888
    s_waitcnt lgkmcnt(4)
    v_mfma_f32_32x32x16_bf16 v[48:63], v[128:131], v[148:151], v[48:63]
    ds_read_b64_tr_b16 v[160:161], v11 offset:20480
    ds_read_b64_tr_b16 v[162:163], v11 offset:21504
    v_mfma_f32_32x32x16_bf16 v[80:95], v[132:135], v[148:151], v[80:95]
    s_add_u32 m0, s41, 34816
    s_add_u32 s42, s40, 1996800
    buffer_load_dwordx4 v13, s[8:11], s42 offen lds
    s_add_u32 m0, s41, 35840
    s_add_u32 s42, s40, 2012160
    buffer_load_dwordx4 v13, s[8:11], s42 offen lds
    s_waitcnt lgkmcnt(3)
    v_mfma_f32_32x32x16_bf16 v[32:47], v[136:139], v[156:159], v[32:47]
    ds_read_b128 v[128:131], v12 offset:40960
    ds_read_b64_tr_b16 v[144:145], v9 offset:24576
    s_waitcnt lgkmcnt(4)
    v_mfma_f32_32x32x16_bf16 v[64:79], v[140:143], v[156:159], v[64:79]
    ds_read_b64_tr_b16 v[146:147], v9 offset:25600
    ds_read_b128 v[132:135], v12 offset:41984
    s_waitcnt lgkmcnt(4)
    v_mfma_f32_32x32x16_bf16 v[48:63], v[136:139], v[160:163], v[48:63]
    ds_read_b64_tr_b16 v[148:149], v11 offset:24576
    ds_read_b64_tr_b16 v[150:151], v11 offset:25600
    v_mfma_f32_32x32x16_bf16 v[80:95], v[140:143], v[160:163], v[80:95]
    s_waitcnt lgkmcnt(3)
    v_mfma_f32_32x32x16_bf16 v[32:47], v[128:131], v[144:147], v[32:47]
    ds_read_b128 v[136:139], v12 offset:45056
    ds_read_b64_tr_b16 v[156:157], v9 offset:28672
    s_waitcnt lgkmcnt(4)
    v_mfma_f32_32x32x16_bf16 v[64:79], v[132:135], v[144:147], v[64:79]
    ds_read_b64_tr_b16 v[158:159], v9 offset:29696
    ds_read_b128 v[140:143], v12 offset:46080
    s_waitcnt lgkmcnt(4)
    v_mfma_f32_32x32x16_bf16 v[48:63], v[128:131], v[148:151], v[48:63]
    ds_read_b64_tr_b16 v[160:161], v11 offset:28672
    ds_read_b64_tr_b16 v[162:163], v11 offset:29696
    v_mfma_f32_32x32x16_bf16 v[80:95], v[132:135], v[148:151], v[80:95]
    s_waitcnt vmcnt(8)
    s_waitcnt lgkmcnt(0)
    s_barrier
    v_mfma_f32_32x32x16_bf16 v[32:47], v[136:139], v[156:159], v[32:47]
    ds_read_b128 v[128:131], v12 offset:0
    ds_read_b64_tr_b16 v[144:145], v8 offset:0
    v_mfma_f32_32x32x16_bf16 v[64:79], v[140:143], v[156:159], v[64:79]
    ds_read_b64_tr_b16 v[146:147], v8 offset:1024
    ds_read_b128 v[132:135], v12 offset:1024
    v_mfma_f32_32x32x16_bf16 v[48:63], v[136:139], v[160:163], v[48:63]
    ds_read_b64_tr_b16 v[148:149], v10 offset:0
    ds_read_b64_tr_b16 v[150:151], v10 offset:1024
    v_mfma_f32_32x32x16_bf16 v[80:95], v[140:143], v[160:163], v[80:95]
    s_add_u32 m0, s41, 49152
    s_add_u32 s42, s40, 2211840
    buffer_load_dwordx4 v13, s[8:11], s42 offen lds
    s_add_u32 m0, s41, 50176
    s_add_u32 s42, s40, 2227200
    buffer_load_dwordx4 v13, s[8:11], s42 offen lds
    s_waitcnt lgkmcnt(3)
    v_mfma_f32_32x32x16_bf16 v[32:47], v[128:131], v[144:147], v[32:47]
    ds_read_b128 v[136:139], v12 offset:4096
    ds_read_b64_tr_b16 v[156:157], v8 offset:4096
    s_waitcnt lgkmcnt(4)
    v_mfma_f32_32x32x16_bf16 v[64:79], v[132:135], v[144:147], v[64:79]
    ds_read_b64_tr_b16 v[158:159], v8 offset:5120
    ds_read_b128 v[140:143], v12 offset:5120
    s_waitcnt lgkmcnt(4)
    v_mfma_f32_32x32x16_bf16 v[48:63], v[128:131], v[148:151], v[48:63]
    ds_read_b64_tr_b16 v[160:161], v10 offset:4096
    ds_read_b64_tr_b16 v[162:163], v10 offset:5120
    v_mfma_f32_32x32x16_bf16 v[80:95], v[132:135], v[148:151], v[80:95]
    s_add_u32 m0, s41, 51200
    s_add_u32 s42, s40, 2242560
    buffer_load_dwordx4 v13, s[8:11], s42 offen lds
    s_add_u32 m0, s41, 52224
    s_add_u32 s42, s40, 2257920
    buffer_load_dwordx4 v13, s[8:11], s42 offen lds
    s_waitcnt lgkmcnt(3)
    v_mfma_f32_32x32x16_bf16 v[32:47], v[136:139], v[156:159], v[32:47]
    ds_read_b128 v[128:131], v12 offset:8192
    ds_read_b64_tr_b16 v[144:145], v8 offset:8192
    s_waitcnt lgkmcnt(4)
    v_mfma_f32_32x32x16_bf16 v[64:79], v[140:143], v[156:159], v[64:79]
    ds_read_b64_tr_b16 v[146:147], v8 offset:9216
    ds_read_b128 v[132:135], v12 offset:9216
    s_waitcnt lgkmcnt(4)
    v_mfma_f32_32x32x16_bf16 v[48:63], v[136:139], v[160:163], v[48:63]
    ds_read_b64_tr_b16 v[148:149], v10 offset:8192
    ds_read_b64_tr_b16 v[150:151], v10 offset:9216
    v_mfma_f32_32x32x16_bf16 v[80:95], v[140:143], v[160:163], v[80:95]
    s_waitcnt lgkmcnt(3)
    v_mfma_f32_32x32x16_bf16 v[32:47], v[128:131], v[144:147], v[32:47]
    ds_read_b128 v[136:139], v12 offset:12288
    ds_read_b64_tr_b16 v[156:157], v8 offset:12288
    s_waitcnt lgkmcnt(4)
    v_mfma_f32_32x32x16_bf16 v[64:79], v[132:135], v[144:147], v[64:79]
    ds_read_b64_tr_b16 v[158:159], v8 offset:13312
    ds_read_b128 v[140:143], v12 offset:13312
    s_waitcnt lgkmcnt(4)
    v_mfma_f32_32x32x16_bf16 v[48:63], v[128:131], v[148:151], v[48:63]
    ds_read_b64_tr_b16 v[160:161], v10 offset:12288
    ds_read_b64_tr_b16 v[162:163], v10 offset:13312
    v_mfma_f32_32x32x16_bf16 v[80:95], v[132:135], v[148:151], v[80:95]
    s_waitcnt vmcnt(8)
    s_waitcnt lgkmcnt(0)
    s_barrier
    v_mfma_f32_32x32x16_bf16 v[32:47], v[136:139], v[156:159], v[32:47]
    ds_read_b128 v[128:131], v12 offset:16384
    ds_read_b64_tr_b16 v[144:145], v8 offset:16384
    v_mfma_f32_32x32x16_bf16 v[64:79], v[140:143], v[156:159], v[64:79]
    ds_read_b64_tr_b16 v[146:147], v8 offset:17408
    ds_read_b128 v[132:135], v12 offset:17408
    v_mfma_f32_32x32x16_bf16 v[48:63], v[136:139], v[160:163], v[48:63]
    ds_read_b64_tr_b16 v[148:149], v10 offset:16384
    ds_read_b64_tr_b16 v[150:151], v10 offset:17408
    v_mfma_f32_32x32x16_bf16 v[80:95], v[140:143], v[160:163], v[80:95]
    s_waitcnt lgkmcnt(3)
    v_mfma_f32_32x32x16_bf16 v[32:47], v[128:131], v[144:147], v[32:47]
    ds_read_b128 v[136:139], v12 offset:20480
    ds_read_b64_tr_b16 v[156:157], v8 offset:20480
    s_waitcnt lgkmcnt(4)
    v_mfma_f32_32x32x16_bf16 v[64:79], v[132:135], v[144:147], v[64:79]
    ds_read_b64_tr_b16 v[158:159], v8 offset:21504
    ds_read_b128 v[140:143], v12 offset:21504
    s_waitcnt lgkmcnt(4)
    v_mfma_f32_32x32x16_bf16 v[48:63], v[128:131], v[148:151], v[48:63]
    ds_read_b64_tr_b16 v[160:161], v10 offset:20480
    ds_read_b64_tr_b16 v[162:163], v10 offset:21504
    v_mfma_f32_32x32x16_bf16 v[80:95], v[132:135], v[148:151], v[80:95]
    s_waitcnt lgkmcnt(3)
    v_mfma_f32_32x32x16_bf16 v[32:47], v[136:139], v[156:159], v[32:47]
    ds_read_b128 v[128:131], v12 offset:24576
    ds_read_b64_tr_b16 v[144:145], v8 offset:24576
    s_waitcnt lgkmcnt(4)
    v_mfma_f32_32x32x16_bf16 v[64:79], v[140:143], v[156:159], v[64:79]
    ds_read_b64_tr_b16 v[146:147], v8 offset:25600
    ds_read_b128 v[132:135], v12 offset:25600
    s_waitcnt lgkmcnt(4)
    v_mfma_f32_32x32x16_bf16 v[48:63], v[136:139], v[160:163], v[48:63]
    ds_read_b64_tr_b16 v[148:149], v10 offset:24576
    ds_read_b64_tr_b16 v[150:151], v10 offset:25600
    v_mfma_f32_32x32x16_bf16 v[80:95], v[140:143], v[160:163], v[80:95]
    s_waitcnt lgkmcnt(3)
    v_mfma_f32_32x32x16_bf16 v[32:47], v[128:131], v[144:147], v[32:47]
    ds_read_b128 v[136:139], v12 offset:28672
    ds_read_b64_tr_b16 v[156:157], v8 offset:28672
    s_waitcnt lgkmcnt(4)
    v_mfma_f32_32x32x16_bf16 v[64:79], v[132:135], v[144:147], v[64:79]
    ds_read_b64_tr_b16 v[158:159], v8 offset:29696
    ds_read_b128 v[140:143], v12 offset:29696
    s_waitcnt lgkmcnt(4)
    v_mfma_f32_32x32x16_bf16 v[48:63], v[128:131], v[148:151], v[48:63]
    ds_read_b64_tr_b16 v[160:161], v10 offset:28672
    ds_read_b64_tr_b16 v[162:163], v10 offset:29696
    v_mfma_f32_32x32x16_bf16 v[80:95], v[132:135], v[148:151], v[80:95]
    s_waitcnt vmcnt(4)
    s_waitcnt lgkmcnt(0)
    s_barrier
    v_mfma_f32_32x32x16_bf16 v[32:47], v[136:139], v[156:159], v[32:47]
    ds_read_b128 v[128:131], v12 offset:32768
    ds_read_b64_tr_b16 v[144:145], v8 offset:32768
    v_mfma_f32_32x32x16_bf16 v[64:79], v[140:143], v[156:159], v[64:79]
    ds_read_b64_tr_b16 v[146:147], v8 offset:33792
    ds_read_b128 v[132:135], v12 offset:33792
    v_mfma_f32_32x32x16_bf16 v[48:63], v[136:139], v[160:163], v[48:63]
    ds_read_b64_tr_b16 v[148:149], v10 offset:32768
    ds_read_b64_tr_b16 v[150:151], v10 offset:33792
    v_mfma_f32_32x32x16_bf16 v[80:95], v[140:143], v[160:163], v[80:95]
    s_waitcnt lgkmcnt(3)
    v_mfma_f32_32x32x16_bf16 v[32:47], v[128:131], v[144:147], v[32:47]
    ds_read_b128 v[136:139], v12 offset:36864
    ds_read_b64_tr_b16 v[156:157], v8 offset:36864
    s_waitcnt lgkmcnt(4)
    v_mfma_f32_32x32x16_bf16 v[64:79], v[132:135], v[144:147], v[64:79]
    ds_read_b64_tr_b16 v[158:159], v8 offset:37888
    ds_read_b128 v[140:143], v12 offset:37888
    s_waitcnt lgkmcnt(4)
    v_mfma_f32_32x32x16_bf16 v[48:63], v[128:131], v[148:151], v[48:63]
    ds_read_b64_tr_b16 v[160:161], v10 offset:36864
    ds_read_b64_tr_b16 v[162:163], v10 offset:37888
    v_mfma_f32_32x32x16_bf16 v[80:95], v[132:135], v[148:151], v[80:95]
    s_waitcnt lgkmcnt(3)
    v_mfma_f32_32x32x16_bf16 v[32:47], v[136:139], v[156:159], v[32:47]
    ds_read_b128 v[128:131], v12 offset:40960
    ds_read_b64_tr_b16 v[144:145], v8 offset:40960
    s_waitcnt lgkmcnt(4)
    v_mfma_f32_32x32x16_bf16 v[64:79], v[140:143], v[156:159], v[64:79]
    ds_read_b64_tr_b16 v[146:147], v8 offset:41984
    ds_read_b128 v[132:135], v12 offset:41984
    s_waitcnt lgkmcnt(4)
    v_mfma_f32_32x32x16_bf16 v[48:63], v[136:139], v[160:163], v[48:63]
    ds_read_b64_tr_b16 v[148:149], v10 offset:40960
    ds_read_b64_tr_b16 v[150:151], v10 offset:41984
    v_mfma_f32_32x32x16_bf16 v[80:95], v[140:143], v[160:163], v[80:95]
    s_waitcnt lgkmcnt(3)
    v_mfma_f32_32x32x16_bf16 v[32:47], v[128:131], v[144:147], v[32:47]
    ds_read_b128 v[136:139], v12 offset:45056
    ds_read_b64_tr_b16 v[156:157], v8 offset:45056
    s_waitcnt lgkmcnt(4)
    v_mfma_f32_32x32x16_bf16 v[64:79], v[132:135], v[144:147], v[64:79]
    ds_read_b64_tr_b16 v[158:159], v8 offset:46080
    ds_read_b128 v[140:143], v12 offset:46080
    s_waitcnt lgkmcnt(4)
    v_mfma_f32_32x32x16_bf16 v[48:63], v[128:131], v[148:151], v[48:63]
    ds_read_b64_tr_b16 v[160:161], v10 offset:45056
    ds_read_b64_tr_b16 v[162:163], v10 offset:46080
    v_mfma_f32_32x32x16_bf16 v[80:95], v[132:135], v[148:151], v[80:95]
    s_waitcnt vmcnt(0)
    s_waitcnt lgkmcnt(0)
    s_barrier
    v_mfma_f32_32x32x16_bf16 v[32:47], v[136:139], v[156:159], v[32:47]
    ds_read_b128 v[128:131], v12 offset:0
    ds_read_b64_tr_b16 v[144:145], v8 offset:49152
    v_mfma_f32_32x32x16_bf16 v[64:79], v[140:143], v[156:159], v[64:79]
    ds_read_b64_tr_b16 v[146:147], v8 offset:50176
    ds_read_b128 v[132:135], v12 offset:1024
    v_mfma_f32_32x32x16_bf16 v[48:63], v[136:139], v[160:163], v[48:63]
    ds_read_b64_tr_b16 v[148:149], v10 offset:49152
    ds_read_b64_tr_b16 v[150:151], v10 offset:50176
    v_mfma_f32_32x32x16_bf16 v[80:95], v[140:143], v[160:163], v[80:95]
    s_waitcnt lgkmcnt(3)
    v_mfma_f32_32x32x16_bf16 v[32:47], v[128:131], v[144:147], v[32:47]
    ds_read_b128 v[136:139], v12 offset:4096
    ds_read_b64_tr_b16 v[156:157], v8 offset:53248
    s_waitcnt lgkmcnt(4)
    v_mfma_f32_32x32x16_bf16 v[64:79], v[132:135], v[144:147], v[64:79]
    ds_read_b64_tr_b16 v[158:159], v8 offset:54272
    ds_read_b128 v[140:143], v12 offset:5120
    s_waitcnt lgkmcnt(4)
    v_mfma_f32_32x32x16_bf16 v[48:63], v[128:131], v[148:151], v[48:63]
    ds_read_b64_tr_b16 v[160:161], v10 offset:53248
    ds_read_b64_tr_b16 v[162:163], v10 offset:54272
    v_mfma_f32_32x32x16_bf16 v[80:95], v[132:135], v[148:151], v[80:95]
    s_waitcnt lgkmcnt(3)
    v_mfma_f32_32x32x16_bf16 v[32:47], v[136:139], v[156:159], v[32:47]
    ds_read_b128 v[128:131], v12 offset:8192
    ds_read_b64_tr_b16 v[144:145], v8 offset:57344
    s_waitcnt lgkmcnt(4)
    v_mfma_f32_32x32x16_bf16 v[64:79], v[140:143], v[156:159], v[64:79]
    ds_read_b64_tr_b16 v[146:147], v8 offset:58368
    ds_read_b128 v[132:135], v12 offset:9216
    s_waitcnt lgkmcnt(4)
    v_mfma_f32_32x32x16_bf16 v[48:63], v[136:139], v[160:163], v[48:63]
    ds_read_b64_tr_b16 v[148:149], v10 offset:57344
    ds_read_b64_tr_b16 v[150:151], v10 offset:58368
    v_mfma_f32_32x32x16_bf16 v[80:95], v[140:143], v[160:163], v[80:95]
    s_waitcnt lgkmcnt(3)
    v_mfma_f32_32x32x16_bf16 v[32:47], v[128:131], v[144:147], v[32:47]
    ds_read_b128 v[136:139], v12 offset:12288
    ds_read_b64_tr_b16 v[156:157], v8 offset:61440
    s_waitcnt lgkmcnt(4)
    v_mfma_f32_32x32x16_bf16 v[64:79], v[132:135], v[144:147], v[64:79]
    ds_read_b64_tr_b16 v[158:159], v8 offset:62464
    ds_read_b128 v[140:143], v12 offset:13312
    s_waitcnt lgkmcnt(4)
    v_mfma_f32_32x32x16_bf16 v[48:63], v[128:131], v[148:151], v[48:63]
    ds_read_b64_tr_b16 v[160:161], v10 offset:61440
    ds_read_b64_tr_b16 v[162:163], v10 offset:62464
    v_mfma_f32_32x32x16_bf16 v[80:95], v[132:135], v[148:151], v[80:95]
    s_waitcnt lgkmcnt(3)
    v_mfma_f32_32x32x16_bf16 v[32:47], v[136:139], v[156:159], v[32:47]
    s_waitcnt lgkmcnt(2)
    v_mfma_f32_32x32x16_bf16 v[64:79], v[140:143], v[156:159], v[64:79]
    s_waitcnt lgkmcnt(0)
    v_mfma_f32_32x32x16_bf16 v[48:63], v[136:139], v[160:163], v[48:63]
    v_mfma_f32_32x32x16_bf16 v[80:95], v[140:143], v[160:163], v[80:95]
    s_sub_u32 s31, s23, 10
    s_lshl_b32 s31, s31, 7
    s_lshl_b32 s32, s26, 6
    s_add_u32 s31, s31, s32
    s_lshl_b32 s32, s22, 2
    s_lshl_b32 s33, s25, 1
    s_add_u32 s32, s32, s33
    s_mul_i32 s32, s32, 1280
    s_add_u32 s29, s32, 8028160
    v_and_b32 v3, 31, v2
    v_add_u32 v5, s31, v3
    s_mov_b32 s33, 81920
    v_add_u32 v6, 0, v5
    v_mul_u32_u24 v7, 0xcccd, v6
    v_lshrrev_b32 v7, 20, v7
    v_mul_u32_u24 v8, 20, v7
    v_sub_u32 v8, v6, v8
    v_mul_lo_u32 v7, v7, s33
    v_lshl_add_u32 v7, v8, 4, v7
    v_cmp_gt_u32 vcc, 16, v8
    v_lshlrev_b32 v9, 8, v20
    v_lshlrev_b32 v10, 6, v20
    v_add_u32 v10, 768, v10
    v_cndmask_b32 v9, v10, v9, vcc
    v_add_u32 v7, v7, v9
    v_mov_b32 v9, 128
    v_mov_b32 v10, 512
    v_cndmask_b32 v9, v9, v10, vcc
    v_add_u32 v9, v7, v9
    v_cvt_pk_bf16_f32 v168, v32, v33
    v_cvt_pk_bf16_f32 v169, v34, v35
    v_cvt_pk_bf16_f32 v170, v40, v41
    v_cvt_pk_bf16_f32 v171, v42, v43
    buffer_store_dwordx4 v[168:171], v7, s[12:15], s29 offen offset:0 sc1
    v_cvt_pk_bf16_f32 v172, v36, v37
    v_cvt_pk_bf16_f32 v173, v38, v39
    v_cvt_pk_bf16_f32 v174, v44, v45
    v_cvt_pk_bf16_f32 v175, v46, v47
    buffer_store_dwordx4 v[172:175], v9, s[12:15], s29 offen offset:0 sc1
    v_cvt_pk_bf16_f32 v176, v64, v65
    v_cvt_pk_bf16_f32 v177, v66, v67
    v_cvt_pk_bf16_f32 v178, v72, v73
    v_cvt_pk_bf16_f32 v179, v74, v75
    buffer_store_dwordx4 v[176:179], v7, s[12:15], s29 offen offset:1280 sc1
    v_cvt_pk_bf16_f32 v180, v68, v69
    v_cvt_pk_bf16_f32 v181, v70, v71
    v_cvt_pk_bf16_f32 v182, v76, v77
    v_cvt_pk_bf16_f32 v183, v78, v79
    buffer_store_dwordx4 v[180:183], v9, s[12:15], s29 offen offset:1280 sc1
    v_add_u32 v6, 32, v5
    v_mul_u32_u24 v7, 0xcccd, v6
    v_lshrrev_b32 v7, 20, v7
    v_mul_u32_u24 v8, 20, v7
    v_sub_u32 v8, v6, v8
    v_mul_lo_u32 v7, v7, s33
    v_lshl_add_u32 v7, v8, 4, v7
    v_cmp_gt_u32 vcc, 16, v8
    v_lshlrev_b32 v9, 8, v20
    v_lshlrev_b32 v10, 6, v20
    v_add_u32 v10, 768, v10
    v_cndmask_b32 v9, v10, v9, vcc
    v_add_u32 v7, v7, v9
    v_mov_b32 v9, 128
    v_mov_b32 v10, 512
    v_cndmask_b32 v9, v9, v10, vcc
    v_add_u32 v9, v7, v9
    v_cvt_pk_bf16_f32 v168, v48, v49
    v_cvt_pk_bf16_f32 v169, v50, v51
    v_cvt_pk_bf16_f32 v170, v56, v57
    v_cvt_pk_bf16_f32 v171, v58, v59
    buffer_store_dwordx4 v[168:171], v7, s[12:15], s29 offen offset:0 sc1
    v_cvt_pk_bf16_f32 v172, v52, v53
    v_cvt_pk_bf16_f32 v173, v54, v55
    v_cvt_pk_bf16_f32 v174, v60, v61
    v_cvt_pk_bf16_f32 v175, v62, v63
    buffer_store_dwordx4 v[172:175], v9, s[12:15], s29 offen offset:0 sc1
    v_cvt_pk_bf16_f32 v176, v80, v81
    v_cvt_pk_bf16_f32 v177, v82, v83
    v_cvt_pk_bf16_f32 v178, v88, v89
    v_cvt_pk_bf16_f32 v179, v90, v91
    buffer_store_dwordx4 v[176:179], v7, s[12:15], s29 offen offset:1280 sc1
    v_cvt_pk_bf16_f32 v180, v84, v85
    v_cvt_pk_bf16_f32 v181, v86, v87
    v_cvt_pk_bf16_f32 v182, v92, v93
    v_cvt_pk_bf16_f32 v183, v94, v95
    buffer_store_dwordx4 v[180:183], v9, s[12:15], s29 offen offset:1280 sc1
    s_branch L_p1_done
L_p1_prod:
    s_cmp_ge_u32 s3, 6
    s_cbranch_scc1 L_p0_gemv
    s_mov_b32 s16, s86
    s_and_b32 s17, s87, 0xffff
    s_mov_b32 s18, 2621440
    s_mov_b32 s19, 0x00020000
    s_lshl_b32 s36, s2, 3
    s_and_b32 s37, s3, 1
    s_lshl_b32 s37, s37, 2
    s_add_u32 s36, s36, s37
    v_lshrrev_b32 v1, 4, v2
    v_add_u32 v1, s36, v1
    v_and_b32 v3, 15, v2
    v_mul_u32_u24 v4, 1280, v1
    v_lshl_add_u32 v4, v3, 4, v4
    buffer_load_dwordx4 v[8:11], v4, s[16:19], 0 offen offset:0
    buffer_load_dwordx4 v[12:15], v4, s[16:19], 0 offen offset:256
    buffer_load_dwordx4 v[16:19], v4, s[16:19], 0 offen offset:512
    buffer_load_dwordx4 v[20:23], v4, s[16:19], 0 offen offset:768
    buffer_load_dwordx4 v[24:27], v4, s[16:19], 0 offen offset:1024
    v_mov_b32 v250, 0
    global_load_dword v252, v250, s[80:81] sc1
    s_mov_b32 s82, 0x200000
    v_mov_b32 v250, 0
L_tg_ln:
    s_waitcnt vmcnt(0)
    v_readfirstlane_b32 s83, v252
    s_nop 3
    s_cmp_lg_u32 s83, 0
    s_cbranch_scc1 L_tgd_ln
    global_load_dword v252, v250, s[80:81] sc1
    s_sub_u32 s82, s82, 1
    s_cmp_lg_u32 s82, 0
    s_cbranch_scc1 L_tg_ln
L_tgd_ln:
    v_lshlrev_b32 v32, 16, v8
    v_and_b32 v33, 0xffff0000, v8
    v_lshlrev_b32 v34, 16, v9
    v_and_b32 v35, 0xffff0000, v9
    v_lshlrev_b32 v36, 16, v10
    v_and_b32 v37, 0xffff0000, v10
    v_lshlrev_b32 v38, 16, v11
    v_and_b32 v39, 0xffff0000, v11
    v_lshlrev_b32 v40, 16, v12
    v_and_b32 v41, 0xffff0000, v12
    v_lshlrev_b32 v42, 16, v13
    v_and_b32 v43, 0xffff0000, v13
    v_lshlrev_b32 v44, 16, v14
    v_and_b32 v45, 0xffff0000, v14
    v_lshlrev_b32 v46, 16, v15
    v_and_b32 v47, 0xffff0000, v15
    v_lshlrev_b32 v48, 16, v16
    v_and_b32 v49, 0xffff0000, v16
    v_lshlrev_b32 v50, 16, v17
    v_and_b32 v51, 0xffff0000, v17
    v_lshlrev_b32 v52, 16, v18
    v_and_b32 v53, 0xffff0000, v18
    v_lshlrev_b32 v54, 16, v19
    v_and_b32 v55, 0xffff0000, v19
    v_lshlrev_b32 v56, 16, v20
    v_and_b32 v57, 0xffff0000, v20
    v_lshlrev_b32 v58, 16, v21
    v_and_b32 v59, 0xffff0000, v21
    v_lshlrev_b32 v60, 16, v22
    v_and_b32 v61, 0xffff0000, v22
    v_lshlrev_b32 v62, 16, v23
    v_and_b32 v63, 0xffff0000, v23
    v_lshlrev_b32 v64, 16, v24
    v_and_b32 v65, 0xffff0000, v24
    v_lshlrev_b32 v66, 16, v25
    v_and_b32 v67, 0xffff0000, v25
    v_lshlrev_b32 v68, 16, v26
    v_and_b32 v69, 0xffff0000, v26
    v_lshlrev_b32 v70, 16, v27
    v_and_b32 v71, 0xffff0000, v27
    v_add_f32 v4, v32, v33
    v_add_f32 v5, v34, v35
    v_add_f32 v4, v4, v36
    v_add_f32 v5, v5, v37
    v_add_f32 v4, v4, v38
    v_add_f32 v5, v5, v39
    v_add_f32 v4, v4, v40
    v_add_f32 v5, v5, v41
    v_add_f32 v4, v4, v42
    v_add_f32 v5, v5, v43
    v_add_f32 v4, v4, v44
    v_add_f32 v5, v5, v45
    v_add_f32 v4, v4, v46
    v_add_f32 v5, v5, v47
    v_add_f32 v4, v4, v48
    v_add_f32 v5, v5, v49
    v_add_f32 v4, v4, v50
    v_add_f32 v5, v5, v51
    v_add_f32 v4, v4, v52
    v_add_f32 v5, v5, v53
    v_add_f32 v4, v4, v54
    v_add_f32 v5, v5, v55
    v_add_f32 v4, v4, v56
    v_add_f32 v5, v5, v57
    v_add_f32 v4, v4, v58
    v_add_f32 v5, v5, v59
    v_add_f32 v4, v4, v60
    v_add_f32 v5, v5, v61
    v_add_f32 v4, v4, v62
    v_add_f32 v5, v5, v63
    v_add_f32 v4, v4, v64
    v_add_f32 v5, v5, v65
    v_add_f32 v4, v4, v66
    v_add_f32 v5, v5, v67
    v_add_f32 v4, v4, v68
    v_add_f32 v5, v5, v69
    v_add_f32 v4, v4, v70
    v_add_f32 v5, v5, v71
    v_add_f32 v4, v4, v5
    s_nop 1
    v_add_f32_dpp v4, v4, v4 row_ror:8 row_mask:0xf bank_mask:0xf
    s_nop 1
    v_add_f32_dpp v4, v4, v4 row_ror:4 row_mask:0xf bank_mask:0xf
    s_nop 1
    v_add_f32_dpp v4, v4, v4 row_ror:2 row_mask:0xf bank_mask:0xf
    s_nop 1
    v_add_f32_dpp v4, v4, v4 row_ror:1 row_mask:0xf bank_mask:0xf
    v_mul_f32 v4, 0x3acccccd, v4
    v_mov_b32 v5, 0
    v_mov_b32 v28, 0
    v_sub_f32 v6, v32, v4
    v_sub_f32 v7, v33, v4
    v_fmac_f32 v5, v6, v6
    v_fmac_f32 v28, v7, v7
    v_sub_f32 v6, v34, v4
    v_sub_f32 v7, v35, v4
    v_fmac_f32 v5, v6, v6
    v_fmac_f32 v28, v7, v7
    v_sub_f32 v6, v36, v4
    v_sub_f32 v7, v37, v4
    v_fmac_f32 v5, v6, v6
    v_fmac_f32 v28, v7, v7
    v_sub_f32 v6, v38, v4
    v_sub_f32 v7, v39, v4
    v_fmac_f32 v5, v6, v6
    v_fmac_f32 v28, v7, v7
    v_sub_f32 v6, v40, v4
    v_sub_f32 v7, v41, v4
    v_fmac_f32 v5, v6, v6
    v_fmac_f32 v28, v7, v7
    v_sub_f32 v6, v42, v4
    v_sub_f32 v7, v43, v4
    v_fmac_f32 v5, v6, v6
    v_fmac_f32 v28, v7, v7
    v_sub_f32 v6, v44, v4
    v_sub_f32 v7, v45, v4
    v_fmac_f32 v5, v6, v6
    v_fmac_f32 v28, v7, v7
    v_sub_f32 v6, v46, v4
    v_sub_f32 v7, v47, v4
    v_fmac_f32 v5, v6, v6
    v_fmac_f32 v28, v7, v7
    v_sub_f32 v6, v48, v4
    v_sub_f32 v7, v49, v4
    v_fmac_f32 v5, v6, v6
    v_fmac_f32 v28, v7, v7
    v_sub_f32 v6, v50, v4
    v_sub_f32 v7, v51, v4
    v_fmac_f32 v5, v6, v6
    v_fmac_f32 v28, v7, v7
    v_sub_f32 v6, v52, v4
    v_sub_f32 v7, v53, v4
    v_fmac_f32 v5, v6, v6
    v_fmac_f32 v28, v7, v7
    v_sub_f32 v6, v54, v4
    v_sub_f32 v7, v55, v4
    v_fmac_f32 v5, v6, v6
    v_fmac_f32 v28, v7, v7
    v_sub_f32 v6, v56, v4
    v_sub_f32 v7, v57, v4
    v_fmac_f32 v5, v6, v6
    v_fmac_f32 v28, v7, v7
    v_sub_f32 v6, v58, v4
    v_sub_f32 v7, v59, v4
    v_fmac_f32 v5, v6, v6
    v_fmac_f32 v28, v7, v7
    v_sub_f32 v6, v60, v4
    v_sub_f32 v7, v61, v4
    v_fmac_f32 v5, v6, v6
    v_fmac_f32 v28, v7, v7
    v_sub_f32 v6, v62, v4
    v_sub_f32 v7, v63, v4
    v_fmac_f32 v5, v6, v6
    v_fmac_f32 v28, v7, v7
    v_sub_f32 v6, v64, v4
    v_sub_f32 v7, v65, v4
    v_fmac_f32 v5, v6, v6
    v_fmac_f32 v28, v7, v7
    v_sub_f32 v6, v66, v4
    v_sub_f32 v7, v67, v4
    v_fmac_f32 v5, v6, v6
    v_fmac_f32 v28, v7, v7
    v_sub_f32 v6, v68, v4
    v_sub_f32 v7, v69, v4
    v_fmac_f32 v5, v6, v6
    v_fmac_f32 v28, v7, v7
    v_sub_f32 v6, v70, v4
    v_sub_f32 v7, v71, v4
    v_fmac_f32 v5, v6, v6
    v_fmac_f32 v28, v7, v7
    v_add_f32 v5, v5, v28
    s_nop 1
    v_add_f32_dpp v5, v5, v5 row_ror:8 row_mask:0xf bank_mask:0xf
    s_nop 1
    v_add_f32_dpp v5, v5, v5 row_ror:4 row_mask:0xf bank_mask:0xf
    s_nop 1
    v_add_f32_dpp v5, v5, v5 row_ror:2 row_mask:0xf bank_mask:0xf
    s_nop 1
    v_add_f32_dpp v5, v5, v5 row_ror:1 row_mask:0xf bank_mask:0xf
    v_mul_f32 v5, 0x3acccccd, v5
    v_cvt_pk_bf16_f32 v4, v4, v4
    v_and_b32 v4, 0xffff0000, v4
    v_cvt_pk_bf16_f32 v5, v5, v5
    v_and_b32 v5, 0xffff0000, v5
    v_add_f32 v5, 0x3727c5ac, v5
    v_cvt_pk_bf16_f32 v5, v5, v5
    v_and_b32 v5, 0xffff0000, v5
    v_sqrt_f32 v5, v5
    s_nop 0
    v_cvt_pk_bf16_f32 v5, v5, v5
    v_and_b32 v5, 0xffff0000, v5
    v_rcp_f32 v5, v5
    v_sub_f32 v32, v32, v4
    v_sub_f32 v33, v33, v4
    v_sub_f32 v34, v34, v4
    v_sub_f32 v35, v35, v4
    v_sub_f32 v36, v36, v4
    v_sub_f32 v37, v37, v4
    v_sub_f32 v38, v38, v4
    v_sub_f32 v39, v39, v4
    v_sub_f32 v40, v40, v4
    v_sub_f32 v41, v41, v4
    v_sub_f32 v42, v42, v4
    v_sub_f32 v43, v43, v4
    v_sub_f32 v44, v44, v4
    v_sub_f32 v45, v45, v4
    v_sub_f32 v46, v46, v4
    v_sub_f32 v47, v47, v4
    v_sub_f32 v48, v48, v4
    v_sub_f32 v49, v49, v4
    v_sub_f32 v50, v50, v4
    v_sub_f32 v51, v51, v4
    v_sub_f32 v52, v52, v4
    v_sub_f32 v53, v53, v4
    v_sub_f32 v54, v54, v4
    v_sub_f32 v55, v55, v4
    v_sub_f32 v56, v56, v4
    v_sub_f32 v57, v57, v4
    v_sub_f32 v58, v58, v4
    v_sub_f32 v59, v59, v4
    v_sub_f32 v60, v60, v4
    v_sub_f32 v61, v61, v4
    v_sub_f32 v62, v62, v4
    v_sub_f32 v63, v63, v4
    v_sub_f32 v64, v64, v4
    v_sub_f32 v65, v65, v4
    v_sub_f32 v66, v66, v4
    v_sub_f32 v67, v67, v4
    v_sub_f32 v68, v68, v4
    v_sub_f32 v69, v69, v4
    v_sub_f32 v70, v70, v4
    v_sub_f32 v71, v71, v4
    v_cvt_pk_bf16_f32 v8, v32, v33
    v_cvt_pk_bf16_f32 v9, v34, v35
    v_cvt_pk_bf16_f32 v10, v36, v37
    v_cvt_pk_bf16_f32 v11, v38, v39
    v_cvt_pk_bf16_f32 v12, v40, v41
    v_cvt_pk_bf16_f32 v13, v42, v43
    v_cvt_pk_bf16_f32 v14, v44, v45
    v_cvt_pk_bf16_f32 v15, v46, v47
    v_cvt_pk_bf16_f32 v16, v48, v49
    v_cvt_pk_bf16_f32 v17, v50, v51
    v_cvt_pk_bf16_f32 v18, v52, v53
    v_cvt_pk_bf16_f32 v19, v54, v55
    v_cvt_pk_bf16_f32 v20, v56, v57
    v_cvt_pk_bf16_f32 v21, v58, v59
    v_cvt_pk_bf16_f32 v22, v60, v61
    v_cvt_pk_bf16_f32 v23, v62, v63
    v_cvt_pk_bf16_f32 v24, v64, v65
    v_cvt_pk_bf16_f32 v25, v66, v67
    v_cvt_pk_bf16_f32 v26, v68, v69
    v_cvt_pk_bf16_f32 v27, v70, v71
    v_lshlrev_b32 v32, 16, v8
    v_and_b32 v33, 0xffff0000, v8
    v_lshlrev_b32 v34, 16, v9
    v_and_b32 v35, 0xffff0000, v9
    v_lshlrev_b32 v36, 16, v10
    v_and_b32 v37, 0xffff0000, v10
    v_lshlrev_b32 v38, 16, v11
    v_and_b32 v39, 0xffff0000, v11
    v_lshlrev_b32 v40, 16, v12
    v_and_b32 v41, 0xffff0000, v12
    v_lshlrev_b32 v42, 16, v13
    v_and_b32 v43, 0xffff0000, v13
    v_lshlrev_b32 v44, 16, v14
    v_and_b32 v45, 0xffff0000, v14
    v_lshlrev_b32 v46, 16, v15
    v_and_b32 v47, 0xffff0000, v15
    v_lshlrev_b32 v48, 16, v16
    v_and_b32 v49, 0xffff0000, v16
    v_lshlrev_b32 v50, 16, v17
    v_and_b32 v51, 0xffff0000, v17
    v_lshlrev_b32 v52, 16, v18
    v_and_b32 v53, 0xffff0000, v18
    v_lshlrev_b32 v54, 16, v19
    v_and_b32 v55, 0xffff0000, v19
    v_lshlrev_b32 v56, 16, v20
    v_and_b32 v57, 0xffff0000, v20
    v_lshlrev_b32 v58, 16, v21
    v_and_b32 v59, 0xffff0000, v21
    v_lshlrev_b32 v60, 16, v22
    v_and_b32 v61, 0xffff0000, v22
    v_lshlrev_b32 v62, 16, v23
    v_and_b32 v63, 0xffff0000, v23
    v_lshlrev_b32 v64, 16, v24
    v_and_b32 v65, 0xffff0000, v24
    v_lshlrev_b32 v66, 16, v25
    v_and_b32 v67, 0xffff0000, v25
    v_lshlrev_b32 v68, 16, v26
    v_and_b32 v69, 0xffff0000, v26
    v_lshlrev_b32 v70, 16, v27
    v_and_b32 v71, 0xffff0000, v27
    v_mul_f32 v32, v32, v5
    v_mul_f32 v33, v33, v5
    v_mul_f32 v34, v34, v5
    v_mul_f32 v35, v35, v5
    v_mul_f32 v36, v36, v5
    v_mul_f32 v37, v37, v5
    v_mul_f32 v38, v38, v5
    v_mul_f32 v39, v39, v5
    v_mul_f32 v40, v40, v5
    v_mul_f32 v41, v41, v5
    v_mul_f32 v42, v42, v5
    v_mul_f32 v43, v43, v5
    v_mul_f32 v44, v44, v5
    v_mul_f32 v45, v45, v5
    v_mul_f32 v46, v46, v5
    v_mul_f32 v47, v47, v5
    v_mul_f32 v48, v48, v5
    v_mul_f32 v49, v49, v5
    v_mul_f32 v50, v50, v5
    v_mul_f32 v51, v51, v5
    v_mul_f32 v52, v52, v5
    v_mul_f32 v53, v53, v5
    v_mul_f32 v54, v54, v5
    v_mul_f32 v55, v55, v5
    v_mul_f32 v56, v56, v5
    v_mul_f32 v57, v57, v5
    v_mul_f32 v58, v58, v5
    v_mul_f32 v59, v59, v5
    v_mul_f32 v60, v60, v5
    v_mul_f32 v61, v61, v5
    v_mul_f32 v62, v62, v5
    v_mul_f32 v63, v63, v5
    v_mul_f32 v64, v64, v5
    v_mul_f32 v65, v65, v5
    v_mul_f32 v66, v66, v5
    v_mul_f32 v67, v67, v5
    v_mul_f32 v68, v68, v5
    v_mul_f32 v69, v69, v5
    v_mul_f32 v70, v70, v5
    v_mul_f32 v71, v71, v5
    v_cvt_pk_bf16_f32 v8, v32, v33
    v_cvt_pk_bf16_f32 v9, v34, v35
    v_cvt_pk_bf16_f32 v10, v36, v37
    v_cvt_pk_bf16_f32 v11, v38, v39
    v_cvt_pk_bf16_f32 v12, v40, v41
    v_cvt_pk_bf16_f32 v13, v42, v43
    v_cvt_pk_bf16_f32 v14, v44, v45
    v_cvt_pk_bf16_f32 v15, v46, v47
    v_cvt_pk_bf16_f32 v16, v48, v49
    v_cvt_pk_bf16_f32 v17, v50, v51
    v_cvt_pk_bf16_f32 v18, v52, v53
    v_cvt_pk_bf16_f32 v19, v54, v55
    v_cvt_pk_bf16_f32 v20, v56, v57
    v_cvt_pk_bf16_f32 v21, v58, v59
    v_cvt_pk_bf16_f32 v22, v60, v61
    v_cvt_pk_bf16_f32 v23, v62, v63
    v_cvt_pk_bf16_f32 v24, v64, v65
    v_cvt_pk_bf16_f32 v25, v66, v67
    v_cvt_pk_bf16_f32 v26, v68, v69
    v_cvt_pk_bf16_f32 v27, v70, v71
    v_lshlrev_b32 v32, 16, v8
    v_and_b32 v33, 0xffff0000, v8
    v_lshlrev_b32 v34, 16, v9
    v_and_b32 v35, 0xffff0000, v9
    v_lshlrev_b32 v36, 16, v10
    v_and_b32 v37, 0xffff0000, v10
    v_lshlrev_b32 v38, 16, v11
    v_and_b32 v39, 0xffff0000, v11
    v_lshlrev_b32 v40, 16, v12
    v_and_b32 v41, 0xffff0000, v12
    v_lshlrev_b32 v42, 16, v13
    v_and_b32 v43, 0xffff0000, v13
    v_lshlrev_b32 v44, 16, v14
    v_and_b32 v45, 0xffff0000, v14
    v_lshlrev_b32 v46, 16, v15
    v_and_b32 v47, 0xffff0000, v15
    v_lshlrev_b32 v48, 16, v16
    v_and_b32 v49, 0xffff0000, v16
    v_lshlrev_b32 v50, 16, v17
    v_and_b32 v51, 0xffff0000, v17
    v_lshlrev_b32 v52, 16, v18
    v_and_b32 v53, 0xffff0000, v18
    v_lshlrev_b32 v54, 16, v19
    v_and_b32 v55, 0xffff0000, v19
    v_lshlrev_b32 v56, 16, v20
    v_and_b32 v57, 0xffff0000, v20
    v_lshlrev_b32 v58, 16, v21
    v_and_b32 v59, 0xffff0000, v21
    v_lshlrev_b32 v60, 16, v22
    v_and_b32 v61, 0xffff0000, v22
    v_lshlrev_b32 v62, 16, v23
    v_and_b32 v63, 0xffff0000, v23
    v_lshlrev_b32 v64, 16, v24
    v_and_b32 v65, 0xffff0000, v24
    v_lshlrev_b32 v66, 16, v25
    v_and_b32 v67, 0xffff0000, v25
    v_lshlrev_b32 v68, 16, v26
    v_and_b32 v69, 0xffff0000, v26
    v_lshlrev_b32 v70, 16, v27
    v_and_b32 v71, 0xffff0000, v27
    v_cvt_pkrtz_f16_f32 v8, v32, v33
    v_cvt_pkrtz_f16_f32 v9, v34, v35
    v_cvt_pkrtz_f16_f32 v10, v36, v37
    v_cvt_pkrtz_f16_f32 v11, v38, v39
    v_cvt_pkrtz_f16_f32 v12, v40, v41
    v_cvt_pkrtz_f16_f32 v13, v42, v43
    v_cvt_pkrtz_f16_f32 v14, v44, v45
    v_cvt_pkrtz_f16_f32 v15, v46, v47
    v_cvt_pkrtz_f16_f32 v16, v48, v49
    v_cvt_pkrtz_f16_f32 v17, v50, v51
    v_cvt_pkrtz_f16_f32 v18, v52, v53
    v_cvt_pkrtz_f16_f32 v19, v54, v55
    v_cvt_pkrtz_f16_f32 v20, v56, v57
    v_cvt_pkrtz_f16_f32 v21, v58, v59
    v_cvt_pkrtz_f16_f32 v22, v60, v61
    v_cvt_pkrtz_f16_f32 v23, v62, v63
    v_cvt_pkrtz_f16_f32 v24, v64, v65
    v_cvt_pkrtz_f16_f32 v25, v66, v67
    v_cvt_pkrtz_f16_f32 v26, v68, v69
    v_cvt_pkrtz_f16_f32 v27, v70, v71
    v_lshrrev_b32 v6, 5, v1
    v_mul_u32_u24 v6, 40960, v6
    v_lshrrev_b32 v7, 1, v3
    v_lshl_add_u32 v6, v7, 10, v6
    v_and_b32 v7, 1, v3
    v_lshl_add_u32 v6, v7, 9, v6
    v_and_b32 v7, 31, v1
    v_lshl_add_u32 v6, v7, 4, v6
    s_mov_b32 s36, 65536
    buffer_store_dwordx4 v[8:11], v6, s[12:15], s36 offen sc1
    s_mov_b32 s36, 73728
    buffer_store_dwordx4 v[12:15], v6, s[12:15], s36 offen sc1
    s_mov_b32 s36, 81920
    buffer_store_dwordx4 v[16:19], v6, s[12:15], s36 offen sc1
    s_mov_b32 s36, 90112
    buffer_store_dwordx4 v[20:23], v6, s[12:15], s36 offen sc1
    s_mov_b32 s36, 98304
    buffer_store_dwordx4 v[24:27], v6, s[12:15], s36 offen sc1
    s_lshl_b32 s36, s2, 1
    s_and_b32 s37, s3, 1
    s_add_u32 s36, s36, s37
    s_lshl_b32 s36, s36, 2
    s_add_u32 s36, s36, 29622272
    s_branch L_p0_flag
L_p0_gemv:
    s_cmp_ge_u32 s2, 240
    s_cbranch_scc1 L_p0_skip
    s_cmp_lt_u32 s2, 80
    s_cbranch_scc1 L_p0_nd
    v_mov_b32 v250, 0
    global_load_dword v252, v250, s[80:81] sc1
    s_mov_b32 s82, 0x200000
    v_mov_b32 v250, 0
L_tg_dly:
    s_waitcnt vmcnt(0)
    v_readfirstlane_b32 s83, v252
    s_nop 3
    s_cmp_lg_u32 s83, 0
    s_cbranch_scc1 L_tgd_dly
    global_load_dword v252, v250, s[80:81] sc1
    s_sub_u32 s82, s82, 1
    s_cmp_lg_u32 s82, 0
    s_cbranch_scc1 L_tg_dly
L_tgd_dly:
L_p0_nd:
    s_lshr_b32 s36, s2, 2
    s_and_b32 s37, s2, 3
    s_lshl_b32 s37, s37, 1
    s_and_b32 s38, s3, 1
    s_add_u32 s37, s37, s38
    s_mul_i32 s38, s37, 614400
    s_lshl_b32 s39, s36, 7
    s_add_u32 s38, s38, s39
    s_mul_i32 s39, s37, 160
    v_lshrrev_b32 v1, 3, v2
    v_and_b32 v3, 7, v2
    v_mul_u32_u24 v4, 7680, v1
    v_lshl_add_u32 v4, v3, 4, v4
    v_lshlrev_b32 v5, 1, v1
    s_mov_b32 s16, s78
    s_and_b32 s17, s79, 0xffff
    s_mov_b32 s18, 4915200
    s_mov_b32 s19, 0x00020000
    s_mov_b32 s44, s76
    s_and_b32 s45, s77, 0xffff
    s_mov_b32 s46, 1280
    s_mov_b32 s47, 0x00020000
    buffer_load_dwordx4 v[8:11], v4, s[16:19], s38 offen
    s_add_u32 s38, s38, 61440
    buffer_load_dwordx4 v[12:15], v4, s[16:19], s38 offen
    s_add_u32 s38, s38, 61440
    buffer_load_dwordx4 v[16:19], v4, s[16:19], s38 offen
    s_add_u32 s38, s38, 61440
    buffer_load_dwordx4 v[20:23], v4, s[16:19], s38 offen
    s_add_u32 s38, s38, 61440
    buffer_load_dwordx4 v[24:27], v4, s[16:19], s38 offen
    s_add_u32 s38, s38, 61440
    buffer_load_dwordx4 v[28:31], v4, s[16:19], s38 offen
    s_add_u32 s38, s38, 61440
    buffer_load_dwordx4 v[32:35], v4, s[16:19], s38 offen
    s_add_u32 s38, s38, 61440
    buffer_load_dwordx4 v[36:39], v4, s[16:19], s38 offen
    s_add_u32 s38, s38, 61440
    buffer_load_dwordx4 v[40:43], v4, s[16:19], s38 offen
    s_add_u32 s38, s38, 61440
    buffer_load_dwordx4 v[44:47], v4, s[16:19], s38 offen
    buffer_load_ushort v50, v5, s[44:47], s39 offen offset:0
    buffer_load_ushort v51, v5, s[44:47], s39 offen offset:16
    buffer_load_ushort v52, v5, s[44:47], s39 offen offset:32
    buffer_load_ushort v53, v5, s[44:47], s39 offen offset:48
    buffer_load_ushort v54, v5, s[44:47], s39 offen offset:64
    buffer_load_ushort v55, v5, s[44:47], s39 offen offset:80
    buffer_load_ushort v56, v5, s[44:47], s39 offen offset:96
    buffer_load_ushort v57, v5, s[44:47], s39 offen offset:112
    buffer_load_ushort v58, v5, s[44:47], s39 offen offset:128
    buffer_load_ushort v59, v5, s[44:47], s39 offen offset:144
    v_mov_b32 v250, 0
    global_load_dword v252, v250, s[80:81] sc1
    s_mov_b32 s82, 0x200000
    v_mov_b32 v250, 0
L_tg_gv:
    s_waitcnt vmcnt(0)
    v_readfirstlane_b32 s83, v252
    s_nop 3
    s_cmp_lg_u32 s83, 0
    s_cbranch_scc1 L_tgd_gv
    global_load_dword v252, v250, s[80:81] sc1
    s_sub_u32 s82, s82, 1
    s_cmp_lg_u32 s82, 0
    s_cbranch_scc1 L_tg_gv
L_tgd_gv:
    v_lshlrev_b32 v50, 16, v50
    v_mul_f32 v60, 0xbfb8aa3b, v50
    v_lshlrev_b32 v51, 16, v51
    v_mul_f32 v61, 0xbfb8aa3b, v51
    v_lshlrev_b32 v52, 16, v52
    v_mul_f32 v62, 0xbfb8aa3b, v52
    v_lshlrev_b32 v53, 16, v53
    v_mul_f32 v63, 0xbfb8aa3b, v53
    v_lshlrev_b32 v54, 16, v54
    v_mul_f32 v64, 0xbfb8aa3b, v54
    v_lshlrev_b32 v55, 16, v55
    v_mul_f32 v65, 0xbfb8aa3b, v55
    v_lshlrev_b32 v56, 16, v56
    v_mul_f32 v66, 0xbfb8aa3b, v56
    v_lshlrev_b32 v57, 16, v57
    v_mul_f32 v67, 0xbfb8aa3b, v57
    v_lshlrev_b32 v58, 16, v58
    v_mul_f32 v68, 0xbfb8aa3b, v58
    v_lshlrev_b32 v59, 16, v59
    v_mul_f32 v69, 0xbfb8aa3b, v59
    v_exp_f32 v60, v60
    v_exp_f32 v61, v61
    v_exp_f32 v62, v62
    v_exp_f32 v63, v63
    v_exp_f32 v64, v64
    v_exp_f32 v65, v65
    v_exp_f32 v66, v66
    v_exp_f32 v67, v67
    v_exp_f32 v68, v68
    v_exp_f32 v69, v69
    v_add_f32 v60, 1.0, v60
    v_add_f32 v61, 1.0, v61
    v_add_f32 v62, 1.0, v62
    v_add_f32 v63, 1.0, v63
    v_add_f32 v64, 1.0, v64
    v_add_f32 v65, 1.0, v65
    v_add_f32 v66, 1.0, v66
    v_add_f32 v67, 1.0, v67
    v_add_f32 v68, 1.0, v68
    v_add_f32 v69, 1.0, v69
    v_rcp_f32 v60, v60
    v_rcp_f32 v61, v61
    v_rcp_f32 v62, v62
    v_rcp_f32 v63, v63
    v_rcp_f32 v64, v64
    v_rcp_f32 v65, v65
    v_rcp_f32 v66, v66
    v_rcp_f32 v67, v67
    v_rcp_f32 v68, v68
    v_rcp_f32 v69, v69
    v_mul_f32 v50, v50, v60
    v_mul_f32 v51, v51, v61
    v_mul_f32 v52, v52, v62
    v_mul_f32 v53, v53, v63
    v_mul_f32 v54, v54, v64
    v_mul_f32 v55, v55, v65
    v_mul_f32 v56, v56, v66
    v_mul_f32 v57, v57, v67
    v_mul_f32 v58, v58, v68
    v_mul_f32 v59, v59, v69
    v_cvt_pk_bf16_f32 v50, v50, v50
    v_and_b32 v50, 0xffff0000, v50
    v_cvt_pk_bf16_f32 v51, v51, v51
    v_and_b32 v51, 0xffff0000, v51
    v_cvt_pk_bf16_f32 v52, v52, v52
    v_and_b32 v52, 0xffff0000, v52
    v_cvt_pk_bf16_f32 v53, v53, v53
    v_and_b32 v53, 0xffff0000, v53
    v_cvt_pk_bf16_f32 v54, v54, v54
    v_and_b32 v54, 0xffff0000, v54
    v_cvt_pk_bf16_f32 v55, v55, v55
    v_and_b32 v55, 0xffff0000, v55
    v_cvt_pk_bf16_f32 v56, v56, v56
    v_and_b32 v56, 0xffff0000, v56
    v_cvt_pk_bf16_f32 v57, v57, v57
    v_and_b32 v57, 0xffff0000, v57
    v_cvt_pk_bf16_f32 v58, v58, v58
    v_and_b32 v58, 0xffff0000, v58
    v_cvt_pk_bf16_f32 v59, v59, v59
    v_and_b32 v59, 0xffff0000, v59
    v_mov_b32 v72, 0
    v_mov_b32 v73, 0
    v_mov_b32 v74, 0
    v_mov_b32 v75, 0
    v_mov_b32 v76, 0
    v_mov_b32 v77, 0
    v_mov_b32 v78, 0
    v_mov_b32 v79, 0
    v_lshlrev_b32 v80, 16, v8
    v_and_b32 v81, 0xffff0000, v8
    v_lshlrev_b32 v82, 16, v9
    v_and_b32 v83, 0xffff0000, v9
    v_lshlrev_b32 v84, 16, v10
    v_and_b32 v85, 0xffff0000, v10
    v_lshlrev_b32 v86, 16, v11
    v_and_b32 v87, 0xffff0000, v11
    v_fmac_f32 v72, v80, v50
    v_fmac_f32 v73, v81, v50
    v_fmac_f32 v74, v82, v50
    v_fmac_f32 v75, v83, v50
    v_fmac_f32 v76, v84, v50
    v_fmac_f32 v77, v85, v50
    v_fmac_f32 v78, v86, v50
    v_fmac_f32 v79, v87, v50
    v_lshlrev_b32 v80, 16, v12
    v_and_b32 v81, 0xffff0000, v12
    v_lshlrev_b32 v82, 16, v13
    v_and_b32 v83, 0xffff0000, v13
    v_lshlrev_b32 v84, 16, v14
    v_and_b32 v85, 0xffff0000, v14
    v_lshlrev_b32 v86, 16, v15
    v_and_b32 v87, 0xffff0000, v15
    v_fmac_f32 v72, v80, v51
    v_fmac_f32 v73, v81, v51
    v_fmac_f32 v74, v82, v51
    v_fmac_f32 v75, v83, v51
    v_fmac_f32 v76, v84, v51
    v_fmac_f32 v77, v85, v51
    v_fmac_f32 v78, v86, v51
    v_fmac_f32 v79, v87, v51
    v_lshlrev_b32 v80, 16, v16
    v_and_b32 v81, 0xffff0000, v16
    v_lshlrev_b32 v82, 16, v17
    v_and_b32 v83, 0xffff0000, v17
    v_lshlrev_b32 v84, 16, v18
    v_and_b32 v85, 0xffff0000, v18
    v_lshlrev_b32 v86, 16, v19
    v_and_b32 v87, 0xffff0000, v19
    v_fmac_f32 v72, v80, v52
    v_fmac_f32 v73, v81, v52
    v_fmac_f32 v74, v82, v52
    v_fmac_f32 v75, v83, v52
    v_fmac_f32 v76, v84, v52
    v_fmac_f32 v77, v85, v52
    v_fmac_f32 v78, v86, v52
    v_fmac_f32 v79, v87, v52
    v_lshlrev_b32 v80, 16, v20
    v_and_b32 v81, 0xffff0000, v20
    v_lshlrev_b32 v82, 16, v21
    v_and_b32 v83, 0xffff0000, v21
    v_lshlrev_b32 v84, 16, v22
    v_and_b32 v85, 0xffff0000, v22
    v_lshlrev_b32 v86, 16, v23
    v_and_b32 v87, 0xffff0000, v23
    v_fmac_f32 v72, v80, v53
    v_fmac_f32 v73, v81, v53
    v_fmac_f32 v74, v82, v53
    v_fmac_f32 v75, v83, v53
    v_fmac_f32 v76, v84, v53
    v_fmac_f32 v77, v85, v53
    v_fmac_f32 v78, v86, v53
    v_fmac_f32 v79, v87, v53
    v_lshlrev_b32 v80, 16, v24
    v_and_b32 v81, 0xffff0000, v24
    v_lshlrev_b32 v82, 16, v25
    v_and_b32 v83, 0xffff0000, v25
    v_lshlrev_b32 v84, 16, v26
    v_and_b32 v85, 0xffff0000, v26
    v_lshlrev_b32 v86, 16, v27
    v_and_b32 v87, 0xffff0000, v27
    v_fmac_f32 v72, v80, v54
    v_fmac_f32 v73, v81, v54
    v_fmac_f32 v74, v82, v54
    v_fmac_f32 v75, v83, v54
    v_fmac_f32 v76, v84, v54
    v_fmac_f32 v77, v85, v54
    v_fmac_f32 v78, v86, v54
    v_fmac_f32 v79, v87, v54
    v_lshlrev_b32 v80, 16, v28
    v_and_b32 v81, 0xffff0000, v28
    v_lshlrev_b32 v82, 16, v29
    v_and_b32 v83, 0xffff0000, v29
    v_lshlrev_b32 v84, 16, v30
    v_and_b32 v85, 0xffff0000, v30
    v_lshlrev_b32 v86, 16, v31
    v_and_b32 v87, 0xffff0000, v31
    v_fmac_f32 v72, v80, v55
    v_fmac_f32 v73, v81, v55
    v_fmac_f32 v74, v82, v55
    v_fmac_f32 v75, v83, v55
    v_fmac_f32 v76, v84, v55
    v_fmac_f32 v77, v85, v55
    v_fmac_f32 v78, v86, v55
    v_fmac_f32 v79, v87, v55
    v_lshlrev_b32 v80, 16, v32
    v_and_b32 v81, 0xffff0000, v32
    v_lshlrev_b32 v82, 16, v33
    v_and_b32 v83, 0xffff0000, v33
    v_lshlrev_b32 v84, 16, v34
    v_and_b32 v85, 0xffff0000, v34
    v_lshlrev_b32 v86, 16, v35
    v_and_b32 v87, 0xffff0000, v35
    v_fmac_f32 v72, v80, v56
    v_fmac_f32 v73, v81, v56
    v_fmac_f32 v74, v82, v56
    v_fmac_f32 v75, v83, v56
    v_fmac_f32 v76, v84, v56
    v_fmac_f32 v77, v85, v56
    v_fmac_f32 v78, v86, v56
    v_fmac_f32 v79, v87, v56
    v_lshlrev_b32 v80, 16, v36
    v_and_b32 v81, 0xffff0000, v36
    v_lshlrev_b32 v82, 16, v37
    v_and_b32 v83, 0xffff0000, v37
    v_lshlrev_b32 v84, 16, v38
    v_and_b32 v85, 0xffff0000, v38
    v_lshlrev_b32 v86, 16, v39
    v_and_b32 v87, 0xffff0000, v39
    v_fmac_f32 v72, v80, v57
    v_fmac_f32 v73, v81, v57
    v_fmac_f32 v74, v82, v57
    v_fmac_f32 v75, v83, v57
    v_fmac_f32 v76, v84, v57
    v_fmac_f32 v77, v85, v57
    v_fmac_f32 v78, v86, v57
    v_fmac_f32 v79, v87, v57
    v_lshlrev_b32 v80, 16, v40
    v_and_b32 v81, 0xffff0000, v40
    v_lshlrev_b32 v82, 16, v41
    v_and_b32 v83, 0xffff0000, v41
    v_lshlrev_b32 v84, 16, v42
    v_and_b32 v85, 0xffff0000, v42
    v_lshlrev_b32 v86, 16, v43
    v_and_b32 v87, 0xffff0000, v43
    v_fmac_f32 v72, v80, v58
    v_fmac_f32 v73, v81, v58
    v_fmac_f32 v74, v82, v58
    v_fmac_f32 v75, v83, v58
    v_fmac_f32 v76, v84, v58
    v_fmac_f32 v77, v85, v58
    v_fmac_f32 v78, v86, v58
    v_fmac_f32 v79, v87, v58
    v_lshlrev_b32 v80, 16, v44
    v_and_b32 v81, 0xffff0000, v44
    v_lshlrev_b32 v82, 16, v45
    v_and_b32 v83, 0xffff0000, v45
    v_lshlrev_b32 v84, 16, v46
    v_and_b32 v85, 0xffff0000, v46
    v_lshlrev_b32 v86, 16, v47
    v_and_b32 v87, 0xffff0000, v47
    v_fmac_f32 v72, v80, v59
    v_fmac_f32 v73, v81, v59
    v_fmac_f32 v74, v82, v59
    v_fmac_f32 v75, v83, v59
    v_fmac_f32 v76, v84, v59
    v_fmac_f32 v77, v85, v59
    v_fmac_f32 v78, v86, v59
    v_fmac_f32 v79, v87, v59
    v_add_f32_dpp v72, v72, v72 row_ror:8 row_mask:0xf bank_mask:0xf
    v_add_f32_dpp v73, v73, v73 row_ror:8 row_mask:0xf bank_mask:0xf
    v_add_f32_dpp v74, v74, v74 row_ror:8 row_mask:0xf bank_mask:0xf
    v_add_f32_dpp v75, v75, v75 row_ror:8 row_mask:0xf bank_mask:0xf
    v_add_f32_dpp v76, v76, v76 row_ror:8 row_mask:0xf bank_mask:0xf
    v_add_f32_dpp v77, v77, v77 row_ror:8 row_mask:0xf bank_mask:0xf
    v_add_f32_dpp v78, v78, v78 row_ror:8 row_mask:0xf bank_mask:0xf
    v_add_f32_dpp v79, v79, v79 row_ror:8 row_mask:0xf bank_mask:0xf
    v_mov_b32 v80, v72
    v_mov_b32 v81, v73
    v_mov_b32 v82, v74
    v_mov_b32 v83, v75
    v_mov_b32 v84, v76
    v_mov_b32 v85, v77
    v_mov_b32 v86, v78
    v_mov_b32 v87, v79
    v_permlane16_swap_b32 v72, v80
    v_permlane16_swap_b32 v73, v81
    v_permlane16_swap_b32 v74, v82
    v_permlane16_swap_b32 v75, v83
    v_permlane16_swap_b32 v76, v84
    v_permlane16_swap_b32 v77, v85
    v_permlane16_swap_b32 v78, v86
    v_permlane16_swap_b32 v79, v87
    v_add_f32 v72, v72, v80
    v_add_f32 v73, v73, v81
    v_add_f32 v74, v74, v82
    v_add_f32 v75, v75, v83
    v_add_f32 v76, v76, v84
    v_add_f32 v77, v77, v85
    v_add_f32 v78, v78, v86
    v_add_f32 v79, v79, v87
    v_mov_b32 v80, v72
    v_mov_b32 v81, v73
    v_mov_b32 v82, v74
    v_mov_b32 v83, v75
    v_mov_b32 v84, v76
    v_mov_b32 v85, v77
    v_mov_b32 v86, v78
    v_mov_b32 v87, v79
    v_permlane32_swap_b32 v72, v80
    v_permlane32_swap_b32 v73, v81
    v_permlane32_swap_b32 v74, v82
    v_permlane32_swap_b32 v75, v83
    v_permlane32_swap_b32 v76, v84
    v_permlane32_swap_b32 v77, v85
    v_permlane32_swap_b32 v78, v86
    v_permlane32_swap_b32 v79, v87
    v_add_f32 v72, v72, v80
    v_add_f32 v73, v73, v81
    v_add_f32 v74, v74, v82
    v_add_f32 v75, v75, v83
    v_add_f32 v76, v76, v84
    v_add_f32 v77, v77, v85
    v_add_f32 v78, v78, v86
    v_add_f32 v79, v79, v87
    s_mul_i32 s38, s37, 15360
    s_lshl_b32 s39, s36, 8
    s_add_u32 s38, s38, s39
    s_add_u32 s38, s38, 29229056
    v_lshlrev_b32 v4, 5, v2
    s_mov_b64 exec, 0xff
    buffer_store_dwordx4 v[72:75], v4, s[12:15], s38 offen sc1
    buffer_store_dwordx4 v[76:79], v4, s[12:15], s38 offen offset:16 sc1
    s_mov_b64 exec, -1
    s_lshl_b32 s36, s36, 3
    s_add_u32 s36, s36, s37
    s_lshl_b32 s36, s36, 2
    s_add_u32 s36, s36, 29624320
L_p0_flag:
    s_waitcnt vmcnt(0) lgkmcnt(0)
    v_lshlrev_b32 v250, 14, v2
    v_add_u32 v250, s36, v250
    v_mov_b32 v251, s83
    s_mov_b64 exec, 0xffff
    global_store_dword v250, v251, s[84:85] sc1
    s_mov_b64 exec, -1
    s_branch L_p0_done
L_p0_skip:
    v_mov_b32 v250, 0
    global_load_dword v252, v250, s[80:81] sc1
    s_mov_b32 s82, 0x200000
    v_mov_b32 v250, 0
L_tg_sk:
    s_waitcnt vmcnt(0)
    v_readfirstlane_b32 s83, v252
    s_nop 3
    s_cmp_lg_u32 s83, 0
    s_cbranch_scc1 L_tgd_sk
    global_load_dword v252, v250, s[80:81] sc1
    s_sub_u32 s82, s82, 1
    s_cmp_lg_u32 s82, 0
    s_cbranch_scc1 L_tg_sk
L_tgd_sk:
L_p0_done:
    s_nop 3
    s_barrier
    s_cmp_ge_u32 s23, 15
    s_cbranch_scc1 L_sigb_p1
    s_sub_u32 s24, s24, 4
    v_lshrrev_b32 v20, 5, v2
    v_lshlrev_b32 v5, 4, v2
    s_lshl_b32 s25, s22, 7
    s_add_u32 s25, s25, -640
    v_add_u32 v6, s25, v5
    v_add_u32 v7, 2048, v5
    v_cmp_gt_u32 vcc, 40, v2
    s_nop 1
    v_cndmask_b32 v6, v6, v7, vcc
    s_cmp_lg_u32 s3, 4
    s_cbranch_scc1 L_wt_p1
    s_and_b32 s82, s2, 15
    s_lshl_b32 s82, s82, 14
    s_add_u32 s82, s82, 29622272
    v_add_u32 v247, s82, v6
    s_mov_b32 s82, 0x200000
    s_mov_b32 exec_hi, 65535
L_wl_p1:
    global_load_dwordx4 v[248:251], v247, s[84:85] sc1
    s_waitcnt vmcnt(0)
    v_xor_b32 v248, s83, v248
    v_xor_b32 v249, s83, v249
    v_xor_b32 v250, s83, v250
    v_xor_b32 v251, s83, v251
    v_or3_b32 v248, v248, v249, v250
    v_or_b32 v248, v248, v251
    v_cmp_ne_u32 vcc, 0, v248
    s_nop 4
    s_cbranch_vccz L_wd_p1
    s_sleep 2
    s_sub_u32 s82, s82, 1
    s_cmp_lg_u32 s82, 0
    s_cbranch_scc1 L_wl_p1
L_wd_p1:
    s_mov_b64 exec, -1
L_wt_p1:
    s_nop 1
    v_mov_b32 v250, 163824
    s_cmp_lg_u32 s3, 4
    s_cbranch_scc1 L_p1_lspin
    v_mov_b32 v251, 1
    ds_write_b32 v250, v251
    s_branch L_p1_lgo
L_p1_lspin:
    ds_read_b32 v251, v250
    s_waitcnt lgkmcnt(0)
    v_readfirstlane_b32 s82, v251
    s_nop 3
    s_cmp_lg_u32 s82, 0
    s_cbranch_scc1 L_p1_lgo
    s_sleep 1
    s_branch L_p1_lspin
L_p1_lgo:
    s_waitcnt lgkmcnt(0)
    v_lshrrev_b32 v3, 2, v2
    v_and_b32 v4, 3, v2
    v_lshlrev_b32 v6, 8, v3
    v_lshl_add_u32 v6, v4, 4, v6
    v_cmp_gt_u32 vcc, 40, v2
    v_mov_b32 v7, 0x7ffffff0
    s_nop 0
    v_cndmask_b32 v6, v7, v6, vcc
    s_lshl_b32 s25, s24, 6
    s_add_u32 s25, s25, 29229056
    s_mul_i32 s26, s22, 163840
    s_lshl_b32 s27, s24, 10
    s_add_u32 s26, s26, s27
    s_add_u32 s26, s26, 65536
    buffer_load_dwordx4 v[168:171], v6, s[12:15], s25 offen offset:2560 sc1
    buffer_load_dwordx4 v[172:175], v6, s[12:15], s25 offen sc1
    s_add_u32 s25, s25, 15360
    buffer_load_dwordx4 v[176:179], v6, s[12:15], s25 offen offset:2560 sc1
    buffer_load_dwordx4 v[180:183], v6, s[12:15], s25 offen sc1
    s_add_u32 s25, s25, 15360
    buffer_load_dwordx4 v[184:187], v6, s[12:15], s25 offen offset:2560 sc1
    buffer_load_dwordx4 v[188:191], v6, s[12:15], s25 offen sc1
    s_add_u32 s25, s25, 15360
    buffer_load_dwordx4 v[192:195], v6, s[12:15], s25 offen offset:2560 sc1
    buffer_load_dwordx4 v[196:199], v6, s[12:15], s25 offen sc1
    s_add_u32 s25, s25, 15360
    buffer_load_dwordx4 v[200:203], v6, s[12:15], s25 offen offset:2560 sc1
    buffer_load_dwordx4 v[204:207], v6, s[12:15], s25 offen sc1
    s_add_u32 s25, s25, 15360
    buffer_load_dwordx4 v[208:211], v6, s[12:15], s25 offen offset:2560 sc1
    buffer_load_dwordx4 v[212:215], v6, s[12:15], s25 offen sc1
    s_add_u32 s25, s25, 15360
    buffer_load_dwordx4 v[216:219], v6, s[12:15], s25 offen offset:2560 sc1
    buffer_load_dwordx4 v[220:223], v6, s[12:15], s25 offen sc1
    s_add_u32 s25, s25, 15360
    buffer_load_dwordx4 v[224:227], v6, s[12:15], s25 offen offset:2560 sc1
    buffer_load_dwordx4 v[228:231], v6, s[12:15], s25 offen sc1
    s_add_u32 s29, s26, 0
    buffer_load_dwordx4 v[104:107], v5, s[12:15], s29 offen sc1
    s_add_u32 s29, s26, 40960
    buffer_load_dwordx4 v[108:111], v5, s[12:15], s29 offen sc1
    s_add_u32 s29, s26, 81920
    buffer_load_dwordx4 v[112:115], v5, s[12:15], s29 offen sc1
    s_add_u32 s29, s26, 122880
    buffer_load_dwordx4 v[116:119], v5, s[12:15], s29 offen sc1
    s_add_u32 s29, s26, 4096
    buffer_load_dwordx4 v[120:123], v5, s[12:15], s29 offen sc1
    s_add_u32 s29, s26, 45056
    buffer_load_dwordx4 v[124:127], v5, s[12:15], s29 offen sc1
    s_add_u32 s29, s26, 86016
    buffer_load_dwordx4 v[128:131], v5, s[12:15], s29 offen sc1
    s_add_u32 s29, s26, 126976
    buffer_load_dwordx4 v[132:135], v5, s[12:15], s29 offen sc1
    s_waitcnt vmcnt(21)
    v_add_f32 v168, v168, v176
    v_add_f32 v169, v169, v177
    v_add_f32 v170, v170, v178
    v_add_f32 v171, v171, v179
    s_waitcnt vmcnt(20)
    v_add_f32 v172, v172, v180
    v_add_f32 v173, v173, v181
    v_add_f32 v174, v174, v182
    v_add_f32 v175, v175, v183
    s_waitcnt vmcnt(19)
    v_add_f32 v168, v168, v184
    v_add_f32 v169, v169, v185
    v_add_f32 v170, v170, v186
    v_add_f32 v171, v171, v187
    s_waitcnt vmcnt(18)
    v_add_f32 v172, v172, v188
    v_add_f32 v173, v173, v189
    v_add_f32 v174, v174, v190
    v_add_f32 v175, v175, v191
    s_waitcnt vmcnt(17)
    v_add_f32 v168, v168, v192
    v_add_f32 v169, v169, v193
    v_add_f32 v170, v170, v194
    v_add_f32 v171, v171, v195
    s_waitcnt vmcnt(16)
    v_add_f32 v172, v172, v196
    v_add_f32 v173, v173, v197
    v_add_f32 v174, v174, v198
    v_add_f32 v175, v175, v199
    s_waitcnt vmcnt(15)
    v_add_f32 v168, v168, v200
    v_add_f32 v169, v169, v201
    v_add_f32 v170, v170, v202
    v_add_f32 v171, v171, v203
    s_waitcnt vmcnt(14)
    v_add_f32 v172, v172, v204
    v_add_f32 v173, v173, v205
    v_add_f32 v174, v174, v206
    v_add_f32 v175, v175, v207
    s_waitcnt vmcnt(13)
    v_add_f32 v168, v168, v208
    v_add_f32 v169, v169, v209
    v_add_f32 v170, v170, v210
    v_add_f32 v171, v171, v211
    s_waitcnt vmcnt(12)
    v_add_f32 v172, v172, v212
    v_add_f32 v173, v173, v213
    v_add_f32 v174, v174, v214
    v_add_f32 v175, v175, v215
    s_waitcnt vmcnt(11)
    v_add_f32 v168, v168, v216
    v_add_f32 v169, v169, v217
    v_add_f32 v170, v170, v218
    v_add_f32 v171, v171, v219
    s_waitcnt vmcnt(10)
    v_add_f32 v172, v172, v220
    v_add_f32 v173, v173, v221
    v_add_f32 v174, v174, v222
    v_add_f32 v175, v175, v223
    s_waitcnt vmcnt(9)
    v_add_f32 v168, v168, v224
    v_add_f32 v169, v169, v225
    v_add_f32 v170, v170, v226
    v_add_f32 v171, v171, v227
    s_waitcnt vmcnt(8)
    v_add_f32 v172, v172, v228
    v_add_f32 v173, v173, v229
    v_add_f32 v174, v174, v230
    v_add_f32 v175, v175, v231
    v_cvt_pk_bf16_f32 v32, v168, v168
    v_and_b32 v32, 0xffff0000, v32
    v_cvt_pk_bf16_f32 v33, v169, v169
    v_and_b32 v33, 0xffff0000, v33
    v_cvt_pk_bf16_f32 v34, v170, v170
    v_and_b32 v34, 0xffff0000, v34
    v_cvt_pk_bf16_f32 v35, v171, v171
    v_and_b32 v35, 0xffff0000, v35
    v_cvt_pk_bf16_f32 v36, v172, v172
    v_and_b32 v36, 0xffff0000, v36
    v_cvt_pk_bf16_f32 v37, v173, v173
    v_and_b32 v37, 0xffff0000, v37
    v_cvt_pk_bf16_f32 v38, v174, v174
    v_and_b32 v38, 0xffff0000, v38
    v_cvt_pk_bf16_f32 v39, v175, v175
    v_and_b32 v39, 0xffff0000, v39
    v_add_f32 v32, 1.0, v32
    v_cvt_pk_bf16_f32 v32, v32, v32
    v_and_b32 v32, 0xffff0000, v32
    v_add_f32 v33, 1.0, v33
    v_cvt_pk_bf16_f32 v33, v33, v33
    v_and_b32 v33, 0xffff0000, v33
    v_add_f32 v34, 1.0, v34
    v_cvt_pk_bf16_f32 v34, v34, v34
    v_and_b32 v34, 0xffff0000, v34
    v_add_f32 v35, 1.0, v35
    v_cvt_pk_bf16_f32 v35, v35, v35
    v_and_b32 v35, 0xffff0000, v35
    s_mul_i32 s25, s24, 1280
    s_add_u32 s25, s25, 147456
    v_lshlrev_b32 v14, 7, v3
    v_lshrrev_b32 v15, 1, v4
    v_lshl_add_u32 v14, v15, 6, v14
    v_and_b32 v15, 1, v4
    v_lshl_add_u32 v14, v15, 4, v14
    v_add_u32 v14, s25, v14
    v_cmp_gt_u32 vcc, 40, v2
    s_nop 1
    s_and_saveexec_b64 s[34:35], vcc
    ds_write_b128 v14, v[32:35]
    ds_write_b128 v14, v[36:39] offset:32
    s_mov_b64 exec, s[34:35]
    v_lshlrev_b32 v15, 6, v20
    v_add_u32 v15, s25, v15
    s_lshl_b32 s25, s24, 12
    s_add_u32 s25, s25, 98304
    v_add_u32 v16, s25, v5
    s_waitcnt lgkmcnt(0)
    ds_read_b128 v[32:35], v15 offset:0
    ds_read_b128 v[36:39], v15 offset:16
    ds_read_b128 v[40:43], v15 offset:32
    ds_read_b128 v[44:47], v15 offset:48
    ds_read_b128 v[48:51], v15 offset:128
    ds_read_b128 v[52:55], v15 offset:144
    ds_read_b128 v[56:59], v15 offset:160
    ds_read_b128 v[60:63], v15 offset:176
    s_add_u32 s29, s26, 8192
    buffer_load_dwordx4 v[136:139], v5, s[12:15], s29 offen sc1
    s_add_u32 s29, s26, 49152
    buffer_load_dwordx4 v[140:143], v5, s[12:15], s29 offen sc1
    s_add_u32 s29, s26, 90112
    buffer_load_dwordx4 v[144:147], v5, s[12:15], s29 offen sc1
    s_add_u32 s29, s26, 131072
    buffer_load_dwordx4 v[148:151], v5, s[12:15], s29 offen sc1
    s_waitcnt vmcnt(11) lgkmcnt(5)
    v_fma_mix_f32 v64, v104, v32, v40 op_sel:[0,0,0] op_sel_hi:[1,0,0]
    v_fma_mix_f32 v65, v104, v33, v41 op_sel:[1,0,0] op_sel_hi:[1,0,0]
    v_fma_mix_f32 v66, v105, v34, v42 op_sel:[0,0,0] op_sel_hi:[1,0,0]
    v_fma_mix_f32 v67, v105, v35, v43 op_sel:[1,0,0] op_sel_hi:[1,0,0]
    s_waitcnt lgkmcnt(4)
    v_fma_mix_f32 v68, v106, v36, v44 op_sel:[0,0,0] op_sel_hi:[1,0,0]
    v_fma_mix_f32 v69, v106, v37, v45 op_sel:[1,0,0] op_sel_hi:[1,0,0]
    v_fma_mix_f32 v70, v107, v38, v46 op_sel:[0,0,0] op_sel_hi:[1,0,0]
    v_fma_mix_f32 v71, v107, v39, v47 op_sel:[1,0,0] op_sel_hi:[1,0,0]
    v_cvt_pk_bf16_f32 v80, v64, v65
    v_cvt_pk_bf16_f32 v81, v66, v67
    v_cvt_pk_bf16_f32 v82, v68, v69
    v_cvt_pk_bf16_f32 v83, v70, v71
    ds_write_b128 v16, v[80:83] offset:0
    s_waitcnt vmcnt(10)
    v_fma_mix_f32 v72, v108, v32, v40 op_sel:[0,0,0] op_sel_hi:[1,0,0]
    v_fma_mix_f32 v73, v108, v33, v41 op_sel:[1,0,0] op_sel_hi:[1,0,0]
    v_fma_mix_f32 v74, v109, v34, v42 op_sel:[0,0,0] op_sel_hi:[1,0,0]
    v_fma_mix_f32 v75, v109, v35, v43 op_sel:[1,0,0] op_sel_hi:[1,0,0]
    v_fma_mix_f32 v76, v110, v36, v44 op_sel:[0,0,0] op_sel_hi:[1,0,0]
    v_fma_mix_f32 v77, v110, v37, v45 op_sel:[1,0,0] op_sel_hi:[1,0,0]
    v_fma_mix_f32 v78, v111, v38, v46 op_sel:[0,0,0] op_sel_hi:[1,0,0]
    v_fma_mix_f32 v79, v111, v39, v47 op_sel:[1,0,0] op_sel_hi:[1,0,0]
    v_cvt_pk_bf16_f32 v84, v72, v73
    v_cvt_pk_bf16_f32 v85, v74, v75
    v_cvt_pk_bf16_f32 v86, v76, v77
    v_cvt_pk_bf16_f32 v87, v78, v79
    ds_write_b128 v16, v[84:87] offset:1024
    s_waitcnt vmcnt(9)
    v_fma_mix_f32 v64, v112, v32, v40 op_sel:[0,0,0] op_sel_hi:[1,0,0]
    v_fma_mix_f32 v65, v112, v33, v41 op_sel:[1,0,0] op_sel_hi:[1,0,0]
    v_fma_mix_f32 v66, v113, v34, v42 op_sel:[0,0,0] op_sel_hi:[1,0,0]
    v_fma_mix_f32 v67, v113, v35, v43 op_sel:[1,0,0] op_sel_hi:[1,0,0]
    v_fma_mix_f32 v68, v114, v36, v44 op_sel:[0,0,0] op_sel_hi:[1,0,0]
    v_fma_mix_f32 v69, v114, v37, v45 op_sel:[1,0,0] op_sel_hi:[1,0,0]
    v_fma_mix_f32 v70, v115, v38, v46 op_sel:[0,0,0] op_sel_hi:[1,0,0]
    v_fma_mix_f32 v71, v115, v39, v47 op_sel:[1,0,0] op_sel_hi:[1,0,0]
    v_cvt_pk_bf16_f32 v88, v64, v65
    v_cvt_pk_bf16_f32 v89, v66, v67
    v_cvt_pk_bf16_f32 v90, v68, v69
    v_cvt_pk_bf16_f32 v91, v70, v71
    ds_write_b128 v16, v[88:91] offset:2048
    s_waitcnt vmcnt(8)
    v_fma_mix_f32 v72, v116, v32, v40 op_sel:[0,0,0] op_sel_hi:[1,0,0]
    v_fma_mix_f32 v73, v116, v33, v41 op_sel:[1,0,0] op_sel_hi:[1,0,0]
    v_fma_mix_f32 v74, v117, v34, v42 op_sel:[0,0,0] op_sel_hi:[1,0,0]
    v_fma_mix_f32 v75, v117, v35, v43 op_sel:[1,0,0] op_sel_hi:[1,0,0]
    v_fma_mix_f32 v76, v118, v36, v44 op_sel:[0,0,0] op_sel_hi:[1,0,0]
    v_fma_mix_f32 v77, v118, v37, v45 op_sel:[1,0,0] op_sel_hi:[1,0,0]
    v_fma_mix_f32 v78, v119, v38, v46 op_sel:[0,0,0] op_sel_hi:[1,0,0]
    v_fma_mix_f32 v79, v119, v39, v47 op_sel:[1,0,0] op_sel_hi:[1,0,0]
    v_cvt_pk_bf16_f32 v92, v72, v73
    v_cvt_pk_bf16_f32 v93, v74, v75
    v_cvt_pk_bf16_f32 v94, v76, v77
    v_cvt_pk_bf16_f32 v95, v78, v79
    ds_write_b128 v16, v[92:95] offset:3072
    s_add_u32 s29, s26, 12288
    buffer_load_dwordx4 v[152:155], v5, s[12:15], s29 offen sc1
    s_add_u32 s29, s26, 53248
    buffer_load_dwordx4 v[156:159], v5, s[12:15], s29 offen sc1
    s_add_u32 s29, s26, 94208
    buffer_load_dwordx4 v[160:163], v5, s[12:15], s29 offen sc1
    s_add_u32 s29, s26, 135168
    buffer_load_dwordx4 v[164:167], v5, s[12:15], s29 offen sc1
    ds_read_b128 v[32:35], v15 offset:256
    ds_read_b128 v[36:39], v15 offset:272
    ds_read_b128 v[40:43], v15 offset:288
    ds_read_b128 v[44:47], v15 offset:304
    s_waitcnt lgkmcnt(4)
    s_barrier
    s_waitcnt vmcnt(11)
    v_fma_mix_f32 v64, v120, v48, v56 op_sel:[0,0,0] op_sel_hi:[1,0,0]
    v_fma_mix_f32 v65, v120, v49, v57 op_sel:[1,0,0] op_sel_hi:[1,0,0]
    v_fma_mix_f32 v66, v121, v50, v58 op_sel:[0,0,0] op_sel_hi:[1,0,0]
    v_fma_mix_f32 v67, v121, v51, v59 op_sel:[1,0,0] op_sel_hi:[1,0,0]
    v_fma_mix_f32 v68, v122, v52, v60 op_sel:[0,0,0] op_sel_hi:[1,0,0]
    v_fma_mix_f32 v69, v122, v53, v61 op_sel:[1,0,0] op_sel_hi:[1,0,0]
    v_fma_mix_f32 v70, v123, v54, v62 op_sel:[0,0,0] op_sel_hi:[1,0,0]
    v_fma_mix_f32 v71, v123, v55, v63 op_sel:[1,0,0] op_sel_hi:[1,0,0]
    v_cvt_pk_bf16_f32 v80, v64, v65
    v_cvt_pk_bf16_f32 v81, v66, v67
    v_cvt_pk_bf16_f32 v82, v68, v69
    v_cvt_pk_bf16_f32 v83, v70, v71
    ds_write_b128 v16, v[80:83] offset:16384
    s_waitcnt vmcnt(10)
    v_fma_mix_f32 v72, v124, v48, v56 op_sel:[0,0,0] op_sel_hi:[1,0,0]
    v_fma_mix_f32 v73, v124, v49, v57 op_sel:[1,0,0] op_sel_hi:[1,0,0]
    v_fma_mix_f32 v74, v125, v50, v58 op_sel:[0,0,0] op_sel_hi:[1,0,0]
    v_fma_mix_f32 v75, v125, v51, v59 op_sel:[1,0,0] op_sel_hi:[1,0,0]
    v_fma_mix_f32 v76, v126, v52, v60 op_sel:[0,0,0] op_sel_hi:[1,0,0]
    v_fma_mix_f32 v77, v126, v53, v61 op_sel:[1,0,0] op_sel_hi:[1,0,0]
    v_fma_mix_f32 v78, v127, v54, v62 op_sel:[0,0,0] op_sel_hi:[1,0,0]
    v_fma_mix_f32 v79, v127, v55, v63 op_sel:[1,0,0] op_sel_hi:[1,0,0]
    v_cvt_pk_bf16_f32 v84, v72, v73
    v_cvt_pk_bf16_f32 v85, v74, v75
    v_cvt_pk_bf16_f32 v86, v76, v77
    v_cvt_pk_bf16_f32 v87, v78, v79
    ds_write_b128 v16, v[84:87] offset:17408
    s_waitcnt vmcnt(9)
    v_fma_mix_f32 v64, v128, v48, v56 op_sel:[0,0,0] op_sel_hi:[1,0,0]
    v_fma_mix_f32 v65, v128, v49, v57 op_sel:[1,0,0] op_sel_hi:[1,0,0]
    v_fma_mix_f32 v66, v129, v50, v58 op_sel:[0,0,0] op_sel_hi:[1,0,0]
    v_fma_mix_f32 v67, v129, v51, v59 op_sel:[1,0,0] op_sel_hi:[1,0,0]
    v_fma_mix_f32 v68, v130, v52, v60 op_sel:[0,0,0] op_sel_hi:[1,0,0]
    v_fma_mix_f32 v69, v130, v53, v61 op_sel:[1,0,0] op_sel_hi:[1,0,0]
    v_fma_mix_f32 v70, v131, v54, v62 op_sel:[0,0,0] op_sel_hi:[1,0,0]
    v_fma_mix_f32 v71, v131, v55, v63 op_sel:[1,0,0] op_sel_hi:[1,0,0]
    v_cvt_pk_bf16_f32 v88, v64, v65
    v_cvt_pk_bf16_f32 v89, v66, v67
    v_cvt_pk_bf16_f32 v90, v68, v69
    v_cvt_pk_bf16_f32 v91, v70, v71
    ds_write_b128 v16, v[88:91] offset:18432
    s_waitcnt vmcnt(8)
    v_fma_mix_f32 v72, v132, v48, v56 op_sel:[0,0,0] op_sel_hi:[1,0,0]
    v_fma_mix_f32 v73, v132, v49, v57 op_sel:[1,0,0] op_sel_hi:[1,0,0]
    v_fma_mix_f32 v74, v133, v50, v58 op_sel:[0,0,0] op_sel_hi:[1,0,0]
    v_fma_mix_f32 v75, v133, v51, v59 op_sel:[1,0,0] op_sel_hi:[1,0,0]
    v_fma_mix_f32 v76, v134, v52, v60 op_sel:[0,0,0] op_sel_hi:[1,0,0]
    v_fma_mix_f32 v77, v134, v53, v61 op_sel:[1,0,0] op_sel_hi:[1,0,0]
    v_fma_mix_f32 v78, v135, v54, v62 op_sel:[0,0,0] op_sel_hi:[1,0,0]
    v_fma_mix_f32 v79, v135, v55, v63 op_sel:[1,0,0] op_sel_hi:[1,0,0]
    v_cvt_pk_bf16_f32 v92, v72, v73
    v_cvt_pk_bf16_f32 v93, v74, v75
    v_cvt_pk_bf16_f32 v94, v76, v77
    v_cvt_pk_bf16_f32 v95, v78, v79
    ds_write_b128 v16, v[92:95] offset:19456
    s_add_u32 s29, s26, 16384
    buffer_load_dwordx4 v[104:107], v5, s[12:15], s29 offen sc1
    s_add_u32 s29, s26, 57344
    buffer_load_dwordx4 v[108:111], v5, s[12:15], s29 offen sc1
    s_add_u32 s29, s26, 98304
    buffer_load_dwordx4 v[112:115], v5, s[12:15], s29 offen sc1
    s_add_u32 s29, s26, 139264
    buffer_load_dwordx4 v[116:119], v5, s[12:15], s29 offen sc1
    ds_read_b128 v[48:51], v15 offset:384
    ds_read_b128 v[52:55], v15 offset:400
    ds_read_b128 v[56:59], v15 offset:416
    ds_read_b128 v[60:63], v15 offset:432
    s_waitcnt vmcnt(11) lgkmcnt(9)
    v_fma_mix_f32 v64, v136, v32, v40 op_sel:[0,0,0] op_sel_hi:[1,0,0]
    v_fma_mix_f32 v65, v136, v33, v41 op_sel:[1,0,0] op_sel_hi:[1,0,0]
    v_fma_mix_f32 v66, v137, v34, v42 op_sel:[0,0,0] op_sel_hi:[1,0,0]
    v_fma_mix_f32 v67, v137, v35, v43 op_sel:[1,0,0] op_sel_hi:[1,0,0]
    s_waitcnt lgkmcnt(8)
    v_fma_mix_f32 v68, v138, v36, v44 op_sel:[0,0,0] op_sel_hi:[1,0,0]
    v_fma_mix_f32 v69, v138, v37, v45 op_sel:[1,0,0] op_sel_hi:[1,0,0]
    v_fma_mix_f32 v70, v139, v38, v46 op_sel:[0,0,0] op_sel_hi:[1,0,0]
    v_fma_mix_f32 v71, v139, v39, v47 op_sel:[1,0,0] op_sel_hi:[1,0,0]
    v_cvt_pk_bf16_f32 v80, v64, v65
    v_cvt_pk_bf16_f32 v81, v66, v67
    v_cvt_pk_bf16_f32 v82, v68, v69
    v_cvt_pk_bf16_f32 v83, v70, v71
    ds_write_b128 v16, v[80:83] offset:32768
    s_waitcnt vmcnt(10)
    v_fma_mix_f32 v72, v140, v32, v40 op_sel:[0,0,0] op_sel_hi:[1,0,0]
    v_fma_mix_f32 v73, v140, v33, v41 op_sel:[1,0,0] op_sel_hi:[1,0,0]
    v_fma_mix_f32 v74, v141, v34, v42 op_sel:[0,0,0] op_sel_hi:[1,0,0]
    v_fma_mix_f32 v75, v141, v35, v43 op_sel:[1,0,0] op_sel_hi:[1,0,0]
    v_fma_mix_f32 v76, v142, v36, v44 op_sel:[0,0,0] op_sel_hi:[1,0,0]
    v_fma_mix_f32 v77, v142, v37, v45 op_sel:[1,0,0] op_sel_hi:[1,0,0]
    v_fma_mix_f32 v78, v143, v38, v46 op_sel:[0,0,0] op_sel_hi:[1,0,0]
    v_fma_mix_f32 v79, v143, v39, v47 op_sel:[1,0,0] op_sel_hi:[1,0,0]
    v_cvt_pk_bf16_f32 v84, v72, v73
    v_cvt_pk_bf16_f32 v85, v74, v75
    v_cvt_pk_bf16_f32 v86, v76, v77
    v_cvt_pk_bf16_f32 v87, v78, v79
    ds_write_b128 v16, v[84:87] offset:33792
    s_waitcnt vmcnt(9)
    v_fma_mix_f32 v64, v144, v32, v40 op_sel:[0,0,0] op_sel_hi:[1,0,0]
    v_fma_mix_f32 v65, v144, v33, v41 op_sel:[1,0,0] op_sel_hi:[1,0,0]
    v_fma_mix_f32 v66, v145, v34, v42 op_sel:[0,0,0] op_sel_hi:[1,0,0]
    v_fma_mix_f32 v67, v145, v35, v43 op_sel:[1,0,0] op_sel_hi:[1,0,0]
    v_fma_mix_f32 v68, v146, v36, v44 op_sel:[0,0,0] op_sel_hi:[1,0,0]
    v_fma_mix_f32 v69, v146, v37, v45 op_sel:[1,0,0] op_sel_hi:[1,0,0]
    v_fma_mix_f32 v70, v147, v38, v46 op_sel:[0,0,0] op_sel_hi:[1,0,0]
    v_fma_mix_f32 v71, v147, v39, v47 op_sel:[1,0,0] op_sel_hi:[1,0,0]
    v_cvt_pk_bf16_f32 v88, v64, v65
    v_cvt_pk_bf16_f32 v89, v66, v67
    v_cvt_pk_bf16_f32 v90, v68, v69
    v_cvt_pk_bf16_f32 v91, v70, v71
    ds_write_b128 v16, v[88:91] offset:34816
    s_waitcnt vmcnt(8)
    v_fma_mix_f32 v72, v148, v32, v40 op_sel:[0,0,0] op_sel_hi:[1,0,0]
    v_fma_mix_f32 v73, v148, v33, v41 op_sel:[1,0,0] op_sel_hi:[1,0,0]
    v_fma_mix_f32 v74, v149, v34, v42 op_sel:[0,0,0] op_sel_hi:[1,0,0]
    v_fma_mix_f32 v75, v149, v35, v43 op_sel:[1,0,0] op_sel_hi:[1,0,0]
    v_fma_mix_f32 v76, v150, v36, v44 op_sel:[0,0,0] op_sel_hi:[1,0,0]
    v_fma_mix_f32 v77, v150, v37, v45 op_sel:[1,0,0] op_sel_hi:[1,0,0]
    v_fma_mix_f32 v78, v151, v38, v46 op_sel:[0,0,0] op_sel_hi:[1,0,0]
    v_fma_mix_f32 v79, v151, v39, v47 op_sel:[1,0,0] op_sel_hi:[1,0,0]
    v_cvt_pk_bf16_f32 v92, v72, v73
    v_cvt_pk_bf16_f32 v93, v74, v75
    v_cvt_pk_bf16_f32 v94, v76, v77
    v_cvt_pk_bf16_f32 v95, v78, v79
    ds_write_b128 v16, v[92:95] offset:35840
    s_waitcnt lgkmcnt(8)
    s_barrier
    s_add_u32 s29, s26, 20480
    buffer_load_dwordx4 v[120:123], v5, s[12:15], s29 offen sc1
    s_add_u32 s29, s26, 61440
    buffer_load_dwordx4 v[124:127], v5, s[12:15], s29 offen sc1
    s_add_u32 s29, s26, 102400
    buffer_load_dwordx4 v[128:131], v5, s[12:15], s29 offen sc1
    s_add_u32 s29, s26, 143360
    buffer_load_dwordx4 v[132:135], v5, s[12:15], s29 offen sc1
    ds_read_b128 v[32:35], v15 offset:512
    ds_read_b128 v[36:39], v15 offset:528
    ds_read_b128 v[40:43], v15 offset:544
    ds_read_b128 v[44:47], v15 offset:560
    s_waitcnt vmcnt(11) lgkmcnt(9)
    v_fma_mix_f32 v64, v152, v48, v56 op_sel:[0,0,0] op_sel_hi:[1,0,0]
    v_fma_mix_f32 v65, v152, v49, v57 op_sel:[1,0,0] op_sel_hi:[1,0,0]
    v_fma_mix_f32 v66, v153, v50, v58 op_sel:[0,0,0] op_sel_hi:[1,0,0]
    v_fma_mix_f32 v67, v153, v51, v59 op_sel:[1,0,0] op_sel_hi:[1,0,0]
    s_waitcnt lgkmcnt(8)
    v_fma_mix_f32 v68, v154, v52, v60 op_sel:[0,0,0] op_sel_hi:[1,0,0]
    v_fma_mix_f32 v69, v154, v53, v61 op_sel:[1,0,0] op_sel_hi:[1,0,0]
    v_fma_mix_f32 v70, v155, v54, v62 op_sel:[0,0,0] op_sel_hi:[1,0,0]
    v_fma_mix_f32 v71, v155, v55, v63 op_sel:[1,0,0] op_sel_hi:[1,0,0]
    v_cvt_pk_bf16_f32 v80, v64, v65
    v_cvt_pk_bf16_f32 v81, v66, v67
    v_cvt_pk_bf16_f32 v82, v68, v69
    v_cvt_pk_bf16_f32 v83, v70, v71
    ds_write_b128 v16, v[80:83] offset:0
    s_waitcnt vmcnt(10)
    v_fma_mix_f32 v72, v156, v48, v56 op_sel:[0,0,0] op_sel_hi:[1,0,0]
    v_fma_mix_f32 v73, v156, v49, v57 op_sel:[1,0,0] op_sel_hi:[1,0,0]
    v_fma_mix_f32 v74, v157, v50, v58 op_sel:[0,0,0] op_sel_hi:[1,0,0]
    v_fma_mix_f32 v75, v157, v51, v59 op_sel:[1,0,0] op_sel_hi:[1,0,0]
    v_fma_mix_f32 v76, v158, v52, v60 op_sel:[0,0,0] op_sel_hi:[1,0,0]
    v_fma_mix_f32 v77, v158, v53, v61 op_sel:[1,0,0] op_sel_hi:[1,0,0]
    v_fma_mix_f32 v78, v159, v54, v62 op_sel:[0,0,0] op_sel_hi:[1,0,0]
    v_fma_mix_f32 v79, v159, v55, v63 op_sel:[1,0,0] op_sel_hi:[1,0,0]
    v_cvt_pk_bf16_f32 v84, v72, v73
    v_cvt_pk_bf16_f32 v85, v74, v75
    v_cvt_pk_bf16_f32 v86, v76, v77
    v_cvt_pk_bf16_f32 v87, v78, v79
    ds_write_b128 v16, v[84:87] offset:1024
    s_waitcnt vmcnt(9)
    v_fma_mix_f32 v64, v160, v48, v56 op_sel:[0,0,0] op_sel_hi:[1,0,0]
    v_fma_mix_f32 v65, v160, v49, v57 op_sel:[1,0,0] op_sel_hi:[1,0,0]
    v_fma_mix_f32 v66, v161, v50, v58 op_sel:[0,0,0] op_sel_hi:[1,0,0]
    v_fma_mix_f32 v67, v161, v51, v59 op_sel:[1,0,0] op_sel_hi:[1,0,0]
    v_fma_mix_f32 v68, v162, v52, v60 op_sel:[0,0,0] op_sel_hi:[1,0,0]
    v_fma_mix_f32 v69, v162, v53, v61 op_sel:[1,0,0] op_sel_hi:[1,0,0]
    v_fma_mix_f32 v70, v163, v54, v62 op_sel:[0,0,0] op_sel_hi:[1,0,0]
    v_fma_mix_f32 v71, v163, v55, v63 op_sel:[1,0,0] op_sel_hi:[1,0,0]
    v_cvt_pk_bf16_f32 v88, v64, v65
    v_cvt_pk_bf16_f32 v89, v66, v67
    v_cvt_pk_bf16_f32 v90, v68, v69
    v_cvt_pk_bf16_f32 v91, v70, v71
    ds_write_b128 v16, v[88:91] offset:2048
    s_waitcnt vmcnt(8)
    v_fma_mix_f32 v72, v164, v48, v56 op_sel:[0,0,0] op_sel_hi:[1,0,0]
    v_fma_mix_f32 v73, v164, v49, v57 op_sel:[1,0,0] op_sel_hi:[1,0,0]
    v_fma_mix_f32 v74, v165, v50, v58 op_sel:[0,0,0] op_sel_hi:[1,0,0]
    v_fma_mix_f32 v75, v165, v51, v59 op_sel:[1,0,0] op_sel_hi:[1,0,0]
    v_fma_mix_f32 v76, v166, v52, v60 op_sel:[0,0,0] op_sel_hi:[1,0,0]
    v_fma_mix_f32 v77, v166, v53, v61 op_sel:[1,0,0] op_sel_hi:[1,0,0]
    v_fma_mix_f32 v78, v167, v54, v62 op_sel:[0,0,0] op_sel_hi:[1,0,0]
    v_fma_mix_f32 v79, v167, v55, v63 op_sel:[1,0,0] op_sel_hi:[1,0,0]
    v_cvt_pk_bf16_f32 v92, v72, v73
    v_cvt_pk_bf16_f32 v93, v74, v75
    v_cvt_pk_bf16_f32 v94, v76, v77
    v_cvt_pk_bf16_f32 v95, v78, v79
    ds_write_b128 v16, v[92:95] offset:3072
    s_waitcnt lgkmcnt(8)
    s_barrier
    s_add_u32 s29, s26, 24576
    buffer_load_dwordx4 v[136:139], v5, s[12:15], s29 offen sc1
    s_add_u32 s29, s26, 65536
    buffer_load_dwordx4 v[140:143], v5, s[12:15], s29 offen sc1
    s_add_u32 s29, s26, 106496
    buffer_load_dwordx4 v[144:147], v5, s[12:15], s29 offen sc1
    s_add_u32 s29, s26, 147456
    buffer_load_dwordx4 v[148:151], v5, s[12:15], s29 offen sc1
    ds_read_b128 v[48:51], v15 offset:640
    ds_read_b128 v[52:55], v15 offset:656
    ds_read_b128 v[56:59], v15 offset:672
    ds_read_b128 v[60:63], v15 offset:688
    s_waitcnt vmcnt(11) lgkmcnt(9)
    v_fma_mix_f32 v64, v104, v32, v40 op_sel:[0,0,0] op_sel_hi:[1,0,0]
    v_fma_mix_f32 v65, v104, v33, v41 op_sel:[1,0,0] op_sel_hi:[1,0,0]
    v_fma_mix_f32 v66, v105, v34, v42 op_sel:[0,0,0] op_sel_hi:[1,0,0]
    v_fma_mix_f32 v67, v105, v35, v43 op_sel:[1,0,0] op_sel_hi:[1,0,0]
    s_waitcnt lgkmcnt(8)
    v_fma_mix_f32 v68, v106, v36, v44 op_sel:[0,0,0] op_sel_hi:[1,0,0]
    v_fma_mix_f32 v69, v106, v37, v45 op_sel:[1,0,0] op_sel_hi:[1,0,0]
    v_fma_mix_f32 v70, v107, v38, v46 op_sel:[0,0,0] op_sel_hi:[1,0,0]
    v_fma_mix_f32 v71, v107, v39, v47 op_sel:[1,0,0] op_sel_hi:[1,0,0]
    v_cvt_pk_bf16_f32 v80, v64, v65
    v_cvt_pk_bf16_f32 v81, v66, v67
    v_cvt_pk_bf16_f32 v82, v68, v69
    v_cvt_pk_bf16_f32 v83, v70, v71
    ds_write_b128 v16, v[80:83] offset:16384
    s_waitcnt vmcnt(10)
    v_fma_mix_f32 v72, v108, v32, v40 op_sel:[0,0,0] op_sel_hi:[1,0,0]
    v_fma_mix_f32 v73, v108, v33, v41 op_sel:[1,0,0] op_sel_hi:[1,0,0]
    v_fma_mix_f32 v74, v109, v34, v42 op_sel:[0,0,0] op_sel_hi:[1,0,0]
    v_fma_mix_f32 v75, v109, v35, v43 op_sel:[1,0,0] op_sel_hi:[1,0,0]
    v_fma_mix_f32 v76, v110, v36, v44 op_sel:[0,0,0] op_sel_hi:[1,0,0]
    v_fma_mix_f32 v77, v110, v37, v45 op_sel:[1,0,0] op_sel_hi:[1,0,0]
    v_fma_mix_f32 v78, v111, v38, v46 op_sel:[0,0,0] op_sel_hi:[1,0,0]
    v_fma_mix_f32 v79, v111, v39, v47 op_sel:[1,0,0] op_sel_hi:[1,0,0]
    v_cvt_pk_bf16_f32 v84, v72, v73
    v_cvt_pk_bf16_f32 v85, v74, v75
    v_cvt_pk_bf16_f32 v86, v76, v77
    v_cvt_pk_bf16_f32 v87, v78, v79
    ds_write_b128 v16, v[84:87] offset:17408
    s_waitcnt vmcnt(9)
    v_fma_mix_f32 v64, v112, v32, v40 op_sel:[0,0,0] op_sel_hi:[1,0,0]
    v_fma_mix_f32 v65, v112, v33, v41 op_sel:[1,0,0] op_sel_hi:[1,0,0]
    v_fma_mix_f32 v66, v113, v34, v42 op_sel:[0,0,0] op_sel_hi:[1,0,0]
    v_fma_mix_f32 v67, v113, v35, v43 op_sel:[1,0,0] op_sel_hi:[1,0,0]
    v_fma_mix_f32 v68, v114, v36, v44 op_sel:[0,0,0] op_sel_hi:[1,0,0]
    v_fma_mix_f32 v69, v114, v37, v45 op_sel:[1,0,0] op_sel_hi:[1,0,0]
    v_fma_mix_f32 v70, v115, v38, v46 op_sel:[0,0,0] op_sel_hi:[1,0,0]
    v_fma_mix_f32 v71, v115, v39, v47 op_sel:[1,0,0] op_sel_hi:[1,0,0]
    v_cvt_pk_bf16_f32 v88, v64, v65
    v_cvt_pk_bf16_f32 v89, v66, v67
    v_cvt_pk_bf16_f32 v90, v68, v69
    v_cvt_pk_bf16_f32 v91, v70, v71
    ds_write_b128 v16, v[88:91] offset:18432
    s_waitcnt vmcnt(8)
    v_fma_mix_f32 v72, v116, v32, v40 op_sel:[0,0,0] op_sel_hi:[1,0,0]
    v_fma_mix_f32 v73, v116, v33, v41 op_sel:[1,0,0] op_sel_hi:[1,0,0]
    v_fma_mix_f32 v74, v117, v34, v42 op_sel:[0,0,0] op_sel_hi:[1,0,0]
    v_fma_mix_f32 v75, v117, v35, v43 op_sel:[1,0,0] op_sel_hi:[1,0,0]
    v_fma_mix_f32 v76, v118, v36, v44 op_sel:[0,0,0] op_sel_hi:[1,0,0]
    v_fma_mix_f32 v77, v118, v37, v45 op_sel:[1,0,0] op_sel_hi:[1,0,0]
    v_fma_mix_f32 v78, v119, v38, v46 op_sel:[0,0,0] op_sel_hi:[1,0,0]
    v_fma_mix_f32 v79, v119, v39, v47 op_sel:[1,0,0] op_sel_hi:[1,0,0]
    v_cvt_pk_bf16_f32 v92, v72, v73
    v_cvt_pk_bf16_f32 v93, v74, v75
    v_cvt_pk_bf16_f32 v94, v76, v77
    v_cvt_pk_bf16_f32 v95, v78, v79
    ds_write_b128 v16, v[92:95] offset:19456
    s_waitcnt lgkmcnt(8)
    s_barrier
    s_add_u32 s29, s26, 28672
    buffer_load_dwordx4 v[152:155], v5, s[12:15], s29 offen sc1
    s_add_u32 s29, s26, 69632
    buffer_load_dwordx4 v[156:159], v5, s[12:15], s29 offen sc1
    s_add_u32 s29, s26, 110592
    buffer_load_dwordx4 v[160:163], v5, s[12:15], s29 offen sc1
    s_add_u32 s29, s26, 151552
    buffer_load_dwordx4 v[164:167], v5, s[12:15], s29 offen sc1
    ds_read_b128 v[32:35], v15 offset:768
    ds_read_b128 v[36:39], v15 offset:784
    ds_read_b128 v[40:43], v15 offset:800
    ds_read_b128 v[44:47], v15 offset:816
    s_waitcnt vmcnt(11) lgkmcnt(9)
    v_fma_mix_f32 v64, v120, v48, v56 op_sel:[0,0,0] op_sel_hi:[1,0,0]
    v_fma_mix_f32 v65, v120, v49, v57 op_sel:[1,0,0] op_sel_hi:[1,0,0]
    v_fma_mix_f32 v66, v121, v50, v58 op_sel:[0,0,0] op_sel_hi:[1,0,0]
    v_fma_mix_f32 v67, v121, v51, v59 op_sel:[1,0,0] op_sel_hi:[1,0,0]
    s_waitcnt lgkmcnt(8)
    v_fma_mix_f32 v68, v122, v52, v60 op_sel:[0,0,0] op_sel_hi:[1,0,0]
    v_fma_mix_f32 v69, v122, v53, v61 op_sel:[1,0,0] op_sel_hi:[1,0,0]
    v_fma_mix_f32 v70, v123, v54, v62 op_sel:[0,0,0] op_sel_hi:[1,0,0]
    v_fma_mix_f32 v71, v123, v55, v63 op_sel:[1,0,0] op_sel_hi:[1,0,0]
    v_cvt_pk_bf16_f32 v80, v64, v65
    v_cvt_pk_bf16_f32 v81, v66, v67
    v_cvt_pk_bf16_f32 v82, v68, v69
    v_cvt_pk_bf16_f32 v83, v70, v71
    ds_write_b128 v16, v[80:83] offset:32768
    s_waitcnt vmcnt(10)
    v_fma_mix_f32 v72, v124, v48, v56 op_sel:[0,0,0] op_sel_hi:[1,0,0]
    v_fma_mix_f32 v73, v124, v49, v57 op_sel:[1,0,0] op_sel_hi:[1,0,0]
    v_fma_mix_f32 v74, v125, v50, v58 op_sel:[0,0,0] op_sel_hi:[1,0,0]
    v_fma_mix_f32 v75, v125, v51, v59 op_sel:[1,0,0] op_sel_hi:[1,0,0]
    v_fma_mix_f32 v76, v126, v52, v60 op_sel:[0,0,0] op_sel_hi:[1,0,0]
    v_fma_mix_f32 v77, v126, v53, v61 op_sel:[1,0,0] op_sel_hi:[1,0,0]
    v_fma_mix_f32 v78, v127, v54, v62 op_sel:[0,0,0] op_sel_hi:[1,0,0]
    v_fma_mix_f32 v79, v127, v55, v63 op_sel:[1,0,0] op_sel_hi:[1,0,0]
    v_cvt_pk_bf16_f32 v84, v72, v73
    v_cvt_pk_bf16_f32 v85, v74, v75
    v_cvt_pk_bf16_f32 v86, v76, v77
    v_cvt_pk_bf16_f32 v87, v78, v79
    ds_write_b128 v16, v[84:87] offset:33792
    s_waitcnt vmcnt(9)
    v_fma_mix_f32 v64, v128, v48, v56 op_sel:[0,0,0] op_sel_hi:[1,0,0]
    v_fma_mix_f32 v65, v128, v49, v57 op_sel:[1,0,0] op_sel_hi:[1,0,0]
    v_fma_mix_f32 v66, v129, v50, v58 op_sel:[0,0,0] op_sel_hi:[1,0,0]
    v_fma_mix_f32 v67, v129, v51, v59 op_sel:[1,0,0] op_sel_hi:[1,0,0]
    v_fma_mix_f32 v68, v130, v52, v60 op_sel:[0,0,0] op_sel_hi:[1,0,0]
    v_fma_mix_f32 v69, v130, v53, v61 op_sel:[1,0,0] op_sel_hi:[1,0,0]
    v_fma_mix_f32 v70, v131, v54, v62 op_sel:[0,0,0] op_sel_hi:[1,0,0]
    v_fma_mix_f32 v71, v131, v55, v63 op_sel:[1,0,0] op_sel_hi:[1,0,0]
    v_cvt_pk_bf16_f32 v88, v64, v65
    v_cvt_pk_bf16_f32 v89, v66, v67
    v_cvt_pk_bf16_f32 v90, v68, v69
    v_cvt_pk_bf16_f32 v91, v70, v71
    ds_write_b128 v16, v[88:91] offset:34816
    s_waitcnt vmcnt(8)
    v_fma_mix_f32 v72, v132, v48, v56 op_sel:[0,0,0] op_sel_hi:[1,0,0]
    v_fma_mix_f32 v73, v132, v49, v57 op_sel:[1,0,0] op_sel_hi:[1,0,0]
    v_fma_mix_f32 v74, v133, v50, v58 op_sel:[0,0,0] op_sel_hi:[1,0,0]
    v_fma_mix_f32 v75, v133, v51, v59 op_sel:[1,0,0] op_sel_hi:[1,0,0]
    v_fma_mix_f32 v76, v134, v52, v60 op_sel:[0,0,0] op_sel_hi:[1,0,0]
    v_fma_mix_f32 v77, v134, v53, v61 op_sel:[1,0,0] op_sel_hi:[1,0,0]
    v_fma_mix_f32 v78, v135, v54, v62 op_sel:[0,0,0] op_sel_hi:[1,0,0]
    v_fma_mix_f32 v79, v135, v55, v63 op_sel:[1,0,0] op_sel_hi:[1,0,0]
    v_cvt_pk_bf16_f32 v92, v72, v73
    v_cvt_pk_bf16_f32 v93, v74, v75
    v_cvt_pk_bf16_f32 v94, v76, v77
    v_cvt_pk_bf16_f32 v95, v78, v79
    ds_write_b128 v16, v[92:95] offset:35840
    s_waitcnt lgkmcnt(8)
    s_barrier
    s_add_u32 s29, s26, 32768
    buffer_load_dwordx4 v[104:107], v5, s[12:15], s29 offen sc1
    s_add_u32 s29, s26, 73728
    buffer_load_dwordx4 v[108:111], v5, s[12:15], s29 offen sc1
    s_add_u32 s29, s26, 114688
    buffer_load_dwordx4 v[112:115], v5, s[12:15], s29 offen sc1
    s_add_u32 s29, s26, 155648
    buffer_load_dwordx4 v[116:119], v5, s[12:15], s29 offen sc1
    ds_read_b128 v[48:51], v15 offset:896
    ds_read_b128 v[52:55], v15 offset:912
    ds_read_b128 v[56:59], v15 offset:928
    ds_read_b128 v[60:63], v15 offset:944
    s_waitcnt vmcnt(11) lgkmcnt(9)
    v_fma_mix_f32 v64, v136, v32, v40 op_sel:[0,0,0] op_sel_hi:[1,0,0]
    v_fma_mix_f32 v65, v136, v33, v41 op_sel:[1,0,0] op_sel_hi:[1,0,0]
    v_fma_mix_f32 v66, v137, v34, v42 op_sel:[0,0,0] op_sel_hi:[1,0,0]
    v_fma_mix_f32 v67, v137, v35, v43 op_sel:[1,0,0] op_sel_hi:[1,0,0]
    s_waitcnt lgkmcnt(8)
    v_fma_mix_f32 v68, v138, v36, v44 op_sel:[0,0,0] op_sel_hi:[1,0,0]
    v_fma_mix_f32 v69, v138, v37, v45 op_sel:[1,0,0] op_sel_hi:[1,0,0]
    v_fma_mix_f32 v70, v139, v38, v46 op_sel:[0,0,0] op_sel_hi:[1,0,0]
    v_fma_mix_f32 v71, v139, v39, v47 op_sel:[1,0,0] op_sel_hi:[1,0,0]
    v_cvt_pk_bf16_f32 v80, v64, v65
    v_cvt_pk_bf16_f32 v81, v66, v67
    v_cvt_pk_bf16_f32 v82, v68, v69
    v_cvt_pk_bf16_f32 v83, v70, v71
    ds_write_b128 v16, v[80:83] offset:0
    s_waitcnt vmcnt(10)
    v_fma_mix_f32 v72, v140, v32, v40 op_sel:[0,0,0] op_sel_hi:[1,0,0]
    v_fma_mix_f32 v73, v140, v33, v41 op_sel:[1,0,0] op_sel_hi:[1,0,0]
    v_fma_mix_f32 v74, v141, v34, v42 op_sel:[0,0,0] op_sel_hi:[1,0,0]
    v_fma_mix_f32 v75, v141, v35, v43 op_sel:[1,0,0] op_sel_hi:[1,0,0]
    v_fma_mix_f32 v76, v142, v36, v44 op_sel:[0,0,0] op_sel_hi:[1,0,0]
    v_fma_mix_f32 v77, v142, v37, v45 op_sel:[1,0,0] op_sel_hi:[1,0,0]
    v_fma_mix_f32 v78, v143, v38, v46 op_sel:[0,0,0] op_sel_hi:[1,0,0]
    v_fma_mix_f32 v79, v143, v39, v47 op_sel:[1,0,0] op_sel_hi:[1,0,0]
    v_cvt_pk_bf16_f32 v84, v72, v73
    v_cvt_pk_bf16_f32 v85, v74, v75
    v_cvt_pk_bf16_f32 v86, v76, v77
    v_cvt_pk_bf16_f32 v87, v78, v79
    ds_write_b128 v16, v[84:87] offset:1024
    s_waitcnt vmcnt(9)
    v_fma_mix_f32 v64, v144, v32, v40 op_sel:[0,0,0] op_sel_hi:[1,0,0]
    v_fma_mix_f32 v65, v144, v33, v41 op_sel:[1,0,0] op_sel_hi:[1,0,0]
    v_fma_mix_f32 v66, v145, v34, v42 op_sel:[0,0,0] op_sel_hi:[1,0,0]
    v_fma_mix_f32 v67, v145, v35, v43 op_sel:[1,0,0] op_sel_hi:[1,0,0]
    v_fma_mix_f32 v68, v146, v36, v44 op_sel:[0,0,0] op_sel_hi:[1,0,0]
    v_fma_mix_f32 v69, v146, v37, v45 op_sel:[1,0,0] op_sel_hi:[1,0,0]
    v_fma_mix_f32 v70, v147, v38, v46 op_sel:[0,0,0] op_sel_hi:[1,0,0]
    v_fma_mix_f32 v71, v147, v39, v47 op_sel:[1,0,0] op_sel_hi:[1,0,0]
    v_cvt_pk_bf16_f32 v88, v64, v65
    v_cvt_pk_bf16_f32 v89, v66, v67
    v_cvt_pk_bf16_f32 v90, v68, v69
    v_cvt_pk_bf16_f32 v91, v70, v71
    ds_write_b128 v16, v[88:91] offset:2048
    s_waitcnt vmcnt(8)
    v_fma_mix_f32 v72, v148, v32, v40 op_sel:[0,0,0] op_sel_hi:[1,0,0]
    v_fma_mix_f32 v73, v148, v33, v41 op_sel:[1,0,0] op_sel_hi:[1,0,0]
    v_fma_mix_f32 v74, v149, v34, v42 op_sel:[0,0,0] op_sel_hi:[1,0,0]
    v_fma_mix_f32 v75, v149, v35, v43 op_sel:[1,0,0] op_sel_hi:[1,0,0]
    v_fma_mix_f32 v76, v150, v36, v44 op_sel:[0,0,0] op_sel_hi:[1,0,0]
    v_fma_mix_f32 v77, v150, v37, v45 op_sel:[1,0,0] op_sel_hi:[1,0,0]
    v_fma_mix_f32 v78, v151, v38, v46 op_sel:[0,0,0] op_sel_hi:[1,0,0]
    v_fma_mix_f32 v79, v151, v39, v47 op_sel:[1,0,0] op_sel_hi:[1,0,0]
    v_cvt_pk_bf16_f32 v92, v72, v73
    v_cvt_pk_bf16_f32 v93, v74, v75
    v_cvt_pk_bf16_f32 v94, v76, v77
    v_cvt_pk_bf16_f32 v95, v78, v79
    ds_write_b128 v16, v[92:95] offset:3072
    s_waitcnt lgkmcnt(8)
    s_barrier
    s_add_u32 s29, s26, 36864
    buffer_load_dwordx4 v[120:123], v5, s[12:15], s29 offen sc1
    s_add_u32 s29, s26, 77824
    buffer_load_dwordx4 v[124:127], v5, s[12:15], s29 offen sc1
    s_add_u32 s29, s26, 118784
    buffer_load_dwordx4 v[128:131], v5, s[12:15], s29 offen sc1
    s_add_u32 s29, s26, 159744
    buffer_load_dwordx4 v[132:135], v5, s[12:15], s29 offen sc1
    ds_read_b128 v[32:35], v15 offset:1024
    ds_read_b128 v[36:39], v15 offset:1040
    ds_read_b128 v[40:43], v15 offset:1056
    ds_read_b128 v[44:47], v15 offset:1072
    s_waitcnt vmcnt(11) lgkmcnt(9)
    v_fma_mix_f32 v64, v152, v48, v56 op_sel:[0,0,0] op_sel_hi:[1,0,0]
    v_fma_mix_f32 v65, v152, v49, v57 op_sel:[1,0,0] op_sel_hi:[1,0,0]
    v_fma_mix_f32 v66, v153, v50, v58 op_sel:[0,0,0] op_sel_hi:[1,0,0]
    v_fma_mix_f32 v67, v153, v51, v59 op_sel:[1,0,0] op_sel_hi:[1,0,0]
    s_waitcnt lgkmcnt(8)
    v_fma_mix_f32 v68, v154, v52, v60 op_sel:[0,0,0] op_sel_hi:[1,0,0]
    v_fma_mix_f32 v69, v154, v53, v61 op_sel:[1,0,0] op_sel_hi:[1,0,0]
    v_fma_mix_f32 v70, v155, v54, v62 op_sel:[0,0,0] op_sel_hi:[1,0,0]
    v_fma_mix_f32 v71, v155, v55, v63 op_sel:[1,0,0] op_sel_hi:[1,0,0]
    v_cvt_pk_bf16_f32 v80, v64, v65
    v_cvt_pk_bf16_f32 v81, v66, v67
    v_cvt_pk_bf16_f32 v82, v68, v69
    v_cvt_pk_bf16_f32 v83, v70, v71
    ds_write_b128 v16, v[80:83] offset:16384
    s_waitcnt vmcnt(10)
    v_fma_mix_f32 v72, v156, v48, v56 op_sel:[0,0,0] op_sel_hi:[1,0,0]
    v_fma_mix_f32 v73, v156, v49, v57 op_sel:[1,0,0] op_sel_hi:[1,0,0]
    v_fma_mix_f32 v74, v157, v50, v58 op_sel:[0,0,0] op_sel_hi:[1,0,0]
    v_fma_mix_f32 v75, v157, v51, v59 op_sel:[1,0,0] op_sel_hi:[1,0,0]
    v_fma_mix_f32 v76, v158, v52, v60 op_sel:[0,0,0] op_sel_hi:[1,0,0]
    v_fma_mix_f32 v77, v158, v53, v61 op_sel:[1,0,0] op_sel_hi:[1,0,0]
    v_fma_mix_f32 v78, v159, v54, v62 op_sel:[0,0,0] op_sel_hi:[1,0,0]
    v_fma_mix_f32 v79, v159, v55, v63 op_sel:[1,0,0] op_sel_hi:[1,0,0]
    v_cvt_pk_bf16_f32 v84, v72, v73
    v_cvt_pk_bf16_f32 v85, v74, v75
    v_cvt_pk_bf16_f32 v86, v76, v77
    v_cvt_pk_bf16_f32 v87, v78, v79
    ds_write_b128 v16, v[84:87] offset:17408
    s_waitcnt vmcnt(9)
    v_fma_mix_f32 v64, v160, v48, v56 op_sel:[0,0,0] op_sel_hi:[1,0,0]
    v_fma_mix_f32 v65, v160, v49, v57 op_sel:[1,0,0] op_sel_hi:[1,0,0]
    v_fma_mix_f32 v66, v161, v50, v58 op_sel:[0,0,0] op_sel_hi:[1,0,0]
    v_fma_mix_f32 v67, v161, v51, v59 op_sel:[1,0,0] op_sel_hi:[1,0,0]
    v_fma_mix_f32 v68, v162, v52, v60 op_sel:[0,0,0] op_sel_hi:[1,0,0]
    v_fma_mix_f32 v69, v162, v53, v61 op_sel:[1,0,0] op_sel_hi:[1,0,0]
    v_fma_mix_f32 v70, v163, v54, v62 op_sel:[0,0,0] op_sel_hi:[1,0,0]
    v_fma_mix_f32 v71, v163, v55, v63 op_sel:[1,0,0] op_sel_hi:[1,0,0]
    v_cvt_pk_bf16_f32 v88, v64, v65
    v_cvt_pk_bf16_f32 v89, v66, v67
    v_cvt_pk_bf16_f32 v90, v68, v69
    v_cvt_pk_bf16_f32 v91, v70, v71
    ds_write_b128 v16, v[88:91] offset:18432
    s_waitcnt vmcnt(8)
    v_fma_mix_f32 v72, v164, v48, v56 op_sel:[0,0,0] op_sel_hi:[1,0,0]
    v_fma_mix_f32 v73, v164, v49, v57 op_sel:[1,0,0] op_sel_hi:[1,0,0]
    v_fma_mix_f32 v74, v165, v50, v58 op_sel:[0,0,0] op_sel_hi:[1,0,0]
    v_fma_mix_f32 v75, v165, v51, v59 op_sel:[1,0,0] op_sel_hi:[1,0,0]
    v_fma_mix_f32 v76, v166, v52, v60 op_sel:[0,0,0] op_sel_hi:[1,0,0]
    v_fma_mix_f32 v77, v166, v53, v61 op_sel:[1,0,0] op_sel_hi:[1,0,0]
    v_fma_mix_f32 v78, v167, v54, v62 op_sel:[0,0,0] op_sel_hi:[1,0,0]
    v_fma_mix_f32 v79, v167, v55, v63 op_sel:[1,0,0] op_sel_hi:[1,0,0]
    v_cvt_pk_bf16_f32 v92, v72, v73
    v_cvt_pk_bf16_f32 v93, v74, v75
    v_cvt_pk_bf16_f32 v94, v76, v77
    v_cvt_pk_bf16_f32 v95, v78, v79
    ds_write_b128 v16, v[92:95] offset:19456
    s_waitcnt lgkmcnt(8)
    s_barrier
    s_mul_i32 s46, s22, 15
    s_add_u32 s46, s46, s23
    s_lshl_b32 s47, s46, 13
    v_lshlrev_b32 v168, 7, v2
    s_and_b32 s52, s2, 15
    s_lshl_b32 s52, s52, 14
    s_add_u32 s52, s52, 29626368
    s_cmp_eq_u32 s24, 9
    s_cselect_b32 s48, s96, s84
    s_cselect_b32 s49, s97, s85
    s_cselect_b32 s50, 1966080, s14
    s_cselect_b32 s47, s47, s52
    s_and_b32 s49, s49, 0xffff
    s_mov_b32 s51, 0x00020000
    s_cmp_eq_u32 s24, 1
    s_cselect_b32 s52, 8192, 0
    s_add_u32 s47, s47, s52
    buffer_load_dword v169, v168, s[48:51], s47 offen
    ds_read_b128 v[48:51], v15 offset:1152
    ds_read_b128 v[52:55], v15 offset:1168
    ds_read_b128 v[56:59], v15 offset:1184
    ds_read_b128 v[60:63], v15 offset:1200
    s_waitcnt vmcnt(8) lgkmcnt(9)
    v_fma_mix_f32 v64, v104, v32, v40 op_sel:[0,0,0] op_sel_hi:[1,0,0]
    v_fma_mix_f32 v65, v104, v33, v41 op_sel:[1,0,0] op_sel_hi:[1,0,0]
    v_fma_mix_f32 v66, v105, v34, v42 op_sel:[0,0,0] op_sel_hi:[1,0,0]
    v_fma_mix_f32 v67, v105, v35, v43 op_sel:[1,0,0] op_sel_hi:[1,0,0]
    s_waitcnt lgkmcnt(8)
    v_fma_mix_f32 v68, v106, v36, v44 op_sel:[0,0,0] op_sel_hi:[1,0,0]
    v_fma_mix_f32 v69, v106, v37, v45 op_sel:[1,0,0] op_sel_hi:[1,0,0]
    v_fma_mix_f32 v70, v107, v38, v46 op_sel:[0,0,0] op_sel_hi:[1,0,0]
    v_fma_mix_f32 v71, v107, v39, v47 op_sel:[1,0,0] op_sel_hi:[1,0,0]
    v_cvt_pk_bf16_f32 v80, v64, v65
    v_cvt_pk_bf16_f32 v81, v66, v67
    v_cvt_pk_bf16_f32 v82, v68, v69
    v_cvt_pk_bf16_f32 v83, v70, v71
    ds_write_b128 v16, v[80:83] offset:32768
    s_waitcnt vmcnt(7)
    v_fma_mix_f32 v72, v108, v32, v40 op_sel:[0,0,0] op_sel_hi:[1,0,0]
    v_fma_mix_f32 v73, v108, v33, v41 op_sel:[1,0,0] op_sel_hi:[1,0,0]
    v_fma_mix_f32 v74, v109, v34, v42 op_sel:[0,0,0] op_sel_hi:[1,0,0]
    v_fma_mix_f32 v75, v109, v35, v43 op_sel:[1,0,0] op_sel_hi:[1,0,0]
    v_fma_mix_f32 v76, v110, v36, v44 op_sel:[0,0,0] op_sel_hi:[1,0,0]
    v_fma_mix_f32 v77, v110, v37, v45 op_sel:[1,0,0] op_sel_hi:[1,0,0]
    v_fma_mix_f32 v78, v111, v38, v46 op_sel:[0,0,0] op_sel_hi:[1,0,0]
    v_fma_mix_f32 v79, v111, v39, v47 op_sel:[1,0,0] op_sel_hi:[1,0,0]
    v_cvt_pk_bf16_f32 v84, v72, v73
    v_cvt_pk_bf16_f32 v85, v74, v75
    v_cvt_pk_bf16_f32 v86, v76, v77
    v_cvt_pk_bf16_f32 v87, v78, v79
    ds_write_b128 v16, v[84:87] offset:33792
    s_waitcnt vmcnt(6)
    v_fma_mix_f32 v64, v112, v32, v40 op_sel:[0,0,0] op_sel_hi:[1,0,0]
    v_fma_mix_f32 v65, v112, v33, v41 op_sel:[1,0,0] op_sel_hi:[1,0,0]
    v_fma_mix_f32 v66, v113, v34, v42 op_sel:[0,0,0] op_sel_hi:[1,0,0]
    v_fma_mix_f32 v67, v113, v35, v43 op_sel:[1,0,0] op_sel_hi:[1,0,0]
    v_fma_mix_f32 v68, v114, v36, v44 op_sel:[0,0,0] op_sel_hi:[1,0,0]
    v_fma_mix_f32 v69, v114, v37, v45 op_sel:[1,0,0] op_sel_hi:[1,0,0]
    v_fma_mix_f32 v70, v115, v38, v46 op_sel:[0,0,0] op_sel_hi:[1,0,0]
    v_fma_mix_f32 v71, v115, v39, v47 op_sel:[1,0,0] op_sel_hi:[1,0,0]
    v_cvt_pk_bf16_f32 v88, v64, v65
    v_cvt_pk_bf16_f32 v89, v66, v67
    v_cvt_pk_bf16_f32 v90, v68, v69
    v_cvt_pk_bf16_f32 v91, v70, v71
    ds_write_b128 v16, v[88:91] offset:34816
    s_waitcnt vmcnt(5)
    v_fma_mix_f32 v72, v116, v32, v40 op_sel:[0,0,0] op_sel_hi:[1,0,0]
    v_fma_mix_f32 v73, v116, v33, v41 op_sel:[1,0,0] op_sel_hi:[1,0,0]
    v_fma_mix_f32 v74, v117, v34, v42 op_sel:[0,0,0] op_sel_hi:[1,0,0]
    v_fma_mix_f32 v75, v117, v35, v43 op_sel:[1,0,0] op_sel_hi:[1,0,0]
    v_fma_mix_f32 v76, v118, v36, v44 op_sel:[0,0,0] op_sel_hi:[1,0,0]
    v_fma_mix_f32 v77, v118, v37, v45 op_sel:[1,0,0] op_sel_hi:[1,0,0]
    v_fma_mix_f32 v78, v119, v38, v46 op_sel:[0,0,0] op_sel_hi:[1,0,0]
    v_fma_mix_f32 v79, v119, v39, v47 op_sel:[1,0,0] op_sel_hi:[1,0,0]
    v_cvt_pk_bf16_f32 v92, v72, v73
    v_cvt_pk_bf16_f32 v93, v74, v75
    v_cvt_pk_bf16_f32 v94, v76, v77
    v_cvt_pk_bf16_f32 v95, v78, v79
    ds_write_b128 v16, v[92:95] offset:35840
    s_waitcnt lgkmcnt(8)
    s_barrier
    s_waitcnt vmcnt(4) lgkmcnt(5)
    v_fma_mix_f32 v64, v120, v48, v56 op_sel:[0,0,0] op_sel_hi:[1,0,0]
    v_fma_mix_f32 v65, v120, v49, v57 op_sel:[1,0,0] op_sel_hi:[1,0,0]
    v_fma_mix_f32 v66, v121, v50, v58 op_sel:[0,0,0] op_sel_hi:[1,0,0]
    v_fma_mix_f32 v67, v121, v51, v59 op_sel:[1,0,0] op_sel_hi:[1,0,0]
    s_waitcnt lgkmcnt(4)
    v_fma_mix_f32 v68, v122, v52, v60 op_sel:[0,0,0] op_sel_hi:[1,0,0]
    v_fma_mix_f32 v69, v122, v53, v61 op_sel:[1,0,0] op_sel_hi:[1,0,0]
    v_fma_mix_f32 v70, v123, v54, v62 op_sel:[0,0,0] op_sel_hi:[1,0,0]
    v_fma_mix_f32 v71, v123, v55, v63 op_sel:[1,0,0] op_sel_hi:[1,0,0]
    v_cvt_pk_bf16_f32 v80, v64, v65
    v_cvt_pk_bf16_f32 v81, v66, v67
    v_cvt_pk_bf16_f32 v82, v68, v69
    v_cvt_pk_bf16_f32 v83, v70, v71
    ds_write_b128 v16, v[80:83] offset:0
    s_waitcnt vmcnt(3)
    v_fma_mix_f32 v72, v124, v48, v56 op_sel:[0,0,0] op_sel_hi:[1,0,0]
    v_fma_mix_f32 v73, v124, v49, v57 op_sel:[1,0,0] op_sel_hi:[1,0,0]
    v_fma_mix_f32 v74, v125, v50, v58 op_sel:[0,0,0] op_sel_hi:[1,0,0]
    v_fma_mix_f32 v75, v125, v51, v59 op_sel:[1,0,0] op_sel_hi:[1,0,0]
    v_fma_mix_f32 v76, v126, v52, v60 op_sel:[0,0,0] op_sel_hi:[1,0,0]
    v_fma_mix_f32 v77, v126, v53, v61 op_sel:[1,0,0] op_sel_hi:[1,0,0]
    v_fma_mix_f32 v78, v127, v54, v62 op_sel:[0,0,0] op_sel_hi:[1,0,0]
    v_fma_mix_f32 v79, v127, v55, v63 op_sel:[1,0,0] op_sel_hi:[1,0,0]
    v_cvt_pk_bf16_f32 v84, v72, v73
    v_cvt_pk_bf16_f32 v85, v74, v75
    v_cvt_pk_bf16_f32 v86, v76, v77
    v_cvt_pk_bf16_f32 v87, v78, v79
    ds_write_b128 v16, v[84:87] offset:1024
    s_waitcnt vmcnt(2)
    v_fma_mix_f32 v64, v128, v48, v56 op_sel:[0,0,0] op_sel_hi:[1,0,0]
    v_fma_mix_f32 v65, v128, v49, v57 op_sel:[1,0,0] op_sel_hi:[1,0,0]
    v_fma_mix_f32 v66, v129, v50, v58 op_sel:[0,0,0] op_sel_hi:[1,0,0]
    v_fma_mix_f32 v67, v129, v51, v59 op_sel:[1,0,0] op_sel_hi:[1,0,0]
    v_fma_mix_f32 v68, v130, v52, v60 op_sel:[0,0,0] op_sel_hi:[1,0,0]
    v_fma_mix_f32 v69, v130, v53, v61 op_sel:[1,0,0] op_sel_hi:[1,0,0]
    v_fma_mix_f32 v70, v131, v54, v62 op_sel:[0,0,0] op_sel_hi:[1,0,0]
    v_fma_mix_f32 v71, v131, v55, v63 op_sel:[1,0,0] op_sel_hi:[1,0,0]
    v_cvt_pk_bf16_f32 v88, v64, v65
    v_cvt_pk_bf16_f32 v89, v66, v67
    v_cvt_pk_bf16_f32 v90, v68, v69
    v_cvt_pk_bf16_f32 v91, v70, v71
    ds_write_b128 v16, v[88:91] offset:2048
    s_waitcnt vmcnt(1)
    v_fma_mix_f32 v72, v132, v48, v56 op_sel:[0,0,0] op_sel_hi:[1,0,0]
    v_fma_mix_f32 v73, v132, v49, v57 op_sel:[1,0,0] op_sel_hi:[1,0,0]
    v_fma_mix_f32 v74, v133, v50, v58 op_sel:[0,0,0] op_sel_hi:[1,0,0]
    v_fma_mix_f32 v75, v133, v51, v59 op_sel:[1,0,0] op_sel_hi:[1,0,0]
    v_fma_mix_f32 v76, v134, v52, v60 op_sel:[0,0,0] op_sel_hi:[1,0,0]
    v_fma_mix_f32 v77, v134, v53, v61 op_sel:[1,0,0] op_sel_hi:[1,0,0]
    v_fma_mix_f32 v78, v135, v54, v62 op_sel:[0,0,0] op_sel_hi:[1,0,0]
    v_fma_mix_f32 v79, v135, v55, v63 op_sel:[1,0,0] op_sel_hi:[1,0,0]
    v_cvt_pk_bf16_f32 v92, v72, v73
    v_cvt_pk_bf16_f32 v93, v74, v75
    v_cvt_pk_bf16_f32 v94, v76, v77
    v_cvt_pk_bf16_f32 v95, v78, v79
    ds_write_b128 v16, v[92:95] offset:3072
    s_waitcnt lgkmcnt(4)
    s_barrier
    s_waitcnt lgkmcnt(0)
    s_barrier
    s_branch L_sigb_p1
L_p1_idle:
    s_barrier
    v_mov_b32 v250, 0
    global_load_dword v252, v250, s[80:81] sc1
    s_mov_b32 s82, 0x200000
    v_mov_b32 v250, 0
L_tg_idle:
    s_waitcnt vmcnt(0)
    v_readfirstlane_b32 s83, v252
    s_nop 3
    s_cmp_lg_u32 s83, 0
    s_cbranch_scc1 L_tgd_idle
    global_load_dword v252, v250, s[80:81] sc1
    s_sub_u32 s82, s82, 1
    s_cmp_lg_u32 s82, 0
    s_cbranch_scc1 L_tg_idle
L_tgd_idle:
    s_cmp_eq_u32 s24, 3
    s_cbranch_scc1 L_p1_fin
    s_nop 0
    s_lshl_b32 s16, s24, 4
    s_add_u32 s16, s16, s22
    s_cmp_ge_u32 s16, 40
    s_cbranch_scc1 L_p1_done
    s_mul_i32 s17, s24, 20480
    s_mul_i32 s20, s16, 26
    s_lshr_b32 s20, s20, 8
    s_mul_i32 s21, s20, 10
    s_sub_u32 s21, s16, s21
    s_mul_i32 s25, s20, 204800
    s_lshl_b32 s26, s21, 7
    s_add_u32 s25, s25, s26
    v_lshrrev_b32 v8, 3, v2
    v_mul_u32_u24 v8, 1280, v8
    v_and_b32 v9, 7, v2
    v_lshl_add_u32 v8, v9, 4, v8
    s_mov_b32 s28, s90
    s_and_b32 s29, s91, 0xffff
    s_mov_b32 s30, 819200
    s_mov_b32 s31, 0x00020000
    s_add_u32 m0, s17, 0
    s_nop 0
    buffer_load_dwordx4 v8, s[28:31], s25 offen lds
    s_add_u32 s25, s25, 10240
    s_add_u32 m0, s17, 1024
    s_nop 0
    buffer_load_dwordx4 v8, s[28:31], s25 offen lds
    s_add_u32 s25, s25, 10240
    s_add_u32 m0, s17, 2048
    s_nop 0
    buffer_load_dwordx4 v8, s[28:31], s25 offen lds
    s_add_u32 s25, s25, 10240
    s_add_u32 m0, s17, 3072
    s_nop 0
    buffer_load_dwordx4 v8, s[28:31], s25 offen lds
    s_add_u32 s25, s25, 10240
    s_add_u32 m0, s17, 4096
    s_nop 0
    buffer_load_dwordx4 v8, s[28:31], s25 offen lds
    s_add_u32 s25, s25, 10240
    s_add_u32 m0, s17, 5120
    s_nop 0
    buffer_load_dwordx4 v8, s[28:31], s25 offen lds
    s_add_u32 s25, s25, 10240
    s_add_u32 m0, s17, 6144
    s_nop 0
    buffer_load_dwordx4 v8, s[28:31], s25 offen lds
    s_add_u32 s25, s25, 10240
    s_add_u32 m0, s17, 7168
    s_nop 0
    buffer_load_dwordx4 v8, s[28:31], s25 offen lds
    s_add_u32 s25, s25, 10240
    s_add_u32 m0, s17, 8192
    s_nop 0
    buffer_load_dwordx4 v8, s[28:31], s25 offen lds
    s_add_u32 s25, s25, 10240
    s_add_u32 m0, s17, 9216
    s_nop 0
    buffer_load_dwordx4 v8, s[28:31], s25 offen lds
    s_add_u32 s25, s25, 10240
    s_add_u32 m0, s17, 10240
    s_nop 0
    buffer_load_dwordx4 v8, s[28:31], s25 offen lds
    s_add_u32 s25, s25, 10240
    s_add_u32 m0, s17, 11264
    s_nop 0
    buffer_load_dwordx4 v8, s[28:31], s25 offen lds
    s_add_u32 s25, s25, 10240
    s_add_u32 m0, s17, 12288
    s_nop 0
    buffer_load_dwordx4 v8, s[28:31], s25 offen lds
    s_add_u32 s25, s25, 10240
    s_add_u32 m0, s17, 13312
    s_nop 0
    buffer_load_dwordx4 v8, s[28:31], s25 offen lds
    s_add_u32 s25, s25, 10240
    s_add_u32 m0, s17, 14336
    s_nop 0
    buffer_load_dwordx4 v8, s[28:31], s25 offen lds
    s_add_u32 s25, s25, 10240
    s_add_u32 m0, s17, 15360
    s_nop 0
    buffer_load_dwordx4 v8, s[28:31], s25 offen lds
    s_add_u32 s25, s25, 10240
    s_add_u32 m0, s17, 16384
    s_nop 0
    buffer_load_dwordx4 v8, s[28:31], s25 offen lds
    s_add_u32 s25, s25, 10240
    s_add_u32 m0, s17, 17408
    s_nop 0
    buffer_load_dwordx4 v8, s[28:31], s25 offen lds
    s_add_u32 s25, s25, 10240
    s_add_u32 m0, s17, 18432
    s_nop 0
    buffer_load_dwordx4 v8, s[28:31], s25 offen lds
    s_add_u32 s25, s25, 10240
    s_add_u32 m0, s17, 19456
    s_nop 0
    buffer_load_dwordx4 v8, s[28:31], s25 offen lds
    s_add_u32 s25, s25, 10240
    v_lshrrev_b32 v4, 4, v2
    v_bfe_u32 v5, v2, 2, 2
    v_and_b32 v6, 3, v2
    v_lshlrev_b32 v7, 4, v2
    v_add_u32 v9, 0, v4
    v_mul_u32_u24 v10, 52, v9
    v_lshrrev_b32 v10, 8, v10
    v_mul_u32_u24 v10, 20, v10
    v_lshl_add_u32 v10, v9, 2, v10
    v_add_u32 v10, v10, v5
    v_lshlrev_b32 v10, 7, v10
    v_lshl_add_u32 v10, v6, 3, v10
    v_add_u32 v12, s17, v10
    v_add_u32 v9, 4, v4
    v_mul_u32_u24 v10, 52, v9
    v_lshrrev_b32 v10, 8, v10
    v_mul_u32_u24 v10, 20, v10
    v_lshl_add_u32 v10, v9, 2, v10
    v_add_u32 v10, v10, v5
    v_lshlrev_b32 v10, 7, v10
    v_lshl_add_u32 v10, v6, 3, v10
    v_add_u32 v13, s17, v10
    v_add_u32 v9, 8, v4
    v_mul_u32_u24 v10, 52, v9
    v_lshrrev_b32 v10, 8, v10
    v_mul_u32_u24 v10, 20, v10
    v_lshl_add_u32 v10, v9, 2, v10
    v_add_u32 v10, v10, v5
    v_lshlrev_b32 v10, 7, v10
    v_lshl_add_u32 v10, v6, 3, v10
    v_add_u32 v14, s17, v10
    v_add_u32 v9, 12, v4
    v_mul_u32_u24 v10, 52, v9
    v_lshrrev_b32 v10, 8, v10
    v_mul_u32_u24 v10, 20, v10
    v_lshl_add_u32 v10, v9, 2, v10
    v_add_u32 v10, v10, v5
    v_lshlrev_b32 v10, 7, v10
    v_lshl_add_u32 v10, v6, 3, v10
    v_add_u32 v15, s17, v10
    v_add_u32 v9, 16, v4
    v_mul_u32_u24 v10, 52, v9
    v_lshrrev_b32 v10, 8, v10
    v_mul_u32_u24 v10, 20, v10
    v_lshl_add_u32 v10, v9, 2, v10
    v_add_u32 v10, v10, v5
    v_lshlrev_b32 v10, 7, v10
    v_lshl_add_u32 v10, v6, 3, v10
    v_add_u32 v16, s17, v10
    s_waitcnt vmcnt(0)
    s_mul_i32 s20, s20, 25600
    s_add_u32 s20, s20, 22413312
    s_lshl_b32 s21, s21, 2
    s_add_u32 s32, s21, 0
    s_mul_i32 s33, s32, 52
    s_lshr_b32 s33, s33, 8
    s_mul_i32 s34, s33, 5
    s_sub_u32 s34, s32, s34
    s_mul_i32 s33, s33, 102400
    s_lshl_b32 s34, s34, 10
    s_add_u32 s33, s33, s34
    s_add_u32 s33, s33, s20
    ds_read_b64_tr_b16 v[24:25], v12 offset:0
    ds_read_b64_tr_b16 v[26:27], v12 offset:2560
    ds_read_b64_tr_b16 v[28:29], v13 offset:0
    ds_read_b64_tr_b16 v[30:31], v13 offset:2560
    ds_read_b64_tr_b16 v[32:33], v14 offset:0
    ds_read_b64_tr_b16 v[34:35], v14 offset:2560
    ds_read_b64_tr_b16 v[36:37], v15 offset:0
    ds_read_b64_tr_b16 v[38:39], v15 offset:2560
    ds_read_b64_tr_b16 v[40:41], v16 offset:0
    ds_read_b64_tr_b16 v[42:43], v16 offset:2560
    s_waitcnt lgkmcnt(8)
    buffer_store_dwordx4 v[24:27], v7, s[12:15], s33 offen sc1
    s_add_u32 s33, s33, 5120
    s_waitcnt lgkmcnt(6)
    buffer_store_dwordx4 v[28:31], v7, s[12:15], s33 offen sc1
    s_add_u32 s33, s33, 5120
    s_waitcnt lgkmcnt(4)
    buffer_store_dwordx4 v[32:35], v7, s[12:15], s33 offen sc1
    s_add_u32 s33, s33, 5120
    s_waitcnt lgkmcnt(2)
    buffer_store_dwordx4 v[36:39], v7, s[12:15], s33 offen sc1
    s_add_u32 s33, s33, 5120
    s_waitcnt lgkmcnt(0)
    buffer_store_dwordx4 v[40:43], v7, s[12:15], s33 offen sc1
    s_add_u32 s32, s21, 1
    s_mul_i32 s33, s32, 52
    s_lshr_b32 s33, s33, 8
    s_mul_i32 s34, s33, 5
    s_sub_u32 s34, s32, s34
    s_mul_i32 s33, s33, 102400
    s_lshl_b32 s34, s34, 10
    s_add_u32 s33, s33, s34
    s_add_u32 s33, s33, s20
    ds_read_b64_tr_b16 v[44:45], v12 offset:32
    ds_read_b64_tr_b16 v[46:47], v12 offset:2592
    ds_read_b64_tr_b16 v[48:49], v13 offset:32
    ds_read_b64_tr_b16 v[50:51], v13 offset:2592
    ds_read_b64_tr_b16 v[52:53], v14 offset:32
    ds_read_b64_tr_b16 v[54:55], v14 offset:2592
    ds_read_b64_tr_b16 v[56:57], v15 offset:32
    ds_read_b64_tr_b16 v[58:59], v15 offset:2592
    ds_read_b64_tr_b16 v[60:61], v16 offset:32
    ds_read_b64_tr_b16 v[62:63], v16 offset:2592
    s_waitcnt lgkmcnt(8)
    buffer_store_dwordx4 v[44:47], v7, s[12:15], s33 offen sc1
    s_add_u32 s33, s33, 5120
    s_waitcnt lgkmcnt(6)
    buffer_store_dwordx4 v[48:51], v7, s[12:15], s33 offen sc1
    s_add_u32 s33, s33, 5120
    s_waitcnt lgkmcnt(4)
    buffer_store_dwordx4 v[52:55], v7, s[12:15], s33 offen sc1
    s_add_u32 s33, s33, 5120
    s_waitcnt lgkmcnt(2)
    buffer_store_dwordx4 v[56:59], v7, s[12:15], s33 offen sc1
    s_add_u32 s33, s33, 5120
    s_waitcnt lgkmcnt(0)
    buffer_store_dwordx4 v[60:63], v7, s[12:15], s33 offen sc1
    s_add_u32 s32, s21, 2
    s_mul_i32 s33, s32, 52
    s_lshr_b32 s33, s33, 8
    s_mul_i32 s34, s33, 5
    s_sub_u32 s34, s32, s34
    s_mul_i32 s33, s33, 102400
    s_lshl_b32 s34, s34, 10
    s_add_u32 s33, s33, s34
    s_add_u32 s33, s33, s20
    ds_read_b64_tr_b16 v[24:25], v12 offset:64
    ds_read_b64_tr_b16 v[26:27], v12 offset:2624
    ds_read_b64_tr_b16 v[28:29], v13 offset:64
    ds_read_b64_tr_b16 v[30:31], v13 offset:2624
    ds_read_b64_tr_b16 v[32:33], v14 offset:64
    ds_read_b64_tr_b16 v[34:35], v14 offset:2624
    ds_read_b64_tr_b16 v[36:37], v15 offset:64
    ds_read_b64_tr_b16 v[38:39], v15 offset:2624
    ds_read_b64_tr_b16 v[40:41], v16 offset:64
    ds_read_b64_tr_b16 v[42:43], v16 offset:2624
    s_waitcnt lgkmcnt(8)
    buffer_store_dwordx4 v[24:27], v7, s[12:15], s33 offen sc1
    s_add_u32 s33, s33, 5120
    s_waitcnt lgkmcnt(6)
    buffer_store_dwordx4 v[28:31], v7, s[12:15], s33 offen sc1
    s_add_u32 s33, s33, 5120
    s_waitcnt lgkmcnt(4)
    buffer_store_dwordx4 v[32:35], v7, s[12:15], s33 offen sc1
    s_add_u32 s33, s33, 5120
    s_waitcnt lgkmcnt(2)
    buffer_store_dwordx4 v[36:39], v7, s[12:15], s33 offen sc1
    s_add_u32 s33, s33, 5120
    s_waitcnt lgkmcnt(0)
    buffer_store_dwordx4 v[40:43], v7, s[12:15], s33 offen sc1
    s_add_u32 s32, s21, 3
    s_mul_i32 s33, s32, 52
    s_lshr_b32 s33, s33, 8
    s_mul_i32 s34, s33, 5
    s_sub_u32 s34, s32, s34
    s_mul_i32 s33, s33, 102400
    s_lshl_b32 s34, s34, 10
    s_add_u32 s33, s33, s34
    s_add_u32 s33, s33, s20
    ds_read_b64_tr_b16 v[44:45], v12 offset:96
    ds_read_b64_tr_b16 v[46:47], v12 offset:2656
    ds_read_b64_tr_b16 v[48:49], v13 offset:96
    ds_read_b64_tr_b16 v[50:51], v13 offset:2656
    ds_read_b64_tr_b16 v[52:53], v14 offset:96
    ds_read_b64_tr_b16 v[54:55], v14 offset:2656
    ds_read_b64_tr_b16 v[56:57], v15 offset:96
    ds_read_b64_tr_b16 v[58:59], v15 offset:2656
    ds_read_b64_tr_b16 v[60:61], v16 offset:96
    ds_read_b64_tr_b16 v[62:63], v16 offset:2656
    s_waitcnt lgkmcnt(8)
    buffer_store_dwordx4 v[44:47], v7, s[12:15], s33 offen sc1
    s_add_u32 s33, s33, 5120
    s_waitcnt lgkmcnt(6)
    buffer_store_dwordx4 v[48:51], v7, s[12:15], s33 offen sc1
    s_add_u32 s33, s33, 5120
    s_waitcnt lgkmcnt(4)
    buffer_store_dwordx4 v[52:55], v7, s[12:15], s33 offen sc1
    s_add_u32 s33, s33, 5120
    s_waitcnt lgkmcnt(2)
    buffer_store_dwordx4 v[56:59], v7, s[12:15], s33 offen sc1
    s_add_u32 s33, s33, 5120
    s_waitcnt lgkmcnt(0)
    buffer_store_dwordx4 v[60:63], v7, s[12:15], s33 offen sc1
    s_branch L_p1_done
L_p1_fin:
    v_add_u32 v6, 2688, v5
    s_cmp_lg_u32 s3, 3
    s_cbranch_scc1 L_wt_fin0
    s_and_b32 s82, s2, 15
    s_lshl_b32 s82, s82, 14
    s_add_u32 s82, s82, 29622272
    v_add_u32 v247, s82, v6
    s_mov_b32 s82, 0x200000
L_wl_fin0:
    global_load_dwordx4 v[248:251], v247, s[84:85] sc1
    s_waitcnt vmcnt(0)
    v_xor_b32 v248, s83, v248
    v_xor_b32 v249, s83, v249
    v_xor_b32 v250, s83, v250
    v_xor_b32 v251, s83, v251
    v_or3_b32 v248, v248, v249, v250
    v_or_b32 v248, v248, v251
    v_cmp_ne_u32 vcc, 0, v248
    s_nop 4
    s_cbranch_vccz L_wd_fin0
    s_sleep 16
    s_sub_u32 s82, s82, 1
    s_cmp_lg_u32 s82, 0
    s_cbranch_scc1 L_wl_fin0
L_wd_fin0:
    s_mov_b64 exec, -1
L_wt_fin0:
    s_nop 1
    v_add_u32 v6, 2944, v5
    s_cmp_lg_u32 s3, 3
    s_cbranch_scc1 L_wt_fin1
    s_and_b32 s82, s2, 15
    s_lshl_b32 s82, s82, 14
    s_add_u32 s82, s82, 29622272
    v_add_u32 v247, s82, v6
    s_mov_b32 s82, 0x200000
L_wl_fin1:
    global_load_dwordx4 v[248:251], v247, s[84:85] sc1
    s_waitcnt vmcnt(0)
    v_xor_b32 v248, s83, v248
    v_xor_b32 v249, s83, v249
    v_xor_b32 v250, s83, v250
    v_xor_b32 v251, s83, v251
    v_or3_b32 v248, v248, v249, v250
    v_or_b32 v248, v248, v251
    v_cmp_ne_u32 vcc, 0, v248
    s_nop 4
    s_cbranch_vccz L_wd_fin1
    s_sleep 16
    s_sub_u32 s82, s82, 1
    s_cmp_lg_u32 s82, 0
    s_cbranch_scc1 L_wl_fin1
L_wd_fin1:
    s_mov_b64 exec, -1
L_wt_fin1:
    s_nop 1
    s_mul_i32 s25, s22, 640
    s_add_u32 s26, s25, 29234176
    v_mov_b32 v7, 0x7ffffff0
    v_cmp_gt_u32 vcc, 40, v2
    s_nop 1
    v_cndmask_b32 v6, v7, v5, vcc
    buffer_load_dwordx4 v[32:35], v6, s[12:15], s26 offen sc1
    s_add_u32 s26, s26, 15360
    buffer_load_dwordx4 v[36:39], v6, s[12:15], s26 offen sc1
    s_add_u32 s26, s26, 15360
    buffer_load_dwordx4 v[40:43], v6, s[12:15], s26 offen sc1
    s_add_u32 s26, s26, 15360
    buffer_load_dwordx4 v[44:47], v6, s[12:15], s26 offen sc1
    s_add_u32 s26, s26, 15360
    buffer_load_dwordx4 v[48:51], v6, s[12:15], s26 offen sc1
    s_add_u32 s26, s26, 15360
    buffer_load_dwordx4 v[52:55], v6, s[12:15], s26 offen sc1
    s_add_u32 s26, s26, 15360
    buffer_load_dwordx4 v[56:59], v6, s[12:15], s26 offen sc1
    s_add_u32 s26, s26, 15360
    buffer_load_dwordx4 v[60:63], v6, s[12:15], s26 offen sc1
    s_waitcnt vmcnt(6)
    v_add_f32 v32, v32, v36
    v_add_f32 v33, v33, v37
    v_add_f32 v34, v34, v38
    v_add_f32 v35, v35, v39
    s_waitcnt vmcnt(5)
    v_add_f32 v32, v32, v40
    v_add_f32 v33, v33, v41
    v_add_f32 v34, v34, v42
    v_add_f32 v35, v35, v43
    s_waitcnt vmcnt(4)
    v_add_f32 v32, v32, v44
    v_add_f32 v33, v33, v45
    v_add_f32 v34, v34, v46
    v_add_f32 v35, v35, v47
    s_waitcnt vmcnt(3)
    v_add_f32 v32, v32, v48
    v_add_f32 v33, v33, v49
    v_add_f32 v34, v34, v50
    v_add_f32 v35, v35, v51
    s_waitcnt vmcnt(2)
    v_add_f32 v32, v32, v52
    v_add_f32 v33, v33, v53
    v_add_f32 v34, v34, v54
    v_add_f32 v35, v35, v55
    s_waitcnt vmcnt(1)
    v_add_f32 v32, v32, v56
    v_add_f32 v33, v33, v57
    v_add_f32 v34, v34, v58
    v_add_f32 v35, v35, v59
    s_waitcnt vmcnt(0)
    v_add_f32 v32, v32, v60
    v_add_f32 v33, v33, v61
    v_add_f32 v34, v34, v62
    v_add_f32 v35, v35, v63
    v_cvt_pk_bf16_f32 v32, v32, v32
    v_and_b32 v32, 0xffff0000, v32
    v_cvt_pk_bf16_f32 v33, v33, v33
    v_and_b32 v33, 0xffff0000, v33
    v_cvt_pk_bf16_f32 v34, v34, v34
    v_and_b32 v34, 0xffff0000, v34
    v_cvt_pk_bf16_f32 v35, v35, v35
    v_and_b32 v35, 0xffff0000, v35
    s_lshr_b32 s27, s22, 2
    s_cmp_lg_u32 s27, 2
    s_cbranch_scc1 L_p1_fin2
    v_add_f32 v32, 1.0, v32
    v_cvt_pk_bf16_f32 v32, v32, v32
    v_and_b32 v32, 0xffff0000, v32
    v_add_f32 v33, 1.0, v33
    v_cvt_pk_bf16_f32 v33, v33, v33
    v_and_b32 v33, 0xffff0000, v33
    v_add_f32 v34, 1.0, v34
    v_cvt_pk_bf16_f32 v34, v34, v34
    v_and_b32 v34, 0xffff0000, v34
    v_add_f32 v35, 1.0, v35
    v_cvt_pk_bf16_f32 v35, v35, v35
    v_and_b32 v35, 0xffff0000, v35
L_p1_fin2:
    s_nop 1
    s_add_u32 s26, s25, 5120
    buffer_store_dwordx4 v[32:35], v6, s[12:15], s26 offen sc1
L_p1_done:
    s_nop 11
    s_waitcnt vmcnt(0) lgkmcnt(0)
L_sigb_p1:
    s_barrier
    s_lshl_b32 s36, s22, 7
    s_lshl_b32 s37, s23, 2
    s_add_u32 s36, s36, s37
    s_add_u32 s36, s36, 4096
    s_cmp_lg_u32 s3, 0
    s_cbranch_scc1 L_sig_p1
    s_add_u32 s36, s36, 29622272
    v_lshlrev_b32 v250, 14, v2
    v_add_u32 v250, s36, v250
    v_mov_b32 v251, s83
    s_mov_b64 exec, 0xffff
    global_store_dword v250, v251, s[84:85] sc1
    s_mov_b64 exec, -1
L_sig_p1:
    s_nop 1
    s_cmp_lt_u32 s23, 15
    s_cbranch_scc1 L_p1_nofw
    s_lshl_b32 s36, s22, 2
    s_add_u32 s36, s36, 6144
    s_cmp_lg_u32 s3, 1
    s_cbranch_scc1 L_sig_p1w
    s_add_u32 s36, s36, 29622272
    v_lshlrev_b32 v250, 14, v2
    v_add_u32 v250, s36, v250
    v_mov_b32 v251, s83
    s_mov_b64 exec, 0xffff
    global_store_dword v250, v251, s[84:85] sc1
    s_mov_b64 exec, -1
L_sig_p1w:
    s_nop 1
L_p1_nofw:
    s_mov_b32 s61, s23
    s_and_b32 s20, s2, 7
    s_lshl_b32 s21, s20, 1
    s_bfe_u32 s20, s2, 0x10003
    s_add_u32 s21, s21, s20
    s_lshr_b32 s22, s2, 4
    s_mov_b32 s24, s3
    v_and_b32 v3, 15, v2
    v_lshrrev_b32 v4, 4, v2
    v_lshlrev_b32 v7, 4, v2
    s_lshl_b32 s25, s22, 3
    s_add_u32 s25, s25, s24
    s_mul_i32 s26, s21, 1280
    s_lshl_b32 s27, s22, 3
    s_mul_i32 s28, s24, 3
    s_add_u32 s27, s27, s28
    s_sub_u32 s27, s27, 16
    s_mul_i32 s28, s24, 3840
    v_add_u32 v12, 0, v2
    v_mul_u32_u24 v13, 820, v12
    v_lshrrev_b32 v13, 16, v13
    v_mul_u32_u24 v14, 80, v13
    v_sub_u32 v14, v12, v14
    v_add_u32 v13, s27, v13
    v_cmp_gt_i32 vcc, 0, v13
    v_mul_i32_i24 v13, 20480, v13
    v_lshl_add_u32 v13, v14, 4, v13
    v_mov_b32 v14, 0x7ffffff0
    v_cndmask_b32 v8, v13, v14, vcc
    v_add_u32 v12, 64, v2
    v_mul_u32_u24 v13, 820, v12
    v_lshrrev_b32 v13, 16, v13
    v_mul_u32_u24 v14, 80, v13
    v_sub_u32 v14, v12, v14
    v_add_u32 v13, s27, v13
    v_cmp_gt_i32 vcc, 0, v13
    v_mul_i32_i24 v13, 20480, v13
    v_lshl_add_u32 v13, v14, 4, v13
    v_mov_b32 v14, 0x7ffffff0
    v_cndmask_b32 v9, v13, v14, vcc
    v_add_u32 v12, 128, v2
    v_mul_u32_u24 v13, 820, v12
    v_lshrrev_b32 v13, 16, v13
    v_mul_u32_u24 v14, 80, v13
    v_sub_u32 v14, v12, v14
    v_add_u32 v13, s27, v13
    v_cmp_gt_i32 vcc, 0, v13
    v_mul_i32_i24 v13, 20480, v13
    v_lshl_add_u32 v13, v14, 4, v13
    v_mov_b32 v14, 0x7ffffff0
    v_cndmask_b32 v10, v13, v14, vcc
    v_add_u32 v12, 192, v2
    v_mul_u32_u24 v13, 820, v12
    v_lshrrev_b32 v13, 16, v13
    v_mul_u32_u24 v14, 80, v13
    v_sub_u32 v14, v12, v14
    v_add_u32 v13, s27, v13
    v_cmp_gt_i32 vcc, 0, v13
    v_mul_i32_i24 v13, 20480, v13
    v_lshl_add_u32 v13, v14, 4, v13
    v_mov_b32 v14, 0x7ffffff0
    v_cndmask_b32 v11, v13, v14, vcc
    s_mov_b32 s8, 6144
    s_lshl_b32 s9, s22, 7
    s_add_u32 s9, s9, 4096
    s_sub_u32 s10, s9, 128
    s_max_u32 s10, s10, 4096
    s_sub_u32 s11, s9, 256
    s_max_u32 s11, s11, 4096
    s_cmp_lg_u32 s3, 7
    s_cbranch_scc1 L_wt_p2w
    s_and_b32 s82, s2, 15
    s_lshl_b32 s82, s82, 14
    s_add_u32 s82, s82, 29622272
    s_add_u32 s4, s84, s82
    s_addc_u32 s5, s85, 0
    s_mov_b32 s6, s83
    s_mov_b32 s7, s83
    s_mov_b32 s82, 0x200000
L_wl_p2w:
    s_load_dwordx16 s[32:47], s[4:5], s8 glc
    s_waitcnt lgkmcnt(0)
    s_xor_b64 s[32:33], s[32:33], s[6:7]
    s_xor_b64 s[34:35], s[34:35], s[6:7]
    s_xor_b64 s[36:37], s[36:37], s[6:7]
    s_xor_b64 s[38:39], s[38:39], s[6:7]
    s_xor_b64 s[40:41], s[40:41], s[6:7]
    s_xor_b64 s[42:43], s[42:43], s[6:7]
    s_xor_b64 s[44:45], s[44:45], s[6:7]
    s_xor_b64 s[46:47], s[46:47], s[6:7]
    s_or_b64 s[32:33], s[32:33], s[34:35]
    s_or_b64 s[32:33], s[32:33], s[36:37]
    s_or_b64 s[32:33], s[32:33], s[38:39]
    s_or_b64 s[32:33], s[32:33], s[40:41]
    s_or_b64 s[32:33], s[32:33], s[42:43]
    s_or_b64 s[32:33], s[32:33], s[44:45]
    s_or_b64 s[32:33], s[32:33], s[46:47]
    s_cbranch_scc0 L_wt_p2w
    s_sleep 1
    s_sub_u32 s82, s82, 1
    s_cmp_lg_u32 s82, 0
    s_cbranch_scc1 L_wl_p2w
L_wt_p2w:
    s_nop 1
    s_cmp_lg_u32 s3, 7
    s_cbranch_scc1 L_wt_p2
    s_and_b32 s82, s2, 15
    s_lshl_b32 s82, s82, 14
    s_add_u32 s82, s82, 29622272
    s_add_u32 s4, s84, s82
    s_addc_u32 s5, s85, 0
    s_mov_b32 s6, s83
    s_mov_b32 s7, s83
    s_mov_b32 s82, 0x200000
L_wl_p2:
    s_load_dwordx16 s[32:47], s[4:5], s9 glc
    s_load_dwordx16 s[48:63], s[4:5], s10 glc
    s_load_dwordx16 s[64:79], s[4:5], s11 glc
    s_waitcnt lgkmcnt(0)
    s_xor_b64 s[32:33], s[32:33], s[6:7]
    s_xor_b64 s[34:35], s[34:35], s[6:7]
    s_xor_b64 s[36:37], s[36:37], s[6:7]
    s_xor_b64 s[38:39], s[38:39], s[6:7]
    s_xor_b64 s[40:41], s[40:41], s[6:7]
    s_xor_b64 s[42:43], s[42:43], s[6:7]
    s_xor_b64 s[44:45], s[44:45], s[6:7]
    s_xor_b64 s[46:47], s[46:47], s[6:7]
    s_xor_b64 s[48:49], s[48:49], s[6:7]
    s_xor_b64 s[50:51], s[50:51], s[6:7]
    s_xor_b64 s[52:53], s[52:53], s[6:7]
    s_xor_b64 s[54:55], s[54:55], s[6:7]
    s_xor_b64 s[56:57], s[56:57], s[6:7]
    s_xor_b64 s[58:59], s[58:59], s[6:7]
    s_xor_b64 s[60:61], s[60:61], s[6:7]
    s_xor_b64 s[62:63], s[62:63], s[6:7]
    s_xor_b64 s[64:65], s[64:65], s[6:7]
    s_xor_b64 s[66:67], s[66:67], s[6:7]
    s_xor_b64 s[68:69], s[68:69], s[6:7]
    s_xor_b64 s[70:71], s[70:71], s[6:7]
    s_xor_b64 s[72:73], s[72:73], s[6:7]
    s_xor_b64 s[74:75], s[74:75], s[6:7]
    s_xor_b64 s[76:77], s[76:77], s[6:7]
    s_xor_b64 s[78:79], s[78:79], s[6:7]
    s_or_b64 s[32:33], s[32:33], s[34:35]
    s_or_b64 s[32:33], s[32:33], s[36:37]
    s_or_b64 s[32:33], s[32:33], s[38:39]
    s_or_b64 s[32:33], s[32:33], s[40:41]
    s_or_b64 s[32:33], s[32:33], s[42:43]
    s_or_b64 s[32:33], s[32:33], s[44:45]
    s_or_b64 s[32:33], s[32:33], s[46:47]
    s_or_b64 s[32:33], s[32:33], s[48:49]
    s_or_b64 s[32:33], s[32:33], s[50:51]
    s_or_b64 s[32:33], s[32:33], s[52:53]
    s_or_b64 s[32:33], s[32:33], s[54:55]
    s_or_b64 s[32:33], s[32:33], s[56:57]
    s_or_b64 s[32:33], s[32:33], s[58:59]
    s_or_b64 s[32:33], s[32:33], s[60:61]
    s_or_b64 s[32:33], s[32:33], s[62:63]
    s_or_b64 s[32:33], s[32:33], s[64:65]
    s_or_b64 s[32:33], s[32:33], s[66:67]
    s_or_b64 s[32:33], s[32:33], s[68:69]
    s_or_b64 s[32:33], s[32:33], s[70:71]
    s_or_b64 s[32:33], s[32:33], s[72:73]
    s_or_b64 s[32:33], s[32:33], s[74:75]
    s_or_b64 s[32:33], s[32:33], s[76:77]
    s_or_b64 s[32:33], s[32:33], s[78:79]
    s_cbranch_scc0 L_wt_p2
    s_sleep 1
    s_sub_u32 s82, s82, 1
    s_cmp_lg_u32 s82, 0
    s_cbranch_scc1 L_wl_p2
L_wt_p2:
    s_nop 1
    s_barrier
    s_add_u32 s29, s26, 5390336
    s_add_u32 m0, s28, 0
    s_nop 0
    buffer_load_dwordx4 v8, s[12:15], s29 offen sc1 lds
    s_add_u32 m0, s28, 1024
    s_nop 0
    buffer_load_dwordx4 v9, s[12:15], s29 offen sc1 lds
    s_add_u32 m0, s28, 2048
    s_nop 0
    buffer_load_dwordx4 v10, s[12:15], s29 offen sc1 lds
    s_add_u32 m0, s28, 3072
    s_mov_b32 exec_hi, 0x0000ffff
    buffer_load_dwordx4 v11, s[12:15], s29 offen sc1 lds
    s_mov_b64 exec, -1
    v_min_u32 v12, 2, v4
    v_lshlrev_b32 v12, 8, v12
    v_lshl_add_u32 v12, v3, 4, v12
    s_mul_i32 s30, s25, 20480
    s_add_u32 s30, s30, s26
    s_add_u32 s30, s30, 2686976
    buffer_load_dwordx4 v[168:171], v12, s[12:15], s30 offen sc1
    buffer_load_dwordx4 v[172:175], v12, s[12:15], s30 offen offset:512 sc1
    s_lshr_b32 s31, s24, 2
    s_and_b32 s32, s24, 3
    s_lshl_b32 s33, s21, 1
    s_add_u32 s33, s33, s31
    s_mul_i32 s33, s33, 81920
    s_add_u32 s33, s33, 8028160
    s_mul_i32 s34, s22, 5120
    s_sub_u32 s34, s34, 10240
    s_lshl_b32 s35, s32, 12
    s_add_u32 s34, s34, s35
    s_mul_i32 s36, s31, 15360
    s_add_u32 s36, s36, s35
    s_add_u32 s36, s36, 30720
    v_mov_b32 v14, 0x7ffffff0
    v_add_u32 v13, s34, v7
    v_cmp_gt_i32 vcc, 0, v13
    s_nop 1
    v_cndmask_b32 v13, v13, v14, vcc
    s_add_u32 m0, s36, 0
    s_nop 0
    buffer_load_dwordx4 v13, s[12:15], s33 offen sc1 lds
    s_add_u32 s34, s34, 1024
    v_add_u32 v13, s34, v7
    v_cmp_gt_i32 vcc, 0, v13
    s_nop 1
    v_cndmask_b32 v13, v13, v14, vcc
    s_add_u32 m0, s36, 1024
    s_nop 0
    buffer_load_dwordx4 v13, s[12:15], s33 offen sc1 lds
    s_add_u32 s34, s34, 1024
    v_add_u32 v13, s34, v7
    v_cmp_gt_i32 vcc, 0, v13
    s_nop 1
    v_cndmask_b32 v13, v13, v14, vcc
    s_add_u32 m0, s36, 2048
    s_nop 0
    buffer_load_dwordx4 v13, s[12:15], s33 offen sc1 lds
    s_add_u32 s34, s34, 1024
    v_add_u32 v13, s34, v7
    v_cmp_gt_i32 vcc, 0, v13
    s_nop 1
    v_cndmask_b32 v13, v13, v14, vcc
    s_add_u32 m0, s36, 3072
    s_cmp_eq_u32 s32, 3
    s_cbranch_scc1 L_p2_v3
    buffer_load_dwordx4 v13, s[12:15], s33 offen sc1 lds
L_p2_v3:
    s_and_b32 s31, s24, 6
    s_mul_i32 s32, s31, 1280
    v_add_u32 v8, s32, v12
    s_mul_i32 s32, s31, 640
    s_add_u32 s32, s32, 30720
    v_add_u32 v9, s32, v7
    v_and_b32 v11, 3, v3
    v_lshl_add_u32 v11, v4, 2, v11
    v_lshlrev_b32 v11, 4, v11
    v_add_u32 v11, s32, v11
    v_cmp_gt_u32 s[48:49], 4, v3
    v_mov_b32 v18, 0x3f803f80
    v_lshlrev_b32 v13, 2, v4
    s_and_b32 s33, s24, 1
    v_add_u32 v14, 0, v13
    v_cmp_le_u32 s[4:5], v14, v3
    s_nop 1
    s_not_b64 s[6:7], s[4:5]
    s_cmp_eq_u32 s33, 0
    s_cselect_b64 s[50:51], s[6:7], 0
    s_cselect_b64 s[58:59], -1, s[6:7]
    s_cselect_b64 s[66:67], s[4:5], -1
    s_cselect_b64 s[74:75], 0, s[4:5]
    v_add_u32 v14, 1, v13
    v_cmp_le_u32 s[4:5], v14, v3
    s_nop 1
    s_not_b64 s[6:7], s[4:5]
    s_cmp_eq_u32 s33, 0
    s_cselect_b64 s[52:53], s[6:7], 0
    s_cselect_b64 s[60:61], -1, s[6:7]
    s_cselect_b64 s[68:69], s[4:5], -1
    s_cselect_b64 s[76:77], 0, s[4:5]
    v_add_u32 v14, 2, v13
    v_cmp_le_u32 s[4:5], v14, v3
    s_nop 1
    s_not_b64 s[6:7], s[4:5]
    s_cmp_eq_u32 s33, 0
    s_cselect_b64 s[54:55], s[6:7], 0
    s_cselect_b64 s[62:63], -1, s[6:7]
    s_cselect_b64 s[70:71], s[4:5], -1
    s_cselect_b64 s[78:79], 0, s[4:5]
    v_add_u32 v14, 3, v13
    v_cmp_le_u32 s[4:5], v14, v3
    s_nop 1
    s_not_b64 s[6:7], s[4:5]
    s_cmp_eq_u32 s33, 0
    s_cselect_b64 s[56:57], s[6:7], 0
    s_cselect_b64 s[64:65], -1, s[6:7]
    s_cselect_b64 s[72:73], s[4:5], -1
    s_cselect_b64 s[80:81], 0, s[4:5]
    s_mul_i32 s35, s25, 20480
    s_add_u32 s35, s35, s26
    s_add_u32 s35, s35, 10747904
    v_lshlrev_b32 v15, 8, v4
    v_lshl_add_u32 v15, v3, 4, v15
    v_lshlrev_b32 v16, 4, v3
    v_mov_b32 v10, 0x7ffffff0
    v_cmp_gt_u32 vcc, 16, v2
    s_nop 1
    v_cndmask_b32 v16, v10, v16, vcc
    s_mov_b32 s36, 0x3ea52b5c
    v_mov_b32 v17, 0xf149f2ca
    v_cmp_gt_u32 s[4:5], 2, v4
    v_cmp_gt_u32 s[6:7], 3, v4
    v_cmp_ne_u32 s[8:9], 0, v4
    s_nop 1
    s_and_b64 s[8:9], s[8:9], s[6:7]
    s_waitcnt vmcnt(3)
    v_cndmask_b32 v168, 0, v168, s[6:7]
    v_cndmask_b32 v169, 0, v169, s[6:7]
    v_cndmask_b32 v170, 0, v170, s[4:5]
    v_cndmask_b32 v171, 0, v171, s[4:5]
    v_cndmask_b32 v172, 0, v172, s[8:9]
    v_cndmask_b32 v173, 0, v173, s[8:9]
    v_cndmask_b32 v174, 0, v174, s[6:7]
    v_cndmask_b32 v175, 0, v175, s[6:7]
    s_barrier
    ds_read_b128 v[176:179], v8 offset:0
    ds_read_b128 v[180:183], v8 offset:1280
    ds_read_b128 v[184:187], v8 offset:2560
    ds_read_b128 v[188:191], v8 offset:3840
    s_waitcnt lgkmcnt(3)
    v_mfma_f32_16x16x32_bf16 v[24:27], v[176:179], v[168:171], 0
    ds_read_b128 v[176:179], v8 offset:5120
    s_waitcnt lgkmcnt(3)
    v_mfma_f32_16x16x32_bf16 v[28:31], v[180:183], v[168:171], 0
    ds_read_b128 v[180:183], v8 offset:6400
    s_waitcnt lgkmcnt(3)
    v_mfma_f32_16x16x32_bf16 v[32:35], v[184:187], v[168:171], 0
    ds_read_b128 v[184:187], v8 offset:7680
    s_waitcnt lgkmcnt(3)
    v_mfma_f32_16x16x32_bf16 v[36:39], v[188:191], v[168:171], 0
    ds_read_b128 v[188:191], v8 offset:8960
    s_waitcnt lgkmcnt(3)
    v_mfma_f32_16x16x32_bf16 v[40:43], v[176:179], v[168:171], 0
    ds_read_b128 v[176:179], v8 offset:10240
    s_waitcnt lgkmcnt(3)
    v_mfma_f32_16x16x32_bf16 v[44:47], v[180:183], v[168:171], 0
    ds_read_b128 v[180:183], v8 offset:11520
    s_waitcnt lgkmcnt(3)
    v_mfma_f32_16x16x32_bf16 v[48:51], v[184:187], v[168:171], 0
    ds_read_b128 v[184:187], v8 offset:12800
    s_waitcnt lgkmcnt(3)
    v_mfma_f32_16x16x32_bf16 v[52:55], v[188:191], v[168:171], 0
    ds_read_b128 v[188:191], v8 offset:14080
    s_waitcnt lgkmcnt(3)
    v_mfma_f32_16x16x32_bf16 v[56:59], v[176:179], v[168:171], 0
    ds_read_b128 v[176:179], v8 offset:15360
    s_waitcnt lgkmcnt(3)
    v_mfma_f32_16x16x32_bf16 v[60:63], v[180:183], v[168:171], 0
    ds_read_b128 v[180:183], v8 offset:16640
    s_waitcnt lgkmcnt(3)
    v_mfma_f32_16x16x32_bf16 v[64:67], v[184:187], v[168:171], 0
    ds_read_b128 v[184:187], v8 offset:17920
    s_waitcnt lgkmcnt(3)
    v_mfma_f32_16x16x32_bf16 v[68:71], v[188:191], v[168:171], 0
    ds_read_b128 v[188:191], v8 offset:19200
    s_waitcnt lgkmcnt(3)
    v_mfma_f32_16x16x32_bf16 v[72:75], v[176:179], v[168:171], 0
    ds_read_b128 v[176:179], v8 offset:20480
    s_waitcnt lgkmcnt(3)
    v_mfma_f32_16x16x32_bf16 v[76:79], v[180:183], v[168:171], 0
    ds_read_b128 v[180:183], v8 offset:21760
    s_waitcnt lgkmcnt(3)
    v_mfma_f32_16x16x32_bf16 v[80:83], v[184:187], v[168:171], 0
    s_waitcnt lgkmcnt(2)
    v_mfma_f32_16x16x32_bf16 v[84:87], v[188:191], v[168:171], 0
    s_waitcnt lgkmcnt(1)
    v_mfma_f32_16x16x32_bf16 v[88:91], v[176:179], v[168:171], 0
    s_waitcnt lgkmcnt(0)
    v_mfma_f32_16x16x32_bf16 v[92:95], v[180:183], v[168:171], 0
    s_waitcnt vmcnt(0)
    s_barrier
    s_cmp_ge_u32 s24, 4
    s_cbranch_scc1 L_p2_rpB
    s_cmp_ge_u32 s2, 240
    s_cbranch_scc1 L_p2_norp1
    s_mov_b32 s28, s92
    s_and_b32 s29, s93, 0xffff
    s_mov_b32 s30, 1966080
    s_mov_b32 s31, 0x00020000
    s_mov_b32 s4, s94
    s_and_b32 s5, s95, 0xffff
    s_mov_b32 s6, 1966080
    s_mov_b32 s7, 0x00020000
    s_mul_i32 s41, s2, 2731
    s_lshr_b32 s41, s41, 16
    s_mul_i32 s42, s41, 24
    s_sub_u32 s42, s2, s42
    s_lshl_b32 s40, s41, 2
    s_add_u32 s40, s40, s24
    s_mul_i32 s40, s40, 49152
    s_lshl_b32 s43, s42, 7
    s_add_u32 s40, s40, s43
    s_add_u32 s43, s40, 24576
    s_lshl_b32 s44, s24, 12
    v_lshrrev_b32 v100, 3, v2
    v_mul_u32_u24 v100, 3072, v100
    v_and_b32 v101, 7, v2
    v_lshl_add_u32 v100, v101, 4, v100
    s_add_u32 m0, s44, 131072
    s_nop 0
    buffer_load_dwordx4 v100, s[28:31], s40 offen lds
    s_add_u32 m0, s44, 132096
    s_nop 0
    buffer_load_dwordx4 v100, s[28:31], s43 offen lds
    s_add_u32 m0, s44, 133120
    s_nop 0
    buffer_load_dwordx4 v100, s[4:7], s40 offen lds
    s_add_u32 m0, s44, 134144
    s_nop 0
    buffer_load_dwordx4 v100, s[4:7], s43 offen lds
    v_and_b32 v100, 15, v2
    v_lshlrev_b32 v100, 4, v100
    v_bfe_u32 v101, v2, 4, 1
    v_mul_u32_u24 v101, 2560, v101
    v_add_u32 v100, v100, v101
    s_lshl_b32 s44, s41, 8
    s_add_u32 s44, s44, 7680
    s_mov_b32 m0, 155648
    s_nop 0
    buffer_load_dwordx4 v100, s[12:15], s44 offen sc1 lds
    s_branch L_p2_norp1
L_p2_rpB:
    s_sub_u32 s16, s24, 4
    s_lshl_b32 s16, s16, 8
    s_add_u32 s16, s16, s2
    s_add_u32 s16, s16, 200
    s_lshl_b32 s17, s24, 12
    s_add_u32 s17, s17, 131072
    s_cmp_ge_u32 s16, 680
    s_cbranch_scc1 L_p2_norp1
    s_mov_b32 s28, s96
    s_and_b32 s29, s97, 0xffff
    s_mov_b32 s30, 1966080
    s_mov_b32 s31, 0x00020000
    s_cmp_lt_u32 s16, 200
    s_cselect_b32 s44, s28, s28
    s_cselect_b32 s45, s29, s29
    s_cselect_b32 s46, s30, s30
    s_mov_b32 s47, 0x00020000
    s_cselect_b32 s40, 0, 200
    s_sub_u32 s40, s16, s40
    s_mul_i32 s41, s40, 6554
    s_lshr_b32 s41, s41, 16
    s_mul_i32 s42, s41, 10
    s_sub_u32 s42, s40, s42
    s_mul_i32 s40, s41, 40960
    s_lshl_b32 s43, s42, 7
    s_add_u32 s40, s40, s43
    v_lshrrev_b32 v100, 3, v2
    v_mul_u32_u24 v100, 1280, v100
    v_and_b32 v101, 7, v2
    v_lshl_add_u32 v100, v101, 4, v100
    s_add_u32 m0, s17, 0
    s_nop 0
    buffer_load_dwordx4 v100, s[44:47], s40 offen lds
    s_add_u32 s40, s40, 10240
    s_add_u32 m0, s17, 1024
    s_nop 0
    buffer_load_dwordx4 v100, s[44:47], s40 offen lds
    s_add_u32 s40, s40, 10240
    s_add_u32 m0, s17, 2048
    s_nop 0
    buffer_load_dwordx4 v100, s[44:47], s40 offen lds
    s_add_u32 s40, s40, 10240
    s_add_u32 m0, s17, 3072
    s_nop 0
    buffer_load_dwordx4 v100, s[44:47], s40 offen lds
L_p2_norp1:
    s_nop 3
    s_lshr_b32 s38, s2, 3
    s_mul_i32 s38, s38, 25600
    s_bfe_u32 s39, s2, 0x10002
    s_mul_i32 s39, s39, 0
    s_add_u32 s38, s38, s39
    s_add_u32 s38, s38, 22413312
    v_add_u32 v104, 0, v0
    v_lshlrev_b32 v105, 7, v104
    v_cmp_gt_u32 vcc, 200, v104
    v_mov_b32 v106, 0x7ffffff0
    s_nop 0
    v_cndmask_b32 v105, v106, v105, vcc
    buffer_load_dword v200, v105, s[12:15], s38 offen
    s_nop 9
    s_cmp_ge_u32 s22, 2
    s_cbranch_scc1 L_p2_fix0
    s_and_b32 s37, s25, 0xfffe
    s_sub_u32 s37, 16, s37
    s_cmp_le_i32 s37, 0
    s_cbranch_scc1 L_p2_fix0
    v_mov_b32 v24, v17
    v_mov_b32 v25, v17
    v_mov_b32 v26, v17
    v_mov_b32 v27, v17
    s_cmp_le_i32 s37, 1
    s_cbranch_scc1 L_p2_fix0
    v_mov_b32 v28, v17
    v_mov_b32 v29, v17
    v_mov_b32 v30, v17
    v_mov_b32 v31, v17
    s_cmp_le_i32 s37, 2
    s_cbranch_scc1 L_p2_fix0
    v_mov_b32 v32, v17
    v_mov_b32 v33, v17
    v_mov_b32 v34, v17
    v_mov_b32 v35, v17
    s_cmp_le_i32 s37, 3
    s_cbranch_scc1 L_p2_fix0
    v_mov_b32 v36, v17
    v_mov_b32 v37, v17
    v_mov_b32 v38, v17
    v_mov_b32 v39, v17
    s_cmp_le_i32 s37, 4
    s_cbranch_scc1 L_p2_fix0
    v_mov_b32 v40, v17
    v_mov_b32 v41, v17
    v_mov_b32 v42, v17
    v_mov_b32 v43, v17
    s_cmp_le_i32 s37, 5
    s_cbranch_scc1 L_p2_fix0
    v_mov_b32 v44, v17
    v_mov_b32 v45, v17
    v_mov_b32 v46, v17
    v_mov_b32 v47, v17
    s_cmp_le_i32 s37, 6
    s_cbranch_scc1 L_p2_fix0
    v_mov_b32 v48, v17
    v_mov_b32 v49, v17
    v_mov_b32 v50, v17
    v_mov_b32 v51, v17
    s_cmp_le_i32 s37, 7
    s_cbranch_scc1 L_p2_fix0
    v_mov_b32 v52, v17
    v_mov_b32 v53, v17
    v_mov_b32 v54, v17
    v_mov_b32 v55, v17
    s_cmp_le_i32 s37, 8
    s_cbranch_scc1 L_p2_fix0
    v_mov_b32 v56, v17
    v_mov_b32 v57, v17
    v_mov_b32 v58, v17
    v_mov_b32 v59, v17
    s_cmp_le_i32 s37, 9
    s_cbranch_scc1 L_p2_fix0
    v_mov_b32 v60, v17
    v_mov_b32 v61, v17
    v_mov_b32 v62, v17
    v_mov_b32 v63, v17
    s_cmp_le_i32 s37, 10
    s_cbranch_scc1 L_p2_fix0
    v_mov_b32 v64, v17
    v_mov_b32 v65, v17
    v_mov_b32 v66, v17
    v_mov_b32 v67, v17
    s_cmp_le_i32 s37, 11
    s_cbranch_scc1 L_p2_fix0
    v_mov_b32 v68, v17
    v_mov_b32 v69, v17
    v_mov_b32 v70, v17
    v_mov_b32 v71, v17
    s_cmp_le_i32 s37, 12
    s_cbranch_scc1 L_p2_fix0
    v_mov_b32 v72, v17
    v_mov_b32 v73, v17
    v_mov_b32 v74, v17
    v_mov_b32 v75, v17
    s_cmp_le_i32 s37, 13
    s_cbranch_scc1 L_p2_fix0
    v_mov_b32 v76, v17
    v_mov_b32 v77, v17
    v_mov_b32 v78, v17
    v_mov_b32 v79, v17
    s_cmp_le_i32 s37, 14
    s_cbranch_scc1 L_p2_fix0
    v_mov_b32 v80, v17
    v_mov_b32 v81, v17
    v_mov_b32 v82, v17
    v_mov_b32 v83, v17
    s_cmp_le_i32 s37, 15
    s_cbranch_scc1 L_p2_fix0
    v_mov_b32 v84, v17
    v_mov_b32 v85, v17
    v_mov_b32 v86, v17
    v_mov_b32 v87, v17
L_p2_fix0:
    s_nop 1
    v_cndmask_b32 v24, v17, v24, s[50:51]
    v_cndmask_b32 v25, v17, v25, s[52:53]
    v_cndmask_b32 v26, v17, v26, s[54:55]
    v_cndmask_b32 v27, v17, v27, s[56:57]
    v_cndmask_b32 v28, v17, v28, s[58:59]
    v_cndmask_b32 v29, v17, v29, s[60:61]
    ds_read_b128 v[176:179], v8 offset:512
    v_cndmask_b32 v30, v17, v30, s[62:63]
    v_cndmask_b32 v31, v17, v31, s[64:65]
    v_cndmask_b32 v88, v17, v88, s[66:67]
    v_cndmask_b32 v89, v17, v89, s[68:69]
    v_cndmask_b32 v90, v17, v90, s[70:71]
    v_cndmask_b32 v91, v17, v91, s[72:73]
    v_cndmask_b32 v92, v17, v92, s[74:75]
    ds_read_b128 v[180:183], v8 offset:1792
    v_cndmask_b32 v93, v17, v93, s[76:77]
    v_cndmask_b32 v94, v17, v94, s[78:79]
    v_cndmask_b32 v95, v17, v95, s[80:81]
    v_max_f32 v192, v24, v25
    v_max_f32 v193, v42, v43
    v_max_f32 v194, v60, v61
    v_max_f32 v195, v78, v79
    ds_read_b128 v[184:187], v8 offset:3072
    v_max3_f32 v192, v192, v26, v27
    v_max3_f32 v193, v193, v44, v45
    v_max3_f32 v194, v194, v62, v63
    v_max3_f32 v195, v195, v80, v81
    v_max3_f32 v192, v192, v28, v29
    v_max3_f32 v193, v193, v46, v47
    ds_read_b128 v[188:191], v8 offset:4352
    v_max3_f32 v194, v194, v64, v65
    v_max3_f32 v195, v195, v82, v83
    v_max3_f32 v192, v192, v30, v31
    v_max3_f32 v193, v193, v48, v49
    v_max3_f32 v194, v194, v66, v67
    v_max3_f32 v195, v195, v84, v85
    v_max3_f32 v192, v192, v32, v33
    s_waitcnt lgkmcnt(3)
    v_mfma_f32_16x16x32_bf16 v[96:99], v[176:179], v[172:175], 0
    v_max3_f32 v193, v193, v50, v51
    v_max3_f32 v194, v194, v68, v69
    v_max3_f32 v195, v195, v86, v87
    v_max3_f32 v192, v192, v34, v35
    v_max3_f32 v193, v193, v52, v53
    v_max3_f32 v194, v194, v70, v71
    v_max3_f32 v195, v195, v88, v89
    ds_read_b128 v[176:179], v8 offset:5632
    v_max3_f32 v192, v192, v36, v37
    v_max3_f32 v193, v193, v54, v55
    v_max3_f32 v194, v194, v72, v73
    v_max3_f32 v195, v195, v90, v91
    v_max3_f32 v192, v192, v38, v39
    v_max3_f32 v193, v193, v56, v57
    v_max3_f32 v194, v194, v74, v75
    s_waitcnt lgkmcnt(3)
    v_mfma_f32_16x16x32_bf16 v[100:103], v[180:183], v[172:175], 0
    v_max3_f32 v195, v195, v92, v93
    v_max3_f32 v192, v192, v40, v41
    v_max3_f32 v193, v193, v58, v59
    v_max3_f32 v194, v194, v76, v77
    v_max3_f32 v195, v195, v94, v95
    v_max3_f32 v192, v192, v193, v194
    ds_read_b128 v[180:183], v8 offset:6912
    v_max_f32 v192, v192, v195
    v_mov_b32 v193, v192
    s_nop 1
    v_permlane16_swap_b32 v192, v193
    v_max_f32 v192, v192, v193
    v_mov_b32 v193, v192
    s_nop 1
    v_permlane32_swap_b32 v192, v193
    v_max_f32 v192, v192, v193
    s_waitcnt lgkmcnt(3)
    v_mfma_f32_16x16x32_bf16 v[104:107], v[184:187], v[172:175], 0
    v_mul_f32 v192, s36, v192
    v_sub_f32 v192, 0, v192
    v_fma_f32 v24, v24, s36, v192
    v_fma_f32 v25, v25, s36, v192
    v_fma_f32 v26, v26, s36, v192
    v_fma_f32 v27, v27, s36, v192
    v_fma_f32 v28, v28, s36, v192
    ds_read_b128 v[184:187], v8 offset:8192
    v_fma_f32 v29, v29, s36, v192
    v_fma_f32 v30, v30, s36, v192
    v_fma_f32 v31, v31, s36, v192
    v_exp_f32 v24, v24
    v_exp_f32 v25, v25
    v_exp_f32 v26, v26
    v_exp_f32 v27, v27
    s_waitcnt lgkmcnt(3)
    v_mfma_f32_16x16x32_bf16 v[108:111], v[188:191], v[172:175], 0
    v_exp_f32 v28, v28
    v_exp_f32 v29, v29
    v_exp_f32 v30, v30
    v_exp_f32 v31, v31
    v_fma_f32 v32, v32, s36, v192
    v_fma_f32 v33, v33, s36, v192
    ds_read_b128 v[188:191], v8 offset:9472
    v_fma_f32 v34, v34, s36, v192
    v_fma_f32 v35, v35, s36, v192
    v_fma_f32 v36, v36, s36, v192
    v_fma_f32 v37, v37, s36, v192
    v_fma_f32 v38, v38, s36, v192
    v_fma_f32 v39, v39, s36, v192
    v_exp_f32 v32, v32
    s_waitcnt lgkmcnt(3)
    v_mfma_f32_16x16x32_bf16 v[112:115], v[176:179], v[172:175], 0
    v_exp_f32 v33, v33
    v_exp_f32 v34, v34
    v_exp_f32 v35, v35
    v_exp_f32 v36, v36
    v_exp_f32 v37, v37
    v_exp_f32 v38, v38
    v_exp_f32 v39, v39
    ds_read_b128 v[176:179], v8 offset:10752
    v_cvt_pk_bf16_f32 v24, v24, v25
    v_cvt_pk_bf16_f32 v25, v26, v27
    v_cvt_pk_bf16_f32 v26, v28, v29
    v_cvt_pk_bf16_f32 v27, v30, v31
    v_fma_f32 v40, v40, s36, v192
    v_fma_f32 v41, v41, s36, v192
    v_fma_f32 v42, v42, s36, v192
    s_waitcnt lgkmcnt(3)
    v_mfma_f32_16x16x32_bf16 v[116:119], v[180:183], v[172:175], 0
    v_fma_f32 v43, v43, s36, v192
    v_fma_f32 v44, v44, s36, v192
    v_fma_f32 v45, v45, s36, v192
    v_fma_f32 v46, v46, s36, v192
    v_fma_f32 v47, v47, s36, v192
    v_exp_f32 v40, v40
    ds_read_b128 v[180:183], v8 offset:12032
    v_exp_f32 v41, v41
    v_exp_f32 v42, v42
    v_exp_f32 v43, v43
    v_exp_f32 v44, v44
    v_exp_f32 v45, v45
    v_exp_f32 v46, v46
    v_exp_f32 v47, v47
    s_waitcnt lgkmcnt(3)
    v_mfma_f32_16x16x32_bf16 v[120:123], v[184:187], v[172:175], 0
    v_cvt_pk_bf16_f32 v28, v32, v33
    v_cvt_pk_bf16_f32 v29, v34, v35
    v_cvt_pk_bf16_f32 v30, v36, v37
    v_cvt_pk_bf16_f32 v31, v38, v39
    v_fma_f32 v48, v48, s36, v192
    v_fma_f32 v49, v49, s36, v192
    v_fma_f32 v50, v50, s36, v192
    ds_read_b128 v[184:187], v8 offset:13312
    v_fma_f32 v51, v51, s36, v192
    v_fma_f32 v52, v52, s36, v192
    v_fma_f32 v53, v53, s36, v192
    v_fma_f32 v54, v54, s36, v192
    v_fma_f32 v55, v55, s36, v192
    v_exp_f32 v48, v48
    v_exp_f32 v49, v49
    s_waitcnt lgkmcnt(3)
    v_mfma_f32_16x16x32_bf16 v[124:127], v[188:191], v[172:175], 0
    v_exp_f32 v50, v50
    v_exp_f32 v51, v51
    v_exp_f32 v52, v52
    v_exp_f32 v53, v53
    v_exp_f32 v54, v54
    v_exp_f32 v55, v55
    ds_read_b128 v[188:191], v8 offset:14592
    v_cvt_pk_bf16_f32 v32, v40, v41
    v_cvt_pk_bf16_f32 v33, v42, v43
    v_cvt_pk_bf16_f32 v34, v44, v45
    v_cvt_pk_bf16_f32 v35, v46, v47
    v_fma_f32 v56, v56, s36, v192
    v_fma_f32 v57, v57, s36, v192
    v_fma_f32 v58, v58, s36, v192
    s_waitcnt lgkmcnt(3)
    v_mfma_f32_16x16x32_bf16 v[128:131], v[176:179], v[172:175], 0
    v_fma_f32 v59, v59, s36, v192
    v_fma_f32 v60, v60, s36, v192
    v_fma_f32 v61, v61, s36, v192
    v_fma_f32 v62, v62, s36, v192
    v_fma_f32 v63, v63, s36, v192
    v_exp_f32 v56, v56
    v_exp_f32 v57, v57
    ds_read_b128 v[176:179], v8 offset:15872
    v_exp_f32 v58, v58
    v_exp_f32 v59, v59
    v_exp_f32 v60, v60
    v_exp_f32 v61, v61
    v_exp_f32 v62, v62
    v_exp_f32 v63, v63
    v_cvt_pk_bf16_f32 v36, v48, v49
    s_waitcnt lgkmcnt(3)
    v_mfma_f32_16x16x32_bf16 v[132:135], v[180:183], v[172:175], 0
    v_cvt_pk_bf16_f32 v37, v50, v51
    v_cvt_pk_bf16_f32 v38, v52, v53
    v_cvt_pk_bf16_f32 v39, v54, v55
    v_fma_f32 v64, v64, s36, v192
    v_fma_f32 v65, v65, s36, v192
    v_fma_f32 v66, v66, s36, v192
    ds_read_b128 v[180:183], v8 offset:17152
    v_fma_f32 v67, v67, s36, v192
    v_fma_f32 v68, v68, s36, v192
    v_fma_f32 v69, v69, s36, v192
    v_fma_f32 v70, v70, s36, v192
    v_fma_f32 v71, v71, s36, v192
    v_exp_f32 v64, v64
    v_exp_f32 v65, v65
    s_waitcnt lgkmcnt(3)
    v_mfma_f32_16x16x32_bf16 v[136:139], v[184:187], v[172:175], 0
    v_exp_f32 v66, v66
    v_exp_f32 v67, v67
    v_exp_f32 v68, v68
    v_exp_f32 v69, v69
    v_exp_f32 v70, v70
    v_exp_f32 v71, v71
    v_cvt_pk_bf16_f32 v40, v56, v57
    ds_read_b128 v[184:187], v8 offset:18432
    v_cvt_pk_bf16_f32 v41, v58, v59
    v_cvt_pk_bf16_f32 v42, v60, v61
    v_cvt_pk_bf16_f32 v43, v62, v63
    v_fma_f32 v72, v72, s36, v192
    v_fma_f32 v73, v73, s36, v192
    v_fma_f32 v74, v74, s36, v192
    v_fma_f32 v75, v75, s36, v192
    s_waitcnt lgkmcnt(3)
    v_mfma_f32_16x16x32_bf16 v[140:143], v[188:191], v[172:175], 0
    v_fma_f32 v76, v76, s36, v192
    v_fma_f32 v77, v77, s36, v192
    v_fma_f32 v78, v78, s36, v192
    v_fma_f32 v79, v79, s36, v192
    v_exp_f32 v72, v72
    v_exp_f32 v73, v73
    ds_read_b128 v[188:191], v8 offset:19712
    v_exp_f32 v74, v74
    v_exp_f32 v75, v75
    v_exp_f32 v76, v76
    v_exp_f32 v77, v77
    v_exp_f32 v78, v78
    v_exp_f32 v79, v79
    v_cvt_pk_bf16_f32 v44, v64, v65
    s_waitcnt lgkmcnt(3)
    v_mfma_f32_16x16x32_bf16 v[144:147], v[176:179], v[172:175], 0
    v_cvt_pk_bf16_f32 v45, v66, v67
    v_cvt_pk_bf16_f32 v46, v68, v69
    v_cvt_pk_bf16_f32 v47, v70, v71
    v_fma_f32 v80, v80, s36, v192
    v_fma_f32 v81, v81, s36, v192
    v_fma_f32 v82, v82, s36, v192
    v_fma_f32 v83, v83, s36, v192
    ds_read_b128 v[176:179], v8 offset:20992
    v_fma_f32 v84, v84, s36, v192
    v_fma_f32 v85, v85, s36, v192
    v_fma_f32 v86, v86, s36, v192
    v_fma_f32 v87, v87, s36, v192
    v_exp_f32 v80, v80
    v_exp_f32 v81, v81
    v_exp_f32 v82, v82
    s_waitcnt lgkmcnt(3)
    v_mfma_f32_16x16x32_bf16 v[148:151], v[180:183], v[172:175], 0
    v_exp_f32 v83, v83
    v_exp_f32 v84, v84
    v_exp_f32 v85, v85
    v_exp_f32 v86, v86
    v_exp_f32 v87, v87
    v_cvt_pk_bf16_f32 v48, v72, v73
    ds_read_b128 v[180:183], v8 offset:22272
    v_cvt_pk_bf16_f32 v49, v74, v75
    v_cvt_pk_bf16_f32 v50, v76, v77
    v_cvt_pk_bf16_f32 v51, v78, v79
    v_fma_f32 v88, v88, s36, v192
    v_fma_f32 v89, v89, s36, v192
    v_fma_f32 v90, v90, s36, v192
    v_fma_f32 v91, v91, s36, v192
    s_waitcnt lgkmcnt(3)
    v_mfma_f32_16x16x32_bf16 v[152:155], v[184:187], v[172:175], 0
    v_fma_f32 v92, v92, s36, v192
    v_fma_f32 v93, v93, s36, v192
    v_fma_f32 v94, v94, s36, v192
    v_fma_f32 v95, v95, s36, v192
    v_exp_f32 v88, v88
    v_exp_f32 v89, v89
    v_exp_f32 v90, v90
    s_waitcnt lgkmcnt(2)
    v_mfma_f32_16x16x32_bf16 v[156:159], v[188:191], v[172:175], 0
    v_exp_f32 v91, v91
    v_exp_f32 v92, v92
    v_exp_f32 v93, v93
    v_exp_f32 v94, v94
    v_exp_f32 v95, v95
    v_cvt_pk_bf16_f32 v52, v80, v81
    v_cvt_pk_bf16_f32 v53, v82, v83
    s_waitcnt lgkmcnt(1)
    v_mfma_f32_16x16x32_bf16 v[160:163], v[176:179], v[172:175], 0
    v_cvt_pk_bf16_f32 v54, v84, v85
    v_cvt_pk_bf16_f32 v55, v86, v87
    v_cvt_pk_bf16_f32 v56, v88, v89
    v_cvt_pk_bf16_f32 v57, v90, v91
    v_cvt_pk_bf16_f32 v58, v92, v93
    v_cvt_pk_bf16_f32 v59, v94, v95
    s_waitcnt lgkmcnt(0)
    v_mfma_f32_16x16x32_bf16 v[164:167], v[180:183], v[172:175], 0
    s_nop 9
    s_cmp_ge_u32 s22, 2
    s_cbranch_scc1 L_p2_fix1
    s_and_b32 s37, s25, 0xfffe
    s_sub_u32 s37, 16, s37
    s_cmp_le_i32 s37, 0
    s_cbranch_scc1 L_p2_fix1
    v_mov_b32 v96, v17
    v_mov_b32 v97, v17
    v_mov_b32 v98, v17
    v_mov_b32 v99, v17
    s_cmp_le_i32 s37, 1
    s_cbranch_scc1 L_p2_fix1
    v_mov_b32 v100, v17
    v_mov_b32 v101, v17
    v_mov_b32 v102, v17
    v_mov_b32 v103, v17
    s_cmp_le_i32 s37, 2
    s_cbranch_scc1 L_p2_fix1
    v_mov_b32 v104, v17
    v_mov_b32 v105, v17
    v_mov_b32 v106, v17
    v_mov_b32 v107, v17
    s_cmp_le_i32 s37, 3
    s_cbranch_scc1 L_p2_fix1
    v_mov_b32 v108, v17
    v_mov_b32 v109, v17
    v_mov_b32 v110, v17
    v_mov_b32 v111, v17
    s_cmp_le_i32 s37, 4
    s_cbranch_scc1 L_p2_fix1
    v_mov_b32 v112, v17
    v_mov_b32 v113, v17
    v_mov_b32 v114, v17
    v_mov_b32 v115, v17
    s_cmp_le_i32 s37, 5
    s_cbranch_scc1 L_p2_fix1
    v_mov_b32 v116, v17
    v_mov_b32 v117, v17
    v_mov_b32 v118, v17
    v_mov_b32 v119, v17
    s_cmp_le_i32 s37, 6
    s_cbranch_scc1 L_p2_fix1
    v_mov_b32 v120, v17
    v_mov_b32 v121, v17
    v_mov_b32 v122, v17
    v_mov_b32 v123, v17
    s_cmp_le_i32 s37, 7
    s_cbranch_scc1 L_p2_fix1
    v_mov_b32 v124, v17
    v_mov_b32 v125, v17
    v_mov_b32 v126, v17
    v_mov_b32 v127, v17
    s_cmp_le_i32 s37, 8
    s_cbranch_scc1 L_p2_fix1
    v_mov_b32 v128, v17
    v_mov_b32 v129, v17
    v_mov_b32 v130, v17
    v_mov_b32 v131, v17
    s_cmp_le_i32 s37, 9
    s_cbranch_scc1 L_p2_fix1
    v_mov_b32 v132, v17
    v_mov_b32 v133, v17
    v_mov_b32 v134, v17
    v_mov_b32 v135, v17
    s_cmp_le_i32 s37, 10
    s_cbranch_scc1 L_p2_fix1
    v_mov_b32 v136, v17
    v_mov_b32 v137, v17
    v_mov_b32 v138, v17
    v_mov_b32 v139, v17
    s_cmp_le_i32 s37, 11
    s_cbranch_scc1 L_p2_fix1
    v_mov_b32 v140, v17
    v_mov_b32 v141, v17
    v_mov_b32 v142, v17
    v_mov_b32 v143, v17
    s_cmp_le_i32 s37, 12
    s_cbranch_scc1 L_p2_fix1
    v_mov_b32 v144, v17
    v_mov_b32 v145, v17
    v_mov_b32 v146, v17
    v_mov_b32 v147, v17
    s_cmp_le_i32 s37, 13
    s_cbranch_scc1 L_p2_fix1
    v_mov_b32 v148, v17
    v_mov_b32 v149, v17
    v_mov_b32 v150, v17
    v_mov_b32 v151, v17
    s_cmp_le_i32 s37, 14
    s_cbranch_scc1 L_p2_fix1
    v_mov_b32 v152, v17
    v_mov_b32 v153, v17
    v_mov_b32 v154, v17
    v_mov_b32 v155, v17
    s_cmp_le_i32 s37, 15
    s_cbranch_scc1 L_p2_fix1
    v_mov_b32 v156, v17
    v_mov_b32 v157, v17
    v_mov_b32 v158, v17
    v_mov_b32 v159, v17
L_p2_fix1:
    s_nop 1
    v_cndmask_b32 v96, v17, v96, s[50:51]
    v_cndmask_b32 v97, v17, v97, s[52:53]
    v_cndmask_b32 v98, v17, v98, s[54:55]
    ds_read_b128 v[60:63], v9 offset:0
    v_cndmask_b32 v99, v17, v99, s[56:57]
    v_cndmask_b32 v100, v17, v100, s[58:59]
    v_cndmask_b32 v101, v17, v101, s[60:61]
    ds_read_b128 v[64:67], v11 offset:1024
    v_cndmask_b32 v102, v17, v102, s[62:63]
    v_cndmask_b32 v103, v17, v103, s[64:65]
    v_cndmask_b32 v160, v17, v160, s[66:67]
    v_cndmask_b32 v161, v17, v161, s[68:69]
    ds_read_b128 v[68:71], v9 offset:1280
    v_cndmask_b32 v162, v17, v162, s[70:71]
    v_cndmask_b32 v163, v17, v163, s[72:73]
    v_cndmask_b32 v164, v17, v164, s[74:75]
    ds_read_b128 v[72:75], v11 offset:2304
    v_cndmask_b32 v165, v17, v165, s[76:77]
    v_cndmask_b32 v166, v17, v166, s[78:79]
    v_cndmask_b32 v167, v17, v167, s[80:81]
    ds_read_b128 v[76:79], v9 offset:2560
    v_max_f32 v196, v96, v97
    v_max_f32 v197, v114, v115
    v_max_f32 v198, v132, v133
    v_max_f32 v199, v150, v151
    ds_read_b128 v[80:83], v11 offset:3584
    v_max3_f32 v196, v196, v98, v99
    v_max3_f32 v197, v197, v116, v117
    v_max3_f32 v198, v198, v134, v135
    s_waitcnt lgkmcnt(4)
    v_cndmask_b32 v64, v18, v64, s[48:49]
    v_max3_f32 v199, v199, v152, v153
    v_max3_f32 v196, v196, v100, v101
    v_max3_f32 v197, v197, v118, v119
    v_cndmask_b32 v65, v18, v65, s[48:49]
    v_max3_f32 v198, v198, v136, v137
    v_max3_f32 v199, v199, v154, v155
    v_max3_f32 v196, v196, v102, v103
    v_max3_f32 v197, v197, v120, v121
    v_cndmask_b32 v66, v18, v66, s[48:49]
    v_max3_f32 v198, v198, v138, v139
    v_max3_f32 v199, v199, v156, v157
    v_max3_f32 v196, v196, v104, v105
    v_cndmask_b32 v67, v18, v67, s[48:49]
    v_max3_f32 v197, v197, v122, v123
    v_max3_f32 v198, v198, v140, v141
    v_max3_f32 v199, v199, v158, v159
    v_max3_f32 v196, v196, v106, v107
    v_mfma_f32_16x16x32_bf16 v[84:87], v[60:63], v[24:27], 0
    v_max3_f32 v197, v197, v124, v125
    v_max3_f32 v198, v198, v142, v143
    v_max3_f32 v199, v199, v160, v161
    v_mfma_f32_16x16x32_bf16 v[88:91], v[64:67], v[24:27], 0
    v_max3_f32 v196, v196, v108, v109
    v_max3_f32 v197, v197, v126, v127
    v_max3_f32 v198, v198, v144, v145
    ds_read_b128 v[60:63], v9 offset:3840
    v_max3_f32 v199, v199, v162, v163
    v_max3_f32 v196, v196, v110, v111
    v_max3_f32 v197, v197, v128, v129
    v_max3_f32 v198, v198, v146, v147
    ds_read_b128 v[64:67], v11 offset:4864
    v_max3_f32 v199, v199, v164, v165
    v_max3_f32 v196, v196, v112, v113
    v_max3_f32 v197, v197, v130, v131
    s_waitcnt lgkmcnt(4)
    v_cndmask_b32 v72, v18, v72, s[48:49]
    v_max3_f32 v198, v198, v148, v149
    v_max3_f32 v199, v199, v166, v167
    v_max3_f32 v196, v196, v197, v198
    v_cndmask_b32 v73, v18, v73, s[48:49]
    v_max_f32 v196, v196, v199
    v_mov_b32 v197, v196
    s_nop 1
    v_permlane16_swap_b32 v196, v197
    v_max_f32 v196, v196, v197
    v_cndmask_b32 v74, v18, v74, s[48:49]
    v_mov_b32 v197, v196
    s_nop 1
    v_permlane32_swap_b32 v196, v197
    v_max_f32 v196, v196, v197
    v_cndmask_b32 v75, v18, v75, s[48:49]
    v_mul_f32 v196, s36, v196
    v_sub_f32 v196, 0, v196
    v_fma_f32 v96, v96, s36, v196
    v_fma_f32 v97, v97, s36, v196
    v_mfma_f32_16x16x32_bf16 v[84:87], v[68:71], v[28:31], v[84:87]
    v_fma_f32 v98, v98, s36, v196
    v_fma_f32 v99, v99, s36, v196
    v_fma_f32 v100, v100, s36, v196
    v_mfma_f32_16x16x32_bf16 v[88:91], v[72:75], v[28:31], v[88:91]
    v_fma_f32 v101, v101, s36, v196
    v_fma_f32 v102, v102, s36, v196
    v_fma_f32 v103, v103, s36, v196
    ds_read_b128 v[68:71], v9 offset:5120
    v_exp_f32 v96, v96
    v_exp_f32 v97, v97
    v_exp_f32 v98, v98
    v_exp_f32 v99, v99
    ds_read_b128 v[72:75], v11 offset:6144
    v_exp_f32 v100, v100
    v_exp_f32 v101, v101
    v_exp_f32 v102, v102
    s_waitcnt lgkmcnt(4)
    v_cndmask_b32 v80, v18, v80, s[48:49]
    v_exp_f32 v103, v103
    v_fma_f32 v104, v104, s36, v196
    v_fma_f32 v105, v105, s36, v196
    v_cndmask_b32 v81, v18, v81, s[48:49]
    v_fma_f32 v106, v106, s36, v196
    v_fma_f32 v107, v107, s36, v196
    v_fma_f32 v108, v108, s36, v196
    v_fma_f32 v109, v109, s36, v196
    v_cndmask_b32 v82, v18, v82, s[48:49]
    v_fma_f32 v110, v110, s36, v196
    v_fma_f32 v111, v111, s36, v196
    v_exp_f32 v104, v104
    v_cndmask_b32 v83, v18, v83, s[48:49]
    v_exp_f32 v105, v105
    v_exp_f32 v106, v106
    v_exp_f32 v107, v107
    v_exp_f32 v108, v108
    v_mfma_f32_16x16x32_bf16 v[84:87], v[76:79], v[32:35], v[84:87]
    v_exp_f32 v109, v109
    v_exp_f32 v110, v110
    v_exp_f32 v111, v111
    v_mfma_f32_16x16x32_bf16 v[88:91], v[80:83], v[32:35], v[88:91]
    v_cvt_pk_bf16_f32 v96, v96, v97
    v_cvt_pk_bf16_f32 v97, v98, v99
    v_cvt_pk_bf16_f32 v98, v100, v101
    ds_read_b128 v[76:79], v9 offset:6400
    v_cvt_pk_bf16_f32 v99, v102, v103
    v_fma_f32 v112, v112, s36, v196
    v_fma_f32 v113, v113, s36, v196
    v_fma_f32 v114, v114, s36, v196
    ds_read_b128 v[80:83], v11 offset:7424
    v_fma_f32 v115, v115, s36, v196
    v_fma_f32 v116, v116, s36, v196
    v_fma_f32 v117, v117, s36, v196
    s_waitcnt lgkmcnt(4)
    v_cndmask_b32 v64, v18, v64, s[48:49]
    v_fma_f32 v118, v118, s36, v196
    v_fma_f32 v119, v119, s36, v196
    v_exp_f32 v112, v112
    v_cndmask_b32 v65, v18, v65, s[48:49]
    v_exp_f32 v113, v113
    v_exp_f32 v114, v114
    v_exp_f32 v115, v115
    v_exp_f32 v116, v116
    v_cndmask_b32 v66, v18, v66, s[48:49]
    v_exp_f32 v117, v117
    v_exp_f32 v118, v118
    v_exp_f32 v119, v119
    v_cndmask_b32 v67, v18, v67, s[48:49]
    v_cvt_pk_bf16_f32 v100, v104, v105
    v_cvt_pk_bf16_f32 v101, v106, v107
    v_cvt_pk_bf16_f32 v102, v108, v109
    v_cvt_pk_bf16_f32 v103, v110, v111
    v_mfma_f32_16x16x32_bf16 v[84:87], v[60:63], v[36:39], v[84:87]
    v_fma_f32 v120, v120, s36, v196
    v_fma_f32 v121, v121, s36, v196
    v_fma_f32 v122, v122, s36, v196
    v_mfma_f32_16x16x32_bf16 v[88:91], v[64:67], v[36:39], v[88:91]
    v_fma_f32 v123, v123, s36, v196
    v_fma_f32 v124, v124, s36, v196
    v_fma_f32 v125, v125, s36, v196
    ds_read_b128 v[60:63], v9 offset:7680
    v_fma_f32 v126, v126, s36, v196
    v_fma_f32 v127, v127, s36, v196
    v_exp_f32 v120, v120
    v_exp_f32 v121, v121
    ds_read_b128 v[64:67], v11 offset:8704
    v_exp_f32 v122, v122
    v_exp_f32 v123, v123
    v_exp_f32 v124, v124
    s_waitcnt lgkmcnt(4)
    v_cndmask_b32 v72, v18, v72, s[48:49]
    v_exp_f32 v125, v125
    v_exp_f32 v126, v126
    v_exp_f32 v127, v127
    v_cndmask_b32 v73, v18, v73, s[48:49]
    v_cvt_pk_bf16_f32 v104, v112, v113
    v_cvt_pk_bf16_f32 v105, v114, v115
    v_cvt_pk_bf16_f32 v106, v116, v117
    v_cvt_pk_bf16_f32 v107, v118, v119
    v_cndmask_b32 v74, v18, v74, s[48:49]
    v_fma_f32 v128, v128, s36, v196
    v_fma_f32 v129, v129, s36, v196
    v_fma_f32 v130, v130, s36, v196
    v_cndmask_b32 v75, v18, v75, s[48:49]
    v_fma_f32 v131, v131, s36, v196
    v_fma_f32 v132, v132, s36, v196
    v_fma_f32 v133, v133, s36, v196
    v_fma_f32 v134, v134, s36, v196
    v_mfma_f32_16x16x32_bf16 v[84:87], v[68:71], v[40:43], v[84:87]
    v_fma_f32 v135, v135, s36, v196
    v_exp_f32 v128, v128
    v_exp_f32 v129, v129
    v_mfma_f32_16x16x32_bf16 v[88:91], v[72:75], v[40:43], v[88:91]
    v_exp_f32 v130, v130
    v_exp_f32 v131, v131
    v_exp_f32 v132, v132
    ds_read_b128 v[68:71], v9 offset:8960
    v_exp_f32 v133, v133
    v_exp_f32 v134, v134
    v_exp_f32 v135, v135
    v_cvt_pk_bf16_f32 v108, v120, v121
    ds_read_b128 v[72:75], v11 offset:9984
    v_cvt_pk_bf16_f32 v109, v122, v123
    v_cvt_pk_bf16_f32 v110, v124, v125
    v_cvt_pk_bf16_f32 v111, v126, v127
    s_waitcnt lgkmcnt(4)
    v_cndmask_b32 v80, v18, v80, s[48:49]
    v_fma_f32 v136, v136, s36, v196
    v_fma_f32 v137, v137, s36, v196
    v_fma_f32 v138, v138, s36, v196
    v_cndmask_b32 v81, v18, v81, s[48:49]
    v_fma_f32 v139, v139, s36, v196
    v_fma_f32 v140, v140, s36, v196
    v_fma_f32 v141, v141, s36, v196
    v_fma_f32 v142, v142, s36, v196
    v_cndmask_b32 v82, v18, v82, s[48:49]
    v_fma_f32 v143, v143, s36, v196
    v_exp_f32 v136, v136
    v_exp_f32 v137, v137
    v_cndmask_b32 v83, v18, v83, s[48:49]
    v_exp_f32 v138, v138
    v_exp_f32 v139, v139
    v_exp_f32 v140, v140
    v_exp_f32 v141, v141
    v_mfma_f32_16x16x32_bf16 v[84:87], v[76:79], v[44:47], v[84:87]
    v_exp_f32 v142, v142
    v_exp_f32 v143, v143
    v_cvt_pk_bf16_f32 v112, v128, v129
    v_mfma_f32_16x16x32_bf16 v[88:91], v[80:83], v[44:47], v[88:91]
    v_cvt_pk_bf16_f32 v113, v130, v131
    v_cvt_pk_bf16_f32 v114, v132, v133
    v_cvt_pk_bf16_f32 v115, v134, v135
    ds_read_b128 v[76:79], v9 offset:10240
    v_fma_f32 v144, v144, s36, v196
    v_fma_f32 v145, v145, s36, v196
    v_fma_f32 v146, v146, s36, v196
    v_fma_f32 v147, v147, s36, v196
    ds_read_b128 v[80:83], v11 offset:11264
    v_fma_f32 v148, v148, s36, v196
    v_fma_f32 v149, v149, s36, v196
    v_fma_f32 v150, v150, s36, v196
    s_waitcnt lgkmcnt(4)
    v_cndmask_b32 v64, v18, v64, s[48:49]
    v_fma_f32 v151, v151, s36, v196
    v_exp_f32 v144, v144
    v_exp_f32 v145, v145
    v_cndmask_b32 v65, v18, v65, s[48:49]
    v_exp_f32 v146, v146
    v_exp_f32 v147, v147
    v_exp_f32 v148, v148
    v_exp_f32 v149, v149
    v_cndmask_b32 v66, v18, v66, s[48:49]
    v_exp_f32 v150, v150
    v_exp_f32 v151, v151
    v_cvt_pk_bf16_f32 v116, v136, v137
    v_cndmask_b32 v67, v18, v67, s[48:49]
    v_cvt_pk_bf16_f32 v117, v138, v139
    v_cvt_pk_bf16_f32 v118, v140, v141
    v_cvt_pk_bf16_f32 v119, v142, v143
    v_fma_f32 v152, v152, s36, v196
    v_mfma_f32_16x16x32_bf16 v[84:87], v[60:63], v[48:51], v[84:87]
    v_fma_f32 v153, v153, s36, v196
    v_fma_f32 v154, v154, s36, v196
    v_fma_f32 v155, v155, s36, v196
    v_mfma_f32_16x16x32_bf16 v[88:91], v[64:67], v[48:51], v[88:91]
    v_fma_f32 v156, v156, s36, v196
    v_fma_f32 v157, v157, s36, v196
    v_fma_f32 v158, v158, s36, v196
    s_waitcnt lgkmcnt(2)
    v_cndmask_b32 v72, v18, v72, s[48:49]
    v_fma_f32 v159, v159, s36, v196
    v_exp_f32 v152, v152
    v_exp_f32 v153, v153
    v_exp_f32 v154, v154
    v_cndmask_b32 v73, v18, v73, s[48:49]
    v_exp_f32 v155, v155
    v_exp_f32 v156, v156
    v_exp_f32 v157, v157
    v_cndmask_b32 v74, v18, v74, s[48:49]
    v_exp_f32 v158, v158
    v_exp_f32 v159, v159
    v_cvt_pk_bf16_f32 v120, v144, v145
    v_cndmask_b32 v75, v18, v75, s[48:49]
    v_cvt_pk_bf16_f32 v121, v146, v147
    v_cvt_pk_bf16_f32 v122, v148, v149
    v_cvt_pk_bf16_f32 v123, v150, v151
    v_fma_f32 v160, v160, s36, v196
    v_mfma_f32_16x16x32_bf16 v[84:87], v[68:71], v[52:55], v[84:87]
    v_fma_f32 v161, v161, s36, v196
    v_fma_f32 v162, v162, s36, v196
    v_fma_f32 v163, v163, s36, v196
    v_mfma_f32_16x16x32_bf16 v[88:91], v[72:75], v[52:55], v[88:91]
    v_fma_f32 v164, v164, s36, v196
    v_fma_f32 v165, v165, s36, v196
    v_fma_f32 v166, v166, s36, v196
    v_fma_f32 v167, v167, s36, v196
    s_waitcnt lgkmcnt(0)
    v_cndmask_b32 v80, v18, v80, s[48:49]
    v_exp_f32 v160, v160
    v_exp_f32 v161, v161
    v_exp_f32 v162, v162
    v_cndmask_b32 v81, v18, v81, s[48:49]
    v_exp_f32 v163, v163
    v_exp_f32 v164, v164
    v_exp_f32 v165, v165
    v_cndmask_b32 v82, v18, v82, s[48:49]
    v_exp_f32 v166, v166
    v_exp_f32 v167, v167
    v_cvt_pk_bf16_f32 v124, v152, v153
    v_cvt_pk_bf16_f32 v125, v154, v155
    v_cndmask_b32 v83, v18, v83, s[48:49]
    v_cvt_pk_bf16_f32 v126, v156, v157
    v_cvt_pk_bf16_f32 v127, v158, v159
    v_cvt_pk_bf16_f32 v128, v160, v161
    v_mfma_f32_16x16x32_bf16 v[84:87], v[76:79], v[56:59], v[84:87]
    v_cvt_pk_bf16_f32 v129, v162, v163
    v_cvt_pk_bf16_f32 v130, v164, v165
    v_cvt_pk_bf16_f32 v131, v166, v167
    v_mfma_f32_16x16x32_bf16 v[88:91], v[80:83], v[56:59], v[88:91]
    s_waitcnt vmcnt(0)
    s_barrier
    s_nop 5
    v_mov_b32 v140, v88
    ds_read_b128 v[60:63], v9 offset:15360
    ds_read_b128 v[64:67], v11 offset:16384
    ds_read_b128 v[68:71], v9 offset:16640
    ds_read_b128 v[72:75], v11 offset:17664
    v_mov_b32 v141, v88
    ds_read_b128 v[76:79], v9 offset:17920
    ds_read_b128 v[80:83], v11 offset:18944
    s_waitcnt lgkmcnt(4)
    v_cndmask_b32 v64, v18, v64, s[48:49]
    v_cndmask_b32 v65, v18, v65, s[48:49]
    v_cndmask_b32 v66, v18, v66, s[48:49]
    v_permlane16_swap_b32 v140, v141
    v_cndmask_b32 v67, v18, v67, s[48:49]
    v_mfma_f32_16x16x32_bf16 v[132:135], v[60:63], v[96:99], 0
    s_nop 0
    v_mfma_f32_16x16x32_bf16 v[136:139], v[64:67], v[96:99], 0
    ds_read_b128 v[60:63], v9 offset:19200
    v_rcp_f32 v141, v141
    ds_read_b128 v[64:67], v11 offset:20224
    s_waitcnt lgkmcnt(4)
    v_cndmask_b32 v72, v18, v72, s[48:49]
    v_cndmask_b32 v73, v18, v73, s[48:49]
    v_cndmask_b32 v74, v18, v74, s[48:49]
    v_cndmask_b32 v75, v18, v75, s[48:49]
    v_mul_f32 v142, v84, v141
    v_mfma_f32_16x16x32_bf16 v[132:135], v[68:71], v[100:103], v[132:135]
    v_mfma_f32_16x16x32_bf16 v[136:139], v[72:75], v[100:103], v[136:139]
    ds_read_b128 v[68:71], v9 offset:20480
    ds_read_b128 v[72:75], v11 offset:21504
    v_mul_f32 v143, v85, v141
    s_waitcnt lgkmcnt(4)
    v_cndmask_b32 v80, v18, v80, s[48:49]
    v_cndmask_b32 v81, v18, v81, s[48:49]
    v_cndmask_b32 v82, v18, v82, s[48:49]
    v_cndmask_b32 v83, v18, v83, s[48:49]
    v_mfma_f32_16x16x32_bf16 v[132:135], v[76:79], v[104:107], v[132:135]
    v_mul_f32 v144, v86, v141
    v_mfma_f32_16x16x32_bf16 v[136:139], v[80:83], v[104:107], v[136:139]
    ds_read_b128 v[76:79], v9 offset:21760
    ds_read_b128 v[80:83], v11 offset:22784
    s_waitcnt lgkmcnt(4)
    v_cndmask_b32 v64, v18, v64, s[48:49]
    v_mul_f32 v145, v87, v141
    v_cndmask_b32 v65, v18, v65, s[48:49]
    v_cndmask_b32 v66, v18, v66, s[48:49]
    v_cndmask_b32 v67, v18, v67, s[48:49]
    v_mfma_f32_16x16x32_bf16 v[132:135], v[60:63], v[108:111], v[132:135]
    s_nop 0
    v_mfma_f32_16x16x32_bf16 v[136:139], v[64:67], v[108:111], v[136:139]
    v_mul_f32 v146, v88, v141
    ds_read_b128 v[60:63], v9 offset:23040
    ds_read_b128 v[64:67], v11 offset:24064
    s_waitcnt lgkmcnt(4)
    v_cndmask_b32 v72, v18, v72, s[48:49]
    v_cndmask_b32 v73, v18, v73, s[48:49]
    v_mul_f32 v147, v89, v141
    v_cndmask_b32 v74, v18, v74, s[48:49]
    v_cndmask_b32 v75, v18, v75, s[48:49]
    v_mfma_f32_16x16x32_bf16 v[132:135], v[68:71], v[112:115], v[132:135]
    s_nop 0
    v_mfma_f32_16x16x32_bf16 v[136:139], v[72:75], v[112:115], v[136:139]
    ds_read_b128 v[68:71], v9 offset:24320
    v_mul_f32 v148, v90, v141
    ds_read_b128 v[72:75], v11 offset:25344
    s_waitcnt lgkmcnt(4)
    v_cndmask_b32 v80, v18, v80, s[48:49]
    v_cndmask_b32 v81, v18, v81, s[48:49]
    v_cndmask_b32 v82, v18, v82, s[48:49]
    v_mul_f32 v149, v91, v141
    v_cndmask_b32 v83, v18, v83, s[48:49]
    v_mfma_f32_16x16x32_bf16 v[132:135], v[76:79], v[116:119], v[132:135]
    s_nop 0
    v_mfma_f32_16x16x32_bf16 v[136:139], v[80:83], v[116:119], v[136:139]
    ds_read_b128 v[76:79], v9 offset:25600
    ds_read_b128 v[80:83], v11 offset:26624
    v_cvt_pk_bf16_f32 v160, v142, v143
    s_waitcnt lgkmcnt(4)
    v_cndmask_b32 v64, v18, v64, s[48:49]
    v_cndmask_b32 v65, v18, v65, s[48:49]
    v_cndmask_b32 v66, v18, v66, s[48:49]
    v_cndmask_b32 v67, v18, v67, s[48:49]
    v_cvt_pk_bf16_f32 v161, v144, v145
    v_mfma_f32_16x16x32_bf16 v[132:135], v[60:63], v[120:123], v[132:135]
    v_mfma_f32_16x16x32_bf16 v[136:139], v[64:67], v[120:123], v[136:139]
    s_waitcnt lgkmcnt(2)
    v_cndmask_b32 v72, v18, v72, s[48:49]
    v_cndmask_b32 v73, v18, v73, s[48:49]
    v_cndmask_b32 v74, v18, v74, s[48:49]
    v_cvt_pk_bf16_f32 v164, v146, v147
    v_cndmask_b32 v75, v18, v75, s[48:49]
    v_mfma_f32_16x16x32_bf16 v[132:135], v[68:71], v[124:127], v[132:135]
    s_nop 0
    v_mfma_f32_16x16x32_bf16 v[136:139], v[72:75], v[124:127], v[136:139]
    s_waitcnt lgkmcnt(0)
    v_cndmask_b32 v80, v18, v80, s[48:49]
    v_cvt_pk_bf16_f32 v165, v148, v149
    v_cndmask_b32 v81, v18, v81, s[48:49]
    v_cndmask_b32 v82, v18, v82, s[48:49]
    v_cndmask_b32 v83, v18, v83, s[48:49]
    v_mfma_f32_16x16x32_bf16 v[132:135], v[76:79], v[128:131], v[132:135]
    s_nop 0
    v_mfma_f32_16x16x32_bf16 v[136:139], v[80:83], v[128:131], v[136:139]
    s_nop 7
    v_mov_b32 v150, v136
    v_mov_b32 v151, v136
    s_nop 1
    v_permlane16_swap_b32 v150, v151
    v_rcp_f32 v151, v151
    s_nop 0
    v_mul_f32 v152, v132, v151
    v_mul_f32 v153, v133, v151
    v_mul_f32 v154, v134, v151
    v_mul_f32 v155, v135, v151
    v_mul_f32 v156, v136, v151
    v_mul_f32 v157, v137, v151
    v_mul_f32 v158, v138, v151
    v_mul_f32 v159, v139, v151
    v_cvt_pk_bf16_f32 v162, v152, v153
    v_cvt_pk_bf16_f32 v163, v154, v155
    v_cvt_pk_bf16_f32 v166, v156, v157
    v_cvt_pk_bf16_f32 v167, v158, v159
    buffer_store_dwordx4 v[160:163], v15, s[12:15], s35 offen sc1
    buffer_store_dwordx4 v[164:167], v16, s[12:15], s35 offen offset:1024 sc1
    s_lshl_b32 s22, s22, 7
    s_lshl_b32 s21, s21, 2
    s_add_u32 s22, s22, s21
    s_add_u32 s22, s22, 8192
    s_cmp_ge_u32 s24, 4
    s_cbranch_scc1 L_p2_fin
    s_cmp_ge_u32 s2, 240
    s_cbranch_scc1 L_p2_fin
    v_lshrrev_b32 v20, 5, v2
    s_mov_b32 s30, 0xffff0000
    v_lshlrev_b32 v177, 5, v20
    v_add_u32 v177, 155648, v177
    ds_read_b128 v[184:187], v177 offset:256
    ds_read_b128 v[188:191], v177 offset:272
    ds_read_b128 v[192:195], v177 offset:0
    ds_read_b128 v[196:199], v177 offset:16
    ds_read_b128 v[200:203], v177 offset:320
    ds_read_b128 v[204:207], v177 offset:336
    ds_read_b128 v[208:211], v177 offset:64
    ds_read_b128 v[212:215], v177 offset:80
    ds_read_b128 v[216:219], v177 offset:384
    ds_read_b128 v[220:223], v177 offset:400
    ds_read_b128 v[224:227], v177 offset:128
    ds_read_b128 v[228:231], v177 offset:144
    ds_read_b128 v[232:235], v177 offset:448
    ds_read_b128 v[236:239], v177 offset:464
    ds_read_b128 v[240:243], v177 offset:192
    ds_read_b128 v[244:247], v177 offset:208
    v_bfe_u32 v25, v2, 2, 2
    v_lshl_add_u32 v24, v20, 3, v25
    v_lshlrev_b32 v24, 7, v24
    v_bfe_u32 v25, v2, 4, 1
    v_lshl_add_u32 v24, v25, 11, v24
    v_and_b32 v25, 3, v2
    v_lshl_add_u32 v24, v25, 3, v24
    s_lshl_b32 s40, s24, 5
    s_add_u32 s40, s40, 131072
    v_add_u32 v24, s40, v24
    v_lshlrev_b32 v25, 4, v2
    v_lshlrev_b32 v26, 2, v2
    v_mov_b32 v28, 0x3f803f80
    v_mov_b32 v29, 0x3f803f80
    v_mov_b32 v30, 0x3f803f80
    v_mov_b32 v31, 0x3f803f80
    ds_read_b64_tr_b16 v[32:33], v24 offset:0
    ds_read_b64_tr_b16 v[34:35], v24 offset:512
    ds_read_b64_tr_b16 v[36:37], v24 offset:4096
    ds_read_b64_tr_b16 v[38:39], v24 offset:4608
    ds_read_b64_tr_b16 v[40:41], v24 offset:8192
    ds_read_b64_tr_b16 v[42:43], v24 offset:8704
    ds_read_b64_tr_b16 v[44:45], v24 offset:12288
    ds_read_b64_tr_b16 v[46:47], v24 offset:12800
    s_lshl_b32 s42, s42, 2
    s_add_u32 s42, s42, s24
    s_mul_i32 s40, s42, 40960
    s_mul_i32 s44, s41, 24576
    s_lshl_b32 s41, s41, 12
    s_add_u32 s40, s40, s41
    s_add_u32 s40, s40, 25231360
    s_lshl_b32 s43, s42, 7
    s_add_u32 s43, s43, s44
    s_add_u32 s43, s43, 29360128
    s_add_u32 s44, s43, 12288
    s_waitcnt lgkmcnt(15)
    v_cvt_pk_bf16_f32 v176, v192, v193
    v_cvt_pk_bf16_f32 v177, v194, v195
    v_cvt_pk_bf16_f32 v178, v196, v197
    v_cvt_pk_bf16_f32 v179, v198, v199
    s_waitcnt lgkmcnt(6)
    s_nop 0
    v_mfma_f32_32x32x16_bf16 v[56:71], v[176:179], v[32:35], 0
    v_lshlrev_b32 v48, 16, v32
    v_and_b32 v49, s30, v32
    v_lshlrev_b32 v50, 16, v33
    v_and_b32 v51, s30, v33
    v_lshlrev_b32 v52, 16, v34
    v_and_b32 v53, s30, v34
    v_lshlrev_b32 v54, 16, v35
    v_and_b32 v55, s30, v35
    v_mul_f32 v48, v48, v184
    v_mul_f32 v49, v49, v185
    v_mul_f32 v50, v50, v186
    v_mul_f32 v51, v51, v187
    v_mul_f32 v52, v52, v188
    v_mul_f32 v53, v53, v189
    v_mul_f32 v54, v54, v190
    v_mul_f32 v55, v55, v191
    v_cvt_pk_bf16_f32 v88, v48, v49
    v_cvt_pk_bf16_f32 v89, v50, v51
    v_cvt_pk_bf16_f32 v90, v52, v53
    v_cvt_pk_bf16_f32 v91, v54, v55
    s_nop 1
    v_mfma_f32_32x32x16_bf16 v[72:87], v[28:31], v[88:91], 0
    buffer_store_dwordx4 v[88:91], v25, s[12:15], s40 offen offset:0 sc1
    v_cvt_pk_bf16_f32 v180, v208, v209
    v_cvt_pk_bf16_f32 v181, v210, v211
    v_cvt_pk_bf16_f32 v182, v212, v213
    v_cvt_pk_bf16_f32 v183, v214, v215
    s_waitcnt lgkmcnt(4)
    s_nop 0
    v_mfma_f32_32x32x16_bf16 v[56:71], v[180:183], v[36:39], v[56:71]
    v_lshlrev_b32 v48, 16, v36
    v_and_b32 v49, s30, v36
    v_lshlrev_b32 v50, 16, v37
    v_and_b32 v51, s30, v37
    v_lshlrev_b32 v52, 16, v38
    v_and_b32 v53, s30, v38
    v_lshlrev_b32 v54, 16, v39
    v_and_b32 v55, s30, v39
    v_mul_f32 v48, v48, v200
    v_mul_f32 v49, v49, v201
    v_mul_f32 v50, v50, v202
    v_mul_f32 v51, v51, v203
    v_mul_f32 v52, v52, v204
    v_mul_f32 v53, v53, v205
    v_mul_f32 v54, v54, v206
    v_mul_f32 v55, v55, v207
    v_cvt_pk_bf16_f32 v92, v48, v49
    v_cvt_pk_bf16_f32 v93, v50, v51
    v_cvt_pk_bf16_f32 v94, v52, v53
    v_cvt_pk_bf16_f32 v95, v54, v55
    s_nop 1
    v_mfma_f32_32x32x16_bf16 v[72:87], v[28:31], v[92:95], v[72:87]
    buffer_store_dwordx4 v[92:95], v25, s[12:15], s40 offen offset:1024 sc1
    v_cvt_pk_bf16_f32 v176, v224, v225
    v_cvt_pk_bf16_f32 v177, v226, v227
    v_cvt_pk_bf16_f32 v178, v228, v229
    v_cvt_pk_bf16_f32 v179, v230, v231
    s_waitcnt lgkmcnt(2)
    s_nop 0
    v_mfma_f32_32x32x16_bf16 v[56:71], v[176:179], v[40:43], v[56:71]
    v_lshlrev_b32 v48, 16, v40
    v_and_b32 v49, s30, v40
    v_lshlrev_b32 v50, 16, v41
    v_and_b32 v51, s30, v41
    v_lshlrev_b32 v52, 16, v42
    v_and_b32 v53, s30, v42
    v_lshlrev_b32 v54, 16, v43
    v_and_b32 v55, s30, v43
    v_mul_f32 v48, v48, v216
    v_mul_f32 v49, v49, v217
    v_mul_f32 v50, v50, v218
    v_mul_f32 v51, v51, v219
    v_mul_f32 v52, v52, v220
    v_mul_f32 v53, v53, v221
    v_mul_f32 v54, v54, v222
    v_mul_f32 v55, v55, v223
    v_cvt_pk_bf16_f32 v96, v48, v49
    v_cvt_pk_bf16_f32 v97, v50, v51
    v_cvt_pk_bf16_f32 v98, v52, v53
    v_cvt_pk_bf16_f32 v99, v54, v55
    s_nop 1
    v_mfma_f32_32x32x16_bf16 v[72:87], v[28:31], v[96:99], v[72:87]
    buffer_store_dwordx4 v[96:99], v25, s[12:15], s40 offen offset:2048 sc1
    v_cvt_pk_bf16_f32 v180, v240, v241
    v_cvt_pk_bf16_f32 v181, v242, v243
    v_cvt_pk_bf16_f32 v182, v244, v245
    v_cvt_pk_bf16_f32 v183, v246, v247
    s_waitcnt lgkmcnt(0)
    s_nop 0
    v_mfma_f32_32x32x16_bf16 v[56:71], v[180:183], v[44:47], v[56:71]
    v_lshlrev_b32 v48, 16, v44
    v_and_b32 v49, s30, v44
    v_lshlrev_b32 v50, 16, v45
    v_and_b32 v51, s30, v45
    v_lshlrev_b32 v52, 16, v46
    v_and_b32 v53, s30, v46
    v_lshlrev_b32 v54, 16, v47
    v_and_b32 v55, s30, v47
    v_mul_f32 v48, v48, v232
    v_mul_f32 v49, v49, v233
    v_mul_f32 v50, v50, v234
    v_mul_f32 v51, v51, v235
    v_mul_f32 v52, v52, v236
    v_mul_f32 v53, v53, v237
    v_mul_f32 v54, v54, v238
    v_mul_f32 v55, v55, v239
    v_cvt_pk_bf16_f32 v100, v48, v49
    v_cvt_pk_bf16_f32 v101, v50, v51
    v_cvt_pk_bf16_f32 v102, v52, v53
    v_cvt_pk_bf16_f32 v103, v54, v55
    s_nop 1
    v_mfma_f32_32x32x16_bf16 v[72:87], v[28:31], v[100:103], v[72:87]
    buffer_store_dwordx4 v[100:103], v25, s[12:15], s40 offen offset:3072 sc1
    v_mov_b32 v48, v56
    s_nop 9
    v_mov_b32 v49, v72
    s_mov_b32 exec_hi, 0
    buffer_store_dword v48, v26, s[12:15], s44 offen sc1
    buffer_store_dword v49, v26, s[12:15], s43 offen sc1
    s_mov_b64 exec, -1
    s_waitcnt vmcnt(6)
    s_branch L_sigb_p2
L_p2_fin:
    s_nop 3
    s_waitcnt vmcnt(0) lgkmcnt(0)
L_sigb_p2:
    s_barrier
    s_cmp_lg_u32 s3, 0
    s_cbranch_scc1 L_sig_p2
    s_add_u32 s22, s22, 29622272
    v_lshlrev_b32 v250, 14, v2
    v_add_u32 v250, s22, v250
    v_mov_b32 v251, s83
    s_mov_b64 exec, 0xffff
    global_store_dword v250, v251, s[84:85] sc1
    s_mov_b64 exec, -1
L_sig_p2:
    s_nop 1
    s_and_b32 s20, s2, 7
    s_lshr_b32 s21, s2, 3
    s_lshl_b32 s22, s20, 2
    s_and_b32 s23, s21, 3
    s_add_u32 s22, s22, s23
    s_lshr_b32 s23, s21, 2
    v_lshlrev_b32 v5, 4, v2
    v_add_u32 v6, 4096, v5
    s_mul_i32 s37, s20, 5
    s_lshr_b32 s37, s37, 3
    s_cmp_lt_u32 s3, 4
    s_cbranch_scc1 L_p3_comp
    s_sub_u32 s24, s3, 4
    s_mul_i32 s25, s23, 102400
    s_mul_i32 s26, s24, 5120
    s_add_u32 s25, s25, s26
    s_add_u32 s25, s25, 22413312
    s_cmp_ge_u32 s16, 680
    s_cbranch_scc1 L_p3_norp
    v_lshrrev_b32 v24, 5, v2
    v_lshlrev_b32 v24, 2, v24
    v_bfe_u32 v25, v2, 4, 1
    v_add_u32 v24, v24, v25
    v_bfe_u32 v25, v2, 2, 2
    v_lshl_add_u32 v24, v24, 2, v25
    v_lshlrev_b32 v24, 7, v24
    v_and_b32 v25, 3, v2
    v_lshl_add_u32 v24, v25, 3, v24
    v_add_u32 v24, s17, v24
    v_lshlrev_b32 v25, 4, v2
    ds_read_b64_tr_b16 v[28:29], v24 offset:0
    ds_read_b64_tr_b16 v[30:31], v24 offset:1024
    ds_read_b64_tr_b16 v[32:33], v24 offset:32
    ds_read_b64_tr_b16 v[34:35], v24 offset:1056
    ds_read_b64_tr_b16 v[36:37], v24 offset:64
    ds_read_b64_tr_b16 v[38:39], v24 offset:1088
    ds_read_b64_tr_b16 v[40:41], v24 offset:96
    ds_read_b64_tr_b16 v[42:43], v24 offset:1120
    s_cmp_lt_u32 s16, 200
    s_cselect_b32 s40, 102400, 0
    s_cselect_b32 s43, 0, 245760
    s_add_u32 s40, s40, s43
    s_cselect_b32 s43, 0, 851968
    s_cmp_lt_u32 s16, 200
    s_cselect_b32 s43, 0, 851968
    s_add_u32 s43, s43, 22413312
    s_mul_i32 s41, s41, 5120
    s_add_u32 s43, s43, s41
    s_lshl_b32 s42, s42, 2
    s_add_u32 s44, s42, 0
    s_mul_i32 s45, s44, 52
    s_lshr_b32 s45, s45, 8
    s_mul_i32 s46, s45, 5
    s_sub_u32 s46, s44, s46
    s_mul_i32 s45, s45, s40
    s_lshl_b32 s46, s46, 10
    s_add_u32 s45, s45, s46
    s_add_u32 s45, s45, s43
    s_waitcnt lgkmcnt(6)
    buffer_store_dwordx4 v[28:31], v25, s[12:15], s45 offen sc1
    s_add_u32 s44, s42, 1
    s_mul_i32 s45, s44, 52
    s_lshr_b32 s45, s45, 8
    s_mul_i32 s46, s45, 5
    s_sub_u32 s46, s44, s46
    s_mul_i32 s45, s45, s40
    s_lshl_b32 s46, s46, 10
    s_add_u32 s45, s45, s46
    s_add_u32 s45, s45, s43
    s_waitcnt lgkmcnt(4)
    buffer_store_dwordx4 v[32:35], v25, s[12:15], s45 offen sc1
    s_add_u32 s44, s42, 2
    s_mul_i32 s45, s44, 52
    s_lshr_b32 s45, s45, 8
    s_mul_i32 s46, s45, 5
    s_sub_u32 s46, s44, s46
    s_mul_i32 s45, s45, s40
    s_lshl_b32 s46, s46, 10
    s_add_u32 s45, s45, s46
    s_add_u32 s45, s45, s43
    s_waitcnt lgkmcnt(2)
    buffer_store_dwordx4 v[36:39], v25, s[12:15], s45 offen sc1
    s_add_u32 s44, s42, 3
    s_mul_i32 s45, s44, 52
    s_lshr_b32 s45, s45, 8
    s_mul_i32 s46, s45, 5
    s_sub_u32 s46, s44, s46
    s_mul_i32 s45, s45, s40
    s_lshl_b32 s46, s46, 10
    s_add_u32 s45, s45, s46
    s_add_u32 s45, s45, s43
    s_waitcnt lgkmcnt(0)
    buffer_store_dwordx4 v[40:43], v25, s[12:15], s45 offen sc1
L_p3_norp:
    s_nop 3
    s_mul_i32 s29, s37, 20480
    s_add_u32 s29, s29, s25
    s_add_u32 s37, s37, 1
    s_cmp_ge_u32 s37, 5
    s_cselect_b32 s37, 0, s37
    s_add_u32 m0, s26, 61440
    s_nop 0
    buffer_load_dwordx4 v5, s[12:15], s29 offen offset:0 sc1 lds
    buffer_load_dwordx4 v5, s[12:15], s29 offen offset:1024 sc1 lds
    buffer_load_dwordx4 v5, s[12:15], s29 offen offset:2048 sc1 lds
    buffer_load_dwordx4 v5, s[12:15], s29 offen offset:3072 sc1 lds
    s_add_u32 m0, s26, 65536
    s_nop 0
    buffer_load_dwordx4 v6, s[12:15], s29 offen sc1 lds
    s_mul_i32 s29, s37, 20480
    s_add_u32 s29, s29, s25
    s_add_u32 s37, s37, 1
    s_cmp_ge_u32 s37, 5
    s_cselect_b32 s37, 0, s37
    s_add_u32 m0, s26, 81920
    s_nop 0
    buffer_load_dwordx4 v5, s[12:15], s29 offen offset:0 sc1 lds
    buffer_load_dwordx4 v5, s[12:15], s29 offen offset:1024 sc1 lds
    buffer_load_dwordx4 v5, s[12:15], s29 offen offset:2048 sc1 lds
    buffer_load_dwordx4 v5, s[12:15], s29 offen offset:3072 sc1 lds
    s_add_u32 m0, s26, 86016
    s_nop 0
    buffer_load_dwordx4 v6, s[12:15], s29 offen sc1 lds
    s_mul_i32 s29, s37, 20480
    s_add_u32 s29, s29, s25
    s_add_u32 s37, s37, 1
    s_cmp_ge_u32 s37, 5
    s_cselect_b32 s37, 0, s37
    s_add_u32 m0, s26, 102400
    s_nop 0
    buffer_load_dwordx4 v5, s[12:15], s29 offen offset:0 sc1 lds
    buffer_load_dwordx4 v5, s[12:15], s29 offen offset:1024 sc1 lds
    buffer_load_dwordx4 v5, s[12:15], s29 offen offset:2048 sc1 lds
    buffer_load_dwordx4 v5, s[12:15], s29 offen offset:3072 sc1 lds
    s_add_u32 m0, s26, 106496
    s_nop 0
    buffer_load_dwordx4 v6, s[12:15], s29 offen sc1 lds
    s_mul_i32 s29, s37, 20480
    s_add_u32 s29, s29, s25
    s_add_u32 s37, s37, 1
    s_cmp_ge_u32 s37, 5
    s_cselect_b32 s37, 0, s37
    s_add_u32 m0, s26, 0
    s_nop 0
    buffer_load_dwordx4 v5, s[12:15], s29 offen offset:0 sc1 lds
    buffer_load_dwordx4 v5, s[12:15], s29 offen offset:1024 sc1 lds
    buffer_load_dwordx4 v5, s[12:15], s29 offen offset:2048 sc1 lds
    buffer_load_dwordx4 v5, s[12:15], s29 offen offset:3072 sc1 lds
    s_add_u32 m0, s26, 4096
    s_nop 0
    buffer_load_dwordx4 v6, s[12:15], s29 offen sc1 lds
    s_mul_i32 s29, s37, 20480
    s_add_u32 s29, s29, s25
    s_add_u32 s37, s37, 1
    s_cmp_ge_u32 s37, 5
    s_cselect_b32 s37, 0, s37
    s_add_u32 m0, s26, 20480
    s_nop 0
    buffer_load_dwordx4 v5, s[12:15], s29 offen offset:0 sc1 lds
    buffer_load_dwordx4 v5, s[12:15], s29 offen offset:1024 sc1 lds
    buffer_load_dwordx4 v5, s[12:15], s29 offen offset:2048 sc1 lds
    buffer_load_dwordx4 v5, s[12:15], s29 offen offset:3072 sc1 lds
    s_add_u32 m0, s26, 24576
    s_nop 0
    buffer_load_dwordx4 v6, s[12:15], s29 offen sc1 lds
    s_barrier
    s_waitcnt vmcnt(20)
    s_barrier
    s_waitcnt vmcnt(15)
    s_waitcnt vmcnt(0) lgkmcnt(0)
    s_barrier
    s_lshl_b32 s36, s2, 2
    s_add_u32 s36, s36, 14336
    s_cmp_lg_u32 s3, 4
    s_cbranch_scc1 L_sig_rp
    s_add_u32 s36, s36, 29622272
    v_lshlrev_b32 v250, 14, v2
    v_add_u32 v250, s36, v250
    v_mov_b32 v251, s83
    s_mov_b64 exec, 0xffff
    global_store_dword v250, v251, s[84:85] sc1
    s_mov_b64 exec, -1
L_sig_rp:
    s_nop 1
    s_barrier
    s_barrier
    s_barrier
    s_branch L_sigb_p3
L_p3_comp:
    s_mov_b32 s16, s86
    s_and_b32 s17, s87, 0xffff
    s_mov_b32 s18, 2621440
    s_mov_b32 s19, 0x00020000
    s_mov_b32 s24, s3
    v_and_b32 v3, 15, v2
    v_lshrrev_b32 v4, 4, v2
    s_lshl_b32 s31, s22, 2
    s_add_u32 s31, s31, s24
    s_mul_i32 s27, s31, 20480
    s_add_u32 s27, s27, 10747904
    s_mul_i32 s32, s23, 320
    s_add_u32 s32, s32, 5120
    v_lshlrev_b32 v13, 4, v4
    s_lshr_b32 s33, s31, 1
    s_mul_i32 s33, s33, 40960
    s_mul_i32 s34, s23, 5120
    s_add_u32 s33, s33, s34
    s_add_u32 s33, s33, 13369344
    s_and_b32 s34, s31, 1
    s_lshl_b32 s34, s34, 8
    v_lshl_add_u32 v14, v3, 4, s34
    v_lshrrev_b32 v15, 1, v4
    v_lshl_add_u32 v14, v15, 9, v14
    v_and_b32 v15, 1, v4
    v_lshl_add_u32 v14, v15, 3, v14
    s_mul_i32 s34, s31, 20480
    s_mul_i32 s35, s23, 160
    s_add_u32 s34, s34, s35
    v_mul_u32_u24 v15, 1280, v3
    v_lshl_add_u32 v15, v4, 3, v15
    v_add_u32 v21, 4096, v14
    v_add_u32 v7, 61440, v5
    v_add_u32 v8, 122880, v5
    s_lshr_b32 s36, s22, 1
    s_lshl_b32 s36, s36, 7
    s_add_u32 s36, s36, 8192
    buffer_load_dwordx4 v[132:135], v13, s[12:15], s32 offen offset:0 sc1
    buffer_load_dwordx2 v[152:153], v15, s[16:19], s34 offen offset:0
    buffer_load_dwordx4 v[136:139], v13, s[12:15], s32 offen offset:64 sc1
    buffer_load_dwordx2 v[154:155], v15, s[16:19], s34 offen offset:32
    buffer_load_dwordx4 v[140:143], v13, s[12:15], s32 offen offset:128 sc1
    buffer_load_dwordx2 v[156:157], v15, s[16:19], s34 offen offset:64
    buffer_load_dwordx4 v[144:147], v13, s[12:15], s32 offen offset:192 sc1
    buffer_load_dwordx2 v[158:159], v15, s[16:19], s34 offen offset:96
    buffer_load_dwordx4 v[148:151], v13, s[12:15], s32 offen offset:256 sc1
    buffer_load_dwordx2 v[160:161], v15, s[16:19], s34 offen offset:128
    s_cmp_lg_u32 s3, 0
    s_cbranch_scc1 L_wt_p3
    s_and_b32 s82, s2, 15
    s_lshl_b32 s82, s82, 14
    s_add_u32 s82, s82, 29622272
    s_add_u32 s4, s84, s82
    s_addc_u32 s5, s85, 0
    s_mov_b32 s6, s83
    s_mov_b32 s7, s83
    s_mov_b32 s82, 0x200000
L_wl_p3:
    s_load_dwordx16 s[48:63], s[4:5], s36 glc
    s_waitcnt lgkmcnt(0)
    s_xor_b64 s[48:49], s[48:49], s[6:7]
    s_xor_b64 s[50:51], s[50:51], s[6:7]
    s_xor_b64 s[52:53], s[52:53], s[6:7]
    s_xor_b64 s[54:55], s[54:55], s[6:7]
    s_xor_b64 s[56:57], s[56:57], s[6:7]
    s_xor_b64 s[58:59], s[58:59], s[6:7]
    s_xor_b64 s[60:61], s[60:61], s[6:7]
    s_xor_b64 s[62:63], s[62:63], s[6:7]
    s_or_b64 s[48:49], s[48:49], s[50:51]
    s_or_b64 s[48:49], s[48:49], s[52:53]
    s_or_b64 s[48:49], s[48:49], s[54:55]
    s_or_b64 s[48:49], s[48:49], s[56:57]
    s_or_b64 s[48:49], s[48:49], s[58:59]
    s_or_b64 s[48:49], s[48:49], s[60:61]
    s_or_b64 s[48:49], s[48:49], s[62:63]
    s_cbranch_scc0 L_wt_p3
    s_sleep 1
    s_sub_u32 s82, s82, 1
    s_cmp_lg_u32 s82, 0
    s_cbranch_scc1 L_wl_p3
L_wt_p3:
    s_nop 1
    s_waitcnt vmcnt(0) lgkmcnt(0)
    s_barrier
    s_lshl_b32 s30, s37, 12
    s_add_u32 s30, s30, s27
    s_add_u32 s37, s37, 1
    s_cmp_ge_u32 s37, 5
    s_cselect_b32 s37, 0, s37
    buffer_load_dwordx4 v[164:167], v5, s[12:15], s30 offen offset:0 sc1
    buffer_load_dwordx4 v[168:171], v5, s[12:15], s30 offen offset:1024 sc1
    buffer_load_dwordx4 v[172:175], v5, s[12:15], s30 offen offset:2048 sc1
    buffer_load_dwordx4 v[176:179], v5, s[12:15], s30 offen offset:3072 sc1
    s_lshl_b32 s30, s37, 12
    s_add_u32 s30, s30, s27
    s_add_u32 s37, s37, 1
    s_cmp_ge_u32 s37, 5
    s_cselect_b32 s37, 0, s37
    buffer_load_dwordx4 v[180:183], v5, s[12:15], s30 offen offset:0 sc1
    buffer_load_dwordx4 v[184:187], v5, s[12:15], s30 offen offset:1024 sc1
    buffer_load_dwordx4 v[188:191], v5, s[12:15], s30 offen offset:2048 sc1
    buffer_load_dwordx4 v[192:195], v5, s[12:15], s30 offen offset:3072 sc1
    s_lshl_b32 s30, s37, 12
    s_add_u32 s30, s30, s27
    s_add_u32 s37, s37, 1
    s_cmp_ge_u32 s37, 5
    s_cselect_b32 s37, 0, s37
    buffer_load_dwordx4 v[196:199], v5, s[12:15], s30 offen offset:0 sc1
    buffer_load_dwordx4 v[200:203], v5, s[12:15], s30 offen offset:1024 sc1
    buffer_load_dwordx4 v[204:207], v5, s[12:15], s30 offen offset:2048 sc1
    buffer_load_dwordx4 v[208:211], v5, s[12:15], s30 offen offset:3072 sc1
    s_lshl_b32 s30, s37, 12
    s_add_u32 s30, s30, s27
    s_add_u32 s37, s37, 1
    s_cmp_ge_u32 s37, 5
    s_cselect_b32 s37, 0, s37
    buffer_load_dwordx4 v[212:215], v5, s[12:15], s30 offen offset:0 sc1
    buffer_load_dwordx4 v[216:219], v5, s[12:15], s30 offen offset:1024 sc1
    buffer_load_dwordx4 v[220:223], v5, s[12:15], s30 offen offset:2048 sc1
    buffer_load_dwordx4 v[224:227], v5, s[12:15], s30 offen offset:3072 sc1
    s_barrier
    ds_read_b128 v[52:55], v7 offset:0
    ds_read_b128 v[56:59], v7 offset:1024
    ds_read_b128 v[60:63], v7 offset:2048
    ds_read_b128 v[64:67], v7 offset:3072
    ds_read_b128 v[68:71], v7 offset:4096
    ds_read_b128 v[72:75], v7 offset:5120
    ds_read_b128 v[76:79], v7 offset:6144
    ds_read_b128 v[80:83], v7 offset:7168
    ds_read_b128 v[84:87], v7 offset:8192
    ds_read_b128 v[88:91], v7 offset:9216
    ds_read_b128 v[92:95], v7 offset:10240
    ds_read_b128 v[96:99], v7 offset:11264
    ds_read_b128 v[100:103], v7 offset:12288
    ds_read_b128 v[104:107], v7 offset:13312
    ds_read_b128 v[108:111], v7 offset:14336
    s_waitcnt vmcnt(15) lgkmcnt(14)
    v_mfma_f32_16x16x32_bf16 v[32:35], v[52:55], v[164:167], 0
    ds_read_b128 v[112:115], v7 offset:15360
    s_waitcnt lgkmcnt(14)
    v_mfma_f32_16x16x32_bf16 v[36:39], v[56:59], v[164:167], 0
    ds_read_b128 v[116:119], v7 offset:16384
    s_waitcnt lgkmcnt(14)
    v_mfma_f32_16x16x32_bf16 v[40:43], v[60:63], v[164:167], 0
    ds_read_b128 v[120:123], v7 offset:17408
    s_waitcnt lgkmcnt(14)
    v_mfma_f32_16x16x32_bf16 v[44:47], v[64:67], v[164:167], 0
    ds_read_b128 v[124:127], v7 offset:18432
    s_waitcnt lgkmcnt(14)
    v_mfma_f32_16x16x32_bf16 v[48:51], v[68:71], v[164:167], 0
    ds_read_b128 v[128:131], v7 offset:19456
    s_lshl_b32 s30, s37, 12
    s_add_u32 s30, s30, s27
    s_add_u32 s37, s37, 1
    s_cmp_ge_u32 s37, 5
    s_cselect_b32 s37, 0, s37
    buffer_load_dwordx4 v[228:231], v5, s[12:15], s30 offen offset:0 sc1
    buffer_load_dwordx4 v[232:235], v5, s[12:15], s30 offen offset:1024 sc1
    buffer_load_dwordx4 v[236:239], v5, s[12:15], s30 offen offset:2048 sc1
    buffer_load_dwordx4 v[240:243], v5, s[12:15], s30 offen offset:3072 sc1
    s_barrier
    s_waitcnt vmcnt(18) lgkmcnt(14)
    v_mfma_f32_16x16x32_bf16 v[32:35], v[72:75], v[168:171], v[32:35]
    ds_read_b128 v[52:55], v7 offset:20480
    s_waitcnt lgkmcnt(14)
    v_mfma_f32_16x16x32_bf16 v[36:39], v[76:79], v[168:171], v[36:39]
    ds_read_b128 v[56:59], v7 offset:21504
    s_waitcnt lgkmcnt(14)
    v_mfma_f32_16x16x32_bf16 v[40:43], v[80:83], v[168:171], v[40:43]
    ds_read_b128 v[60:63], v7 offset:22528
    s_waitcnt lgkmcnt(14)
    v_mfma_f32_16x16x32_bf16 v[44:47], v[84:87], v[168:171], v[44:47]
    ds_read_b128 v[64:67], v7 offset:23552
    s_waitcnt lgkmcnt(14)
    v_mfma_f32_16x16x32_bf16 v[48:51], v[88:91], v[168:171], v[48:51]
    ds_read_b128 v[68:71], v7 offset:24576
    s_waitcnt vmcnt(17) lgkmcnt(14)
    v_mfma_f32_16x16x32_bf16 v[32:35], v[92:95], v[172:175], v[32:35]
    ds_read_b128 v[72:75], v7 offset:25600
    s_waitcnt lgkmcnt(14)
    v_mfma_f32_16x16x32_bf16 v[36:39], v[96:99], v[172:175], v[36:39]
    ds_read_b128 v[76:79], v7 offset:26624
    s_waitcnt lgkmcnt(14)
    v_mfma_f32_16x16x32_bf16 v[40:43], v[100:103], v[172:175], v[40:43]
    ds_read_b128 v[80:83], v7 offset:27648
    s_waitcnt lgkmcnt(14)
    v_mfma_f32_16x16x32_bf16 v[44:47], v[104:107], v[172:175], v[44:47]
    ds_read_b128 v[84:87], v7 offset:28672
    s_waitcnt lgkmcnt(14)
    v_mfma_f32_16x16x32_bf16 v[48:51], v[108:111], v[172:175], v[48:51]
    ds_read_b128 v[88:91], v7 offset:29696
    s_waitcnt vmcnt(16) lgkmcnt(14)
    v_mfma_f32_16x16x32_bf16 v[32:35], v[112:115], v[176:179], v[32:35]
    ds_read_b128 v[92:95], v7 offset:30720
    s_waitcnt lgkmcnt(14)
    v_mfma_f32_16x16x32_bf16 v[36:39], v[116:119], v[176:179], v[36:39]
    ds_read_b128 v[96:99], v7 offset:31744
    s_waitcnt lgkmcnt(14)
    v_mfma_f32_16x16x32_bf16 v[40:43], v[120:123], v[176:179], v[40:43]
    ds_read_b128 v[100:103], v7 offset:32768
    s_waitcnt lgkmcnt(14)
    v_mfma_f32_16x16x32_bf16 v[44:47], v[124:127], v[176:179], v[44:47]
    ds_read_b128 v[104:107], v7 offset:33792
    s_waitcnt lgkmcnt(14)
    v_mfma_f32_16x16x32_bf16 v[48:51], v[128:131], v[176:179], v[48:51]
    ds_read_b128 v[108:111], v7 offset:34816
    s_waitcnt vmcnt(15) lgkmcnt(14)
    v_mfma_f32_16x16x32_bf16 v[32:35], v[52:55], v[180:183], v[32:35]
    ds_read_b128 v[112:115], v7 offset:35840
    s_waitcnt lgkmcnt(14)
    v_mfma_f32_16x16x32_bf16 v[36:39], v[56:59], v[180:183], v[36:39]
    ds_read_b128 v[116:119], v7 offset:36864
    s_waitcnt lgkmcnt(14)
    v_mfma_f32_16x16x32_bf16 v[40:43], v[60:63], v[180:183], v[40:43]
    ds_read_b128 v[120:123], v7 offset:37888
    s_waitcnt lgkmcnt(14)
    v_mfma_f32_16x16x32_bf16 v[44:47], v[64:67], v[180:183], v[44:47]
    ds_read_b128 v[124:127], v7 offset:38912
    s_waitcnt lgkmcnt(14)
    v_mfma_f32_16x16x32_bf16 v[48:51], v[68:71], v[180:183], v[48:51]
    ds_read_b128 v[128:131], v7 offset:39936
    s_barrier
    s_waitcnt vmcnt(14) lgkmcnt(14)
    v_mfma_f32_16x16x32_bf16 v[32:35], v[72:75], v[184:187], v[32:35]
    ds_read_b128 v[52:55], v7 offset:40960
    s_waitcnt lgkmcnt(14)
    v_mfma_f32_16x16x32_bf16 v[36:39], v[76:79], v[184:187], v[36:39]
    ds_read_b128 v[56:59], v7 offset:41984
    s_waitcnt lgkmcnt(14)
    v_mfma_f32_16x16x32_bf16 v[40:43], v[80:83], v[184:187], v[40:43]
    ds_read_b128 v[60:63], v7 offset:43008
    s_waitcnt lgkmcnt(14)
    v_mfma_f32_16x16x32_bf16 v[44:47], v[84:87], v[184:187], v[44:47]
    ds_read_b128 v[64:67], v7 offset:44032
    s_waitcnt lgkmcnt(14)
    v_mfma_f32_16x16x32_bf16 v[48:51], v[88:91], v[184:187], v[48:51]
    ds_read_b128 v[68:71], v7 offset:45056
    s_waitcnt vmcnt(13) lgkmcnt(14)
    v_mfma_f32_16x16x32_bf16 v[32:35], v[92:95], v[188:191], v[32:35]
    ds_read_b128 v[72:75], v7 offset:46080
    s_waitcnt lgkmcnt(14)
    v_mfma_f32_16x16x32_bf16 v[36:39], v[96:99], v[188:191], v[36:39]
    ds_read_b128 v[76:79], v7 offset:47104
    s_waitcnt lgkmcnt(14)
    v_mfma_f32_16x16x32_bf16 v[40:43], v[100:103], v[188:191], v[40:43]
    ds_read_b128 v[80:83], v7 offset:48128
    s_waitcnt lgkmcnt(14)
    v_mfma_f32_16x16x32_bf16 v[44:47], v[104:107], v[188:191], v[44:47]
    ds_read_b128 v[84:87], v7 offset:49152
    s_waitcnt lgkmcnt(14)
    v_mfma_f32_16x16x32_bf16 v[48:51], v[108:111], v[188:191], v[48:51]
    ds_read_b128 v[88:91], v7 offset:50176
    s_waitcnt vmcnt(12) lgkmcnt(14)
    v_mfma_f32_16x16x32_bf16 v[32:35], v[112:115], v[192:195], v[32:35]
    ds_read_b128 v[92:95], v7 offset:51200
    s_waitcnt lgkmcnt(14)
    v_mfma_f32_16x16x32_bf16 v[36:39], v[116:119], v[192:195], v[36:39]
    ds_read_b128 v[96:99], v7 offset:52224
    s_waitcnt lgkmcnt(14)
    v_mfma_f32_16x16x32_bf16 v[40:43], v[120:123], v[192:195], v[40:43]
    ds_read_b128 v[100:103], v7 offset:53248
    s_waitcnt lgkmcnt(14)
    v_mfma_f32_16x16x32_bf16 v[44:47], v[124:127], v[192:195], v[44:47]
    ds_read_b128 v[104:107], v7 offset:54272
    s_waitcnt lgkmcnt(14)
    v_mfma_f32_16x16x32_bf16 v[48:51], v[128:131], v[192:195], v[48:51]
    ds_read_b128 v[108:111], v7 offset:55296
    s_waitcnt vmcnt(11) lgkmcnt(14)
    v_mfma_f32_16x16x32_bf16 v[32:35], v[52:55], v[196:199], v[32:35]
    ds_read_b128 v[112:115], v7 offset:56320
    s_waitcnt lgkmcnt(14)
    v_mfma_f32_16x16x32_bf16 v[36:39], v[56:59], v[196:199], v[36:39]
    ds_read_b128 v[116:119], v7 offset:57344
    s_waitcnt lgkmcnt(14)
    v_mfma_f32_16x16x32_bf16 v[40:43], v[60:63], v[196:199], v[40:43]
    ds_read_b128 v[120:123], v7 offset:58368
    s_waitcnt lgkmcnt(14)
    v_mfma_f32_16x16x32_bf16 v[44:47], v[64:67], v[196:199], v[44:47]
    ds_read_b128 v[124:127], v7 offset:59392
    s_waitcnt lgkmcnt(14)
    v_mfma_f32_16x16x32_bf16 v[48:51], v[68:71], v[196:199], v[48:51]
    ds_read_b128 v[128:131], v7 offset:60416
    s_barrier
    s_waitcnt vmcnt(10) lgkmcnt(14)
    v_mfma_f32_16x16x32_bf16 v[32:35], v[72:75], v[200:203], v[32:35]
    ds_read_b128 v[52:55], v5 offset:0
    s_waitcnt lgkmcnt(14)
    v_mfma_f32_16x16x32_bf16 v[36:39], v[76:79], v[200:203], v[36:39]
    ds_read_b128 v[56:59], v5 offset:1024
    s_waitcnt lgkmcnt(14)
    v_mfma_f32_16x16x32_bf16 v[40:43], v[80:83], v[200:203], v[40:43]
    ds_read_b128 v[60:63], v5 offset:2048
    s_waitcnt lgkmcnt(14)
    v_mfma_f32_16x16x32_bf16 v[44:47], v[84:87], v[200:203], v[44:47]
    ds_read_b128 v[64:67], v5 offset:3072
    s_waitcnt lgkmcnt(14)
    v_mfma_f32_16x16x32_bf16 v[48:51], v[88:91], v[200:203], v[48:51]
    ds_read_b128 v[68:71], v5 offset:4096
    s_waitcnt vmcnt(9) lgkmcnt(14)
    v_mfma_f32_16x16x32_bf16 v[32:35], v[92:95], v[204:207], v[32:35]
    ds_read_b128 v[72:75], v5 offset:5120
    s_waitcnt lgkmcnt(14)
    v_mfma_f32_16x16x32_bf16 v[36:39], v[96:99], v[204:207], v[36:39]
    ds_read_b128 v[76:79], v5 offset:6144
    s_waitcnt lgkmcnt(14)
    v_mfma_f32_16x16x32_bf16 v[40:43], v[100:103], v[204:207], v[40:43]
    ds_read_b128 v[80:83], v5 offset:7168
    s_waitcnt lgkmcnt(14)
    v_mfma_f32_16x16x32_bf16 v[44:47], v[104:107], v[204:207], v[44:47]
    ds_read_b128 v[84:87], v5 offset:8192
    s_waitcnt lgkmcnt(14)
    v_mfma_f32_16x16x32_bf16 v[48:51], v[108:111], v[204:207], v[48:51]
    ds_read_b128 v[88:91], v5 offset:9216
    s_waitcnt vmcnt(8) lgkmcnt(14)
    v_mfma_f32_16x16x32_bf16 v[32:35], v[112:115], v[208:211], v[32:35]
    ds_read_b128 v[92:95], v5 offset:10240
    s_waitcnt lgkmcnt(14)
    v_mfma_f32_16x16x32_bf16 v[36:39], v[116:119], v[208:211], v[36:39]
    ds_read_b128 v[96:99], v5 offset:11264
    s_waitcnt lgkmcnt(14)
    v_mfma_f32_16x16x32_bf16 v[40:43], v[120:123], v[208:211], v[40:43]
    ds_read_b128 v[100:103], v5 offset:12288
    s_waitcnt lgkmcnt(14)
    v_mfma_f32_16x16x32_bf16 v[44:47], v[124:127], v[208:211], v[44:47]
    ds_read_b128 v[104:107], v5 offset:13312
    s_waitcnt lgkmcnt(14)
    v_mfma_f32_16x16x32_bf16 v[48:51], v[128:131], v[208:211], v[48:51]
    ds_read_b128 v[108:111], v5 offset:14336
    s_waitcnt vmcnt(7) lgkmcnt(14)
    v_mfma_f32_16x16x32_bf16 v[32:35], v[52:55], v[212:215], v[32:35]
    ds_read_b128 v[112:115], v5 offset:15360
    s_waitcnt lgkmcnt(14)
    v_mfma_f32_16x16x32_bf16 v[36:39], v[56:59], v[212:215], v[36:39]
    ds_read_b128 v[116:119], v5 offset:16384
    s_waitcnt lgkmcnt(14)
    v_mfma_f32_16x16x32_bf16 v[40:43], v[60:63], v[212:215], v[40:43]
    ds_read_b128 v[120:123], v5 offset:17408
    s_waitcnt lgkmcnt(14)
    v_mfma_f32_16x16x32_bf16 v[44:47], v[64:67], v[212:215], v[44:47]
    ds_read_b128 v[124:127], v5 offset:18432
    s_waitcnt lgkmcnt(14)
    v_mfma_f32_16x16x32_bf16 v[48:51], v[68:71], v[212:215], v[48:51]
    ds_read_b128 v[128:131], v5 offset:19456
    s_barrier
    s_waitcnt vmcnt(6) lgkmcnt(14)
    v_mfma_f32_16x16x32_bf16 v[32:35], v[72:75], v[216:219], v[32:35]
    ds_read_b128 v[52:55], v5 offset:20480
    s_waitcnt lgkmcnt(14)
    v_mfma_f32_16x16x32_bf16 v[36:39], v[76:79], v[216:219], v[36:39]
    ds_read_b128 v[56:59], v5 offset:21504
    s_waitcnt lgkmcnt(14)
    v_mfma_f32_16x16x32_bf16 v[40:43], v[80:83], v[216:219], v[40:43]
    ds_read_b128 v[60:63], v5 offset:22528
    s_waitcnt lgkmcnt(14)
    v_mfma_f32_16x16x32_bf16 v[44:47], v[84:87], v[216:219], v[44:47]
    ds_read_b128 v[64:67], v5 offset:23552
    s_waitcnt lgkmcnt(14)
    v_mfma_f32_16x16x32_bf16 v[48:51], v[88:91], v[216:219], v[48:51]
    ds_read_b128 v[68:71], v5 offset:24576
    s_waitcnt vmcnt(5) lgkmcnt(14)
    v_mfma_f32_16x16x32_bf16 v[32:35], v[92:95], v[220:223], v[32:35]
    ds_read_b128 v[72:75], v5 offset:25600
    s_waitcnt lgkmcnt(14)
    v_mfma_f32_16x16x32_bf16 v[36:39], v[96:99], v[220:223], v[36:39]
    ds_read_b128 v[76:79], v5 offset:26624
    s_waitcnt lgkmcnt(14)
    v_mfma_f32_16x16x32_bf16 v[40:43], v[100:103], v[220:223], v[40:43]
    ds_read_b128 v[80:83], v5 offset:27648
    s_waitcnt lgkmcnt(14)
    v_mfma_f32_16x16x32_bf16 v[44:47], v[104:107], v[220:223], v[44:47]
    ds_read_b128 v[84:87], v5 offset:28672
    s_waitcnt lgkmcnt(14)
    v_mfma_f32_16x16x32_bf16 v[48:51], v[108:111], v[220:223], v[48:51]
    ds_read_b128 v[88:91], v5 offset:29696
    s_waitcnt vmcnt(4) lgkmcnt(14)
    v_mfma_f32_16x16x32_bf16 v[32:35], v[112:115], v[224:227], v[32:35]
    ds_read_b128 v[92:95], v5 offset:30720
    s_waitcnt lgkmcnt(14)
    v_mfma_f32_16x16x32_bf16 v[36:39], v[116:119], v[224:227], v[36:39]
    ds_read_b128 v[96:99], v5 offset:31744
    s_waitcnt lgkmcnt(14)
    v_mfma_f32_16x16x32_bf16 v[40:43], v[120:123], v[224:227], v[40:43]
    ds_read_b128 v[100:103], v5 offset:32768
    s_waitcnt lgkmcnt(14)
    v_mfma_f32_16x16x32_bf16 v[44:47], v[124:127], v[224:227], v[44:47]
    ds_read_b128 v[104:107], v5 offset:33792
    s_waitcnt lgkmcnt(14)
    v_mfma_f32_16x16x32_bf16 v[48:51], v[128:131], v[224:227], v[48:51]
    ds_read_b128 v[108:111], v5 offset:34816
    s_waitcnt vmcnt(3) lgkmcnt(14)
    v_mfma_f32_16x16x32_bf16 v[32:35], v[52:55], v[228:231], v[32:35]
    ds_read_b128 v[112:115], v5 offset:35840
    s_waitcnt lgkmcnt(14)
    v_mfma_f32_16x16x32_bf16 v[36:39], v[56:59], v[228:231], v[36:39]
    ds_read_b128 v[116:119], v5 offset:36864
    s_waitcnt lgkmcnt(14)
    v_mfma_f32_16x16x32_bf16 v[40:43], v[60:63], v[228:231], v[40:43]
    ds_read_b128 v[120:123], v5 offset:37888
    s_waitcnt lgkmcnt(14)
    v_mfma_f32_16x16x32_bf16 v[44:47], v[64:67], v[228:231], v[44:47]
    ds_read_b128 v[124:127], v5 offset:38912
    s_waitcnt lgkmcnt(14)
    v_mfma_f32_16x16x32_bf16 v[48:51], v[68:71], v[228:231], v[48:51]
    ds_read_b128 v[128:131], v5 offset:39936
    s_waitcnt vmcnt(2) lgkmcnt(14)
    v_mfma_f32_16x16x32_bf16 v[32:35], v[72:75], v[232:235], v[32:35]
    s_waitcnt lgkmcnt(13)
    v_mfma_f32_16x16x32_bf16 v[36:39], v[76:79], v[232:235], v[36:39]
    s_waitcnt lgkmcnt(12)
    v_mfma_f32_16x16x32_bf16 v[40:43], v[80:83], v[232:235], v[40:43]
    s_waitcnt lgkmcnt(11)
    v_mfma_f32_16x16x32_bf16 v[44:47], v[84:87], v[232:235], v[44:47]
    s_waitcnt lgkmcnt(10)
    v_mfma_f32_16x16x32_bf16 v[48:51], v[88:91], v[232:235], v[48:51]
    s_waitcnt vmcnt(1) lgkmcnt(9)
    v_mfma_f32_16x16x32_bf16 v[32:35], v[92:95], v[236:239], v[32:35]
    s_waitcnt lgkmcnt(8)
    v_mfma_f32_16x16x32_bf16 v[36:39], v[96:99], v[236:239], v[36:39]
    s_waitcnt lgkmcnt(7)
    v_mfma_f32_16x16x32_bf16 v[40:43], v[100:103], v[236:239], v[40:43]
    s_waitcnt lgkmcnt(6)
    v_mfma_f32_16x16x32_bf16 v[44:47], v[104:107], v[236:239], v[44:47]
    s_waitcnt lgkmcnt(5)
    v_mfma_f32_16x16x32_bf16 v[48:51], v[108:111], v[236:239], v[48:51]
    s_waitcnt vmcnt(0) lgkmcnt(4)
    v_mfma_f32_16x16x32_bf16 v[32:35], v[112:115], v[240:243], v[32:35]
    s_waitcnt lgkmcnt(3)
    v_mfma_f32_16x16x32_bf16 v[36:39], v[116:119], v[240:243], v[36:39]
    s_waitcnt lgkmcnt(2)
    v_mfma_f32_16x16x32_bf16 v[40:43], v[120:123], v[240:243], v[40:43]
    s_waitcnt lgkmcnt(1)
    v_mfma_f32_16x16x32_bf16 v[44:47], v[124:127], v[240:243], v[44:47]
    s_waitcnt lgkmcnt(0)
    v_mfma_f32_16x16x32_bf16 v[48:51], v[128:131], v[240:243], v[48:51]
    s_mov_b32 s30, 0xffff0000
    v_mov_b32 v26, 0
    v_mov_b32 v27, 0
    v_and_b32 v22, 1, v4
    v_lshlrev_b32 v23, 3, v22
    v_sub_u32 v23, v14, v23
    v_lshl_add_u32 v22, v22, 10, v23
    v_add_u32 v23, 4096, v23
    v_cvt_pk_bf16_f32 v52, v32, v33
    v_cvt_pk_bf16_f32 v53, v34, v35
    v_lshlrev_b32 v32, 16, v52
    v_and_b32 v33, s30, v52
    v_lshlrev_b32 v34, 16, v53
    v_and_b32 v35, s30, v53
    v_mul_f32 v32, v32, v132
    v_mul_f32 v33, v33, v133
    v_mul_f32 v34, v34, v134
    v_mul_f32 v35, v35, v135
    v_cvt_pk_bf16_f32 v52, v32, v33
    v_cvt_pk_bf16_f32 v53, v34, v35
    v_lshlrev_b32 v32, 16, v52
    v_and_b32 v33, s30, v52
    v_lshlrev_b32 v34, 16, v53
    v_and_b32 v35, s30, v53
    v_lshlrev_b32 v54, 16, v152
    v_and_b32 v55, s30, v152
    v_lshlrev_b32 v56, 16, v153
    v_and_b32 v57, s30, v153
    v_add_f32 v32, v32, v54
    v_add_f32 v33, v33, v55
    v_add_f32 v34, v34, v56
    v_add_f32 v35, v35, v57
    v_cvt_pk_bf16_f32 v68, v32, v33
    v_cvt_pk_bf16_f32 v69, v34, v35
    v_lshlrev_b32 v32, 16, v68
    v_and_b32 v33, s30, v68
    v_lshlrev_b32 v34, 16, v69
    v_and_b32 v35, s30, v69
    v_add_f32 v26, v26, v32
    v_fmac_f32 v27, v32, v32
    v_add_f32 v26, v26, v33
    v_fmac_f32 v27, v33, v33
    v_add_f32 v26, v26, v34
    v_fmac_f32 v27, v34, v34
    v_add_f32 v26, v26, v35
    v_fmac_f32 v27, v35, v35
    v_mov_b32 v236, v68
    v_mov_b32 v237, v69
    v_cvt_pk_bf16_f32 v60, v36, v37
    v_cvt_pk_bf16_f32 v61, v38, v39
    v_lshlrev_b32 v36, 16, v60
    v_and_b32 v37, s30, v60
    v_lshlrev_b32 v38, 16, v61
    v_and_b32 v39, s30, v61
    v_mul_f32 v36, v36, v136
    v_mul_f32 v37, v37, v137
    v_mul_f32 v38, v38, v138
    v_mul_f32 v39, v39, v139
    v_cvt_pk_bf16_f32 v60, v36, v37
    v_cvt_pk_bf16_f32 v61, v38, v39
    v_lshlrev_b32 v36, 16, v60
    v_and_b32 v37, s30, v60
    v_lshlrev_b32 v38, 16, v61
    v_and_b32 v39, s30, v61
    v_lshlrev_b32 v62, 16, v154
    v_and_b32 v63, s30, v154
    v_lshlrev_b32 v64, 16, v155
    v_and_b32 v65, s30, v155
    v_add_f32 v36, v36, v62
    v_add_f32 v37, v37, v63
    v_add_f32 v38, v38, v64
    v_add_f32 v39, v39, v65
    v_cvt_pk_bf16_f32 v70, v36, v37
    v_cvt_pk_bf16_f32 v71, v38, v39
    v_lshlrev_b32 v36, 16, v70
    v_and_b32 v37, s30, v70
    v_lshlrev_b32 v38, 16, v71
    v_and_b32 v39, s30, v71
    v_add_f32 v26, v26, v36
    v_fmac_f32 v27, v36, v36
    v_add_f32 v26, v26, v37
    v_fmac_f32 v27, v37, v37
    v_add_f32 v26, v26, v38
    v_fmac_f32 v27, v38, v38
    v_add_f32 v26, v26, v39
    v_fmac_f32 v27, v39, v39
    v_mov_b32 v238, v70
    v_mov_b32 v239, v71
    v_permlane16_swap_b32 v68, v70
    v_permlane16_swap_b32 v69, v71
    buffer_store_dwordx4 v[68:71], v22, s[12:15], s33 offen offset:0 sc1
    v_cvt_pk_bf16_f32 v52, v40, v41
    v_cvt_pk_bf16_f32 v53, v42, v43
    v_lshlrev_b32 v40, 16, v52
    v_and_b32 v41, s30, v52
    v_lshlrev_b32 v42, 16, v53
    v_and_b32 v43, s30, v53
    v_mul_f32 v40, v40, v140
    v_mul_f32 v41, v41, v141
    v_mul_f32 v42, v42, v142
    v_mul_f32 v43, v43, v143
    v_cvt_pk_bf16_f32 v52, v40, v41
    v_cvt_pk_bf16_f32 v53, v42, v43
    v_lshlrev_b32 v40, 16, v52
    v_and_b32 v41, s30, v52
    v_lshlrev_b32 v42, 16, v53
    v_and_b32 v43, s30, v53
    v_lshlrev_b32 v54, 16, v156
    v_and_b32 v55, s30, v156
    v_lshlrev_b32 v56, 16, v157
    v_and_b32 v57, s30, v157
    v_add_f32 v40, v40, v54
    v_add_f32 v41, v41, v55
    v_add_f32 v42, v42, v56
    v_add_f32 v43, v43, v57
    v_cvt_pk_bf16_f32 v72, v40, v41
    v_cvt_pk_bf16_f32 v73, v42, v43
    v_lshlrev_b32 v40, 16, v72
    v_and_b32 v41, s30, v72
    v_lshlrev_b32 v42, 16, v73
    v_and_b32 v43, s30, v73
    v_add_f32 v26, v26, v40
    v_fmac_f32 v27, v40, v40
    v_add_f32 v26, v26, v41
    v_fmac_f32 v27, v41, v41
    v_add_f32 v26, v26, v42
    v_fmac_f32 v27, v42, v42
    v_add_f32 v26, v26, v43
    v_fmac_f32 v27, v43, v43
    v_mov_b32 v240, v72
    v_mov_b32 v241, v73
    v_cvt_pk_bf16_f32 v60, v44, v45
    v_cvt_pk_bf16_f32 v61, v46, v47
    v_lshlrev_b32 v44, 16, v60
    v_and_b32 v45, s30, v60
    v_lshlrev_b32 v46, 16, v61
    v_and_b32 v47, s30, v61
    v_mul_f32 v44, v44, v144
    v_mul_f32 v45, v45, v145
    v_mul_f32 v46, v46, v146
    v_mul_f32 v47, v47, v147
    v_cvt_pk_bf16_f32 v60, v44, v45
    v_cvt_pk_bf16_f32 v61, v46, v47
    v_lshlrev_b32 v44, 16, v60
    v_and_b32 v45, s30, v60
    v_lshlrev_b32 v46, 16, v61
    v_and_b32 v47, s30, v61
    v_lshlrev_b32 v62, 16, v158
    v_and_b32 v63, s30, v158
    v_lshlrev_b32 v64, 16, v159
    v_and_b32 v65, s30, v159
    v_add_f32 v44, v44, v62
    v_add_f32 v45, v45, v63
    v_add_f32 v46, v46, v64
    v_add_f32 v47, v47, v65
    v_cvt_pk_bf16_f32 v74, v44, v45
    v_cvt_pk_bf16_f32 v75, v46, v47
    v_lshlrev_b32 v44, 16, v74
    v_and_b32 v45, s30, v74
    v_lshlrev_b32 v46, 16, v75
    v_and_b32 v47, s30, v75
    v_add_f32 v26, v26, v44
    v_fmac_f32 v27, v44, v44
    v_add_f32 v26, v26, v45
    v_fmac_f32 v27, v45, v45
    v_add_f32 v26, v26, v46
    v_fmac_f32 v27, v46, v46
    v_add_f32 v26, v26, v47
    v_fmac_f32 v27, v47, v47
    v_mov_b32 v242, v74
    v_mov_b32 v243, v75
    v_permlane16_swap_b32 v72, v74
    v_permlane16_swap_b32 v73, v75
    buffer_store_dwordx4 v[72:75], v22, s[12:15], s33 offen offset:2048 sc1
    v_cvt_pk_bf16_f32 v52, v48, v49
    v_cvt_pk_bf16_f32 v53, v50, v51
    v_lshlrev_b32 v48, 16, v52
    v_and_b32 v49, s30, v52
    v_lshlrev_b32 v50, 16, v53
    v_and_b32 v51, s30, v53
    v_mul_f32 v48, v48, v148
    v_mul_f32 v49, v49, v149
    v_mul_f32 v50, v50, v150
    v_mul_f32 v51, v51, v151
    v_cvt_pk_bf16_f32 v52, v48, v49
    v_cvt_pk_bf16_f32 v53, v50, v51
    v_lshlrev_b32 v48, 16, v52
    v_and_b32 v49, s30, v52
    v_lshlrev_b32 v50, 16, v53
    v_and_b32 v51, s30, v53
    v_lshlrev_b32 v54, 16, v160
    v_and_b32 v55, s30, v160
    v_lshlrev_b32 v56, 16, v161
    v_and_b32 v57, s30, v161
    v_add_f32 v48, v48, v54
    v_add_f32 v49, v49, v55
    v_add_f32 v50, v50, v56
    v_add_f32 v51, v51, v57
    v_cvt_pk_bf16_f32 v76, v48, v49
    v_cvt_pk_bf16_f32 v77, v50, v51
    v_lshlrev_b32 v48, 16, v76
    v_and_b32 v49, s30, v76
    v_lshlrev_b32 v50, 16, v77
    v_and_b32 v51, s30, v77
    v_add_f32 v26, v26, v48
    v_fmac_f32 v27, v48, v48
    v_add_f32 v26, v26, v49
    v_fmac_f32 v27, v49, v49
    v_add_f32 v26, v26, v50
    v_fmac_f32 v27, v50, v50
    v_add_f32 v26, v26, v51
    v_fmac_f32 v27, v51, v51
    v_mov_b32 v244, v76
    v_mov_b32 v245, v77
    v_mov_b32 v78, v76
    v_mov_b32 v79, v77
    s_nop 0
    v_permlane16_swap_b32 v76, v78
    v_permlane16_swap_b32 v77, v79
    buffer_store_dwordx4 v[76:79], v23, s[12:15], s33 offen sc1
    v_mov_b32 v28, v26
    s_nop 1
    v_permlane16_swap_b32 v26, v28
    v_add_f32 v26, v26, v28
    v_mov_b32 v28, v26
    s_nop 1
    v_permlane32_swap_b32 v26, v28
    v_add_f32 v26, v26, v28
    v_mov_b32 v28, v27
    s_nop 1
    v_permlane16_swap_b32 v27, v28
    v_add_f32 v27, v27, v28
    v_mov_b32 v28, v27
    s_nop 1
    v_permlane32_swap_b32 v27, v28
    v_add_f32 v27, v27, v28
    s_lshl_b32 s38, s31, 10
    s_lshl_b32 s39, s23, 3
    s_add_u32 s38, s38, s39
    s_add_u32 s38, s38, 15990784
    v_lshlrev_b32 v28, 6, v3
    v_mov_b32 v29, 0x7ffffff0
    v_cmp_gt_u32 vcc, 16, v2
    s_nop 1
    v_cndmask_b32 v28, v29, v28, vcc
    buffer_store_dwordx2 v[26:27], v28, s[12:15], s38 offen sc1
L_p3_done:
    s_nop 11
    v_add_u32 v19, 14336, v5
    s_cmp_lg_u32 s3, 1
    s_cbranch_scc1 L_wt_crp
    s_and_b32 s82, s2, 15
    s_lshl_b32 s82, s82, 14
    s_add_u32 s82, s82, 29622272
    v_add_u32 v247, s82, v19
    s_mov_b32 s82, 0x200000
L_wl_crp:
    global_load_dwordx4 v[248:251], v247, s[84:85] sc1
    s_waitcnt vmcnt(0)
    v_xor_b32 v248, s83, v248
    v_xor_b32 v249, s83, v249
    v_xor_b32 v250, s83, v250
    v_xor_b32 v251, s83, v251
    v_or3_b32 v248, v248, v249, v250
    v_or_b32 v248, v248, v251
    v_cmp_ne_u32 vcc, 0, v248
    s_nop 4
    s_cbranch_vccz L_wd_crp
    s_sleep 4
    s_sub_u32 s82, s82, 1
    s_cmp_lg_u32 s82, 0
    s_cbranch_scc1 L_wl_crp
L_wd_crp:
    s_mov_b64 exec, -1
L_wt_crp:
    s_nop 1
    s_and_b32 s36, s22, 1
    s_lshl_b32 s36, s36, 3
    s_add_u32 s36, s36, s23
    s_lshl_b32 s36, s36, 2
    s_lshr_b32 s22, s22, 1
    s_lshl_b32 s22, s22, 7
    s_add_u32 s22, s22, s36
    s_add_u32 s22, s22, 10240
    s_waitcnt vmcnt(0) lgkmcnt(0)
L_sigb_p3:
    s_barrier
    s_cmp_lg_u32 s3, 0
    s_cbranch_scc1 L_sig_p3
    s_add_u32 s22, s22, 29622272
    v_lshlrev_b32 v250, 14, v2
    v_add_u32 v250, s22, v250
    v_mov_b32 v251, s83
    s_mov_b64 exec, 0xffff
    global_store_dword v250, v251, s[84:85] sc1
    s_mov_b64 exec, -1
L_sig_p3:
    s_nop 1
    s_and_b32 s20, s2, 7
    s_lshr_b32 s21, s2, 3
    s_and_b32 s22, s20, 3
    s_lshl_b32 s22, s22, 2
    s_and_b32 s23, s21, 3
    s_add_u32 s22, s22, s23
    s_lshr_b32 s23, s20, 2
    s_lshl_b32 s23, s23, 3
    s_lshr_b32 s21, s21, 2
    s_add_u32 s23, s23, s21
    s_mov_b32 s24, s3
    v_lshrrev_b32 v20, 5, v2
    v_lshlrev_b32 v5, 4, v2
    s_and_b32 s25, s24, 3
    s_lshr_b32 s26, s24, 2
    s_lshr_b32 s27, s24, 1
    s_lshl_b32 s28, s22, 2
    s_add_u32 s27, s27, s28
    s_mul_i32 s27, s27, 40960
    s_and_b32 s28, s24, 1
    s_lshl_b32 s28, s28, 11
    s_add_u32 s27, s27, s28
    s_add_u32 s27, s27, 13369344
    s_lshl_b32 s28, s24, 11
    s_mul_i32 s29, s24, 3
    s_mul_i32 s30, s23, 245760
    s_add_u32 s30, s30, 25231360
    s_add_u32 s31, s29, 0
    s_lshr_b32 s32, s31, 2
    s_mul_i32 s32, s32, 40960
    s_and_b32 s31, s31, 3
    s_lshl_b32 s31, s31, 10
    s_add_u32 s32, s32, s31
    s_add_u32 s40, s32, s30
    s_add_u32 s31, s29, 1
    s_lshr_b32 s32, s31, 2
    s_mul_i32 s32, s32, 40960
    s_and_b32 s31, s31, 3
    s_lshl_b32 s31, s31, 10
    s_add_u32 s32, s32, s31
    s_add_u32 s41, s32, s30
    s_add_u32 s31, s29, 2
    s_lshr_b32 s32, s31, 2
    s_mul_i32 s32, s32, 40960
    s_and_b32 s31, s31, 3
    s_lshl_b32 s31, s31, 10
    s_add_u32 s32, s32, s31
    s_add_u32 s42, s32, s30
    s_lshl_b32 s29, s29, 10
    s_add_u32 s29, s29, 16384
    s_add_u32 m0, s29, 0
    s_add_u32 s33, s40, 0
    buffer_load_dwordx4 v5, s[12:15], s33 offen sc1 lds
    s_add_u32 m0, s29, 1024
    s_add_u32 s33, s41, 0
    buffer_load_dwordx4 v5, s[12:15], s33 offen sc1 lds
    s_add_u32 m0, s29, 2048
    s_add_u32 s33, s42, 0
    buffer_load_dwordx4 v5, s[12:15], s33 offen sc1 lds
    s_add_u32 m0, s29, 40960
    s_add_u32 s33, s40, 4096
    buffer_load_dwordx4 v5, s[12:15], s33 offen sc1 lds
    s_add_u32 m0, s29, 41984
    s_add_u32 s33, s41, 4096
    buffer_load_dwordx4 v5, s[12:15], s33 offen sc1 lds
    s_add_u32 m0, s29, 43008
    s_add_u32 s33, s42, 4096
    buffer_load_dwordx4 v5, s[12:15], s33 offen sc1 lds
    s_add_u32 m0, s29, 81920
    s_add_u32 s33, s40, 8192
    buffer_load_dwordx4 v5, s[12:15], s33 offen sc1 lds
    s_add_u32 m0, s29, 82944
    s_add_u32 s33, s41, 8192
    buffer_load_dwordx4 v5, s[12:15], s33 offen sc1 lds
    s_add_u32 m0, s29, 83968
    s_add_u32 s33, s42, 8192
    buffer_load_dwordx4 v5, s[12:15], s33 offen sc1 lds
    s_add_u32 m0, s29, 122880
    s_add_u32 s33, s40, 12288
    buffer_load_dwordx4 v5, s[12:15], s33 offen sc1 lds
    s_add_u32 m0, s29, 123904
    s_add_u32 s33, s41, 12288
    buffer_load_dwordx4 v5, s[12:15], s33 offen sc1 lds
    s_add_u32 m0, s29, 124928
    s_add_u32 s33, s42, 12288
    buffer_load_dwordx4 v5, s[12:15], s33 offen sc1 lds
    v_and_b32 v7, 31, v2
    v_lshlrev_b32 v7, 6, v7
    v_lshl_add_u32 v7, v20, 5, v7
    s_lshl_b32 s34, s22, 2
    s_add_u32 s34, s34, s25
    s_lshl_b32 s35, s25, 12
    v_add_u32 v8, s35, v5
    s_mul_i32 s35, s26, 12288
    s_add_u32 s35, s35, 16384
    v_add_u32 v12, s35, v5
    s_lshl_b32 s36, s22, 7
    s_add_u32 s37, s36, 10240
    v_cmp_gt_u32 vcc, 192, v0
    v_mov_b32 v21, 11520
    s_nop 0
    v_cndmask_b32 v21, v21, 0, vcc
    v_lshl_add_u32 v21, v0, 2, v21
    v_mov_b32 v22, 0x7ffffff0
    v_cmp_gt_u32 vcc, 0x180, v0
    s_nop 1
    v_cndmask_b32 v21, v22, v21, vcc
    s_mul_i32 s36, s23, 768
    s_add_u32 s36, s36, 29360128
    buffer_load_dword v128, v21, s[12:15], s36 offen sc1
    s_add_u32 s36, s36, 24576
    buffer_load_dword v129, v21, s[12:15], s36 offen sc1
    s_add_u32 s36, s36, 24576
    buffer_load_dword v130, v21, s[12:15], s36 offen sc1
    s_add_u32 s36, s36, 24576
    buffer_load_dword v131, v21, s[12:15], s36 offen sc1
    s_add_u32 s36, s36, 24576
    buffer_load_dword v132, v21, s[12:15], s36 offen sc1
    s_add_u32 s36, s36, 24576
    buffer_load_dword v133, v21, s[12:15], s36 offen sc1
    s_add_u32 s36, s36, 24576
    buffer_load_dword v134, v21, s[12:15], s36 offen sc1
    s_add_u32 s36, s36, 24576
    buffer_load_dword v135, v21, s[12:15], s36 offen sc1
    s_add_u32 s36, s36, 24576
    buffer_load_dword v136, v21, s[12:15], s36 offen sc1
    s_add_u32 s36, s36, 24576
    buffer_load_dword v137, v21, s[12:15], s36 offen sc1
    v_add_u32 v9, 40960, v8
    v_add_u32 v13, 40960, v12
    v_add_u32 v10, 81920, v8
    v_add_u32 v14, 81920, v12
    v_add_u32 v11, 122880, v8
    v_add_u32 v15, 122880, v12
    v_mov_b32 v32, 0
    v_mov_b32 v33, 0
    v_mov_b32 v34, 0
    v_mov_b32 v35, 0
    v_mov_b32 v36, 0
    v_mov_b32 v37, 0
    v_mov_b32 v38, 0
    v_mov_b32 v39, 0
    v_mov_b32 v40, 0
    v_mov_b32 v41, 0
    v_mov_b32 v42, 0
    v_mov_b32 v43, 0
    v_mov_b32 v44, 0
    v_mov_b32 v45, 0
    v_mov_b32 v46, 0
    v_mov_b32 v47, 0
    v_mov_b32 v48, 0
    v_mov_b32 v49, 0
    v_mov_b32 v50, 0
    v_mov_b32 v51, 0
    v_mov_b32 v52, 0
    v_mov_b32 v53, 0
    v_mov_b32 v54, 0
    v_mov_b32 v55, 0
    v_mov_b32 v56, 0
    v_mov_b32 v57, 0
    v_mov_b32 v58, 0
    v_mov_b32 v59, 0
    v_mov_b32 v60, 0
    v_mov_b32 v61, 0
    v_mov_b32 v62, 0
    v_mov_b32 v63, 0
    v_mov_b32 v64, 0
    v_mov_b32 v65, 0
    v_mov_b32 v66, 0
    v_mov_b32 v67, 0
    v_mov_b32 v68, 0
    v_mov_b32 v69, 0
    v_mov_b32 v70, 0
    v_mov_b32 v71, 0
    v_mov_b32 v72, 0
    v_mov_b32 v73, 0
    v_mov_b32 v74, 0
    v_mov_b32 v75, 0
    v_mov_b32 v76, 0
    v_mov_b32 v77, 0
    v_mov_b32 v78, 0
    v_mov_b32 v79, 0
    s_cmp_lg_u32 s3, 0
    s_cbranch_scc1 L_wt_p4
    s_and_b32 s82, s2, 15
    s_lshl_b32 s82, s82, 14
    s_add_u32 s82, s82, 29622272
    s_add_u32 s4, s84, s82
    s_addc_u32 s5, s85, 0
    s_mov_b32 s6, s83
    s_mov_b32 s7, s83
    s_mov_b32 s82, 0x200000
L_wl_p4:
    s_load_dwordx16 s[48:63], s[4:5], s37 glc
    s_waitcnt lgkmcnt(0)
    s_xor_b64 s[48:49], s[48:49], s[6:7]
    s_xor_b64 s[50:51], s[50:51], s[6:7]
    s_xor_b64 s[52:53], s[52:53], s[6:7]
    s_xor_b64 s[54:55], s[54:55], s[6:7]
    s_xor_b64 s[56:57], s[56:57], s[6:7]
    s_xor_b64 s[58:59], s[58:59], s[6:7]
    s_xor_b64 s[60:61], s[60:61], s[6:7]
    s_xor_b64 s[62:63], s[62:63], s[6:7]
    s_or_b64 s[48:49], s[48:49], s[50:51]
    s_or_b64 s[48:49], s[48:49], s[52:53]
    s_or_b64 s[48:49], s[48:49], s[54:55]
    s_or_b64 s[48:49], s[48:49], s[56:57]
    s_or_b64 s[48:49], s[48:49], s[58:59]
    s_or_b64 s[48:49], s[48:49], s[60:61]
    s_or_b64 s[48:49], s[48:49], s[62:63]
    s_cbranch_scc0 L_wt_p4
    s_sleep 1
    s_sub_u32 s82, s82, 1
    s_cmp_lg_u32 s82, 0
    s_cbranch_scc1 L_wl_p4
L_wt_p4:
    s_nop 1
    s_barrier
    s_add_u32 m0, s28, 0
    s_add_u32 s33, s27, 0
    buffer_load_dwordx4 v5, s[12:15], s33 offen sc1 lds
    buffer_load_dwordx4 v5, s[12:15], s33 offen offset:1024 sc1 lds
    s_add_u32 m0, s28, 40960
    s_add_u32 s33, s27, 4096
    buffer_load_dwordx4 v5, s[12:15], s33 offen sc1 lds
    buffer_load_dwordx4 v5, s[12:15], s33 offen offset:1024 sc1 lds
    s_lshl_b32 s35, s34, 11
    s_add_u32 s35, s35, 15990784
    buffer_load_dwordx4 v[224:227], v7, s[12:15], s35 offen sc1
    buffer_load_dwordx4 v[228:231], v7, s[12:15], s35 offen offset:16 sc1
    s_add_u32 m0, s28, 81920
    s_add_u32 s33, s27, 8192
    buffer_load_dwordx4 v5, s[12:15], s33 offen sc1 lds
    buffer_load_dwordx4 v5, s[12:15], s33 offen offset:1024 sc1 lds
    s_add_u32 m0, s28, 122880
    s_add_u32 s33, s27, 12288
    buffer_load_dwordx4 v5, s[12:15], s33 offen sc1 lds
    buffer_load_dwordx4 v5, s[12:15], s33 offen offset:1024 sc1 lds
    s_waitcnt vmcnt(8)
    s_barrier
    ds_read_b128 v[80:83], v8 offset:0
    ds_read_b128 v[92:95], v12 offset:0
    ds_read_b128 v[96:99], v12 offset:4096
    ds_read_b128 v[100:103], v12 offset:8192
    ds_read_b128 v[84:87], v8 offset:1024
    ds_read_b128 v[104:107], v12 offset:1024
    ds_read_b128 v[108:111], v12 offset:5120
    ds_read_b128 v[112:115], v12 offset:9216
    s_waitcnt lgkmcnt(6)
    v_mfma_f32_32x32x16_bf16 v[32:47], v[92:95], v[80:83], v[32:47]
    ds_read_b128 v[88:91], v8 offset:2048
    s_waitcnt lgkmcnt(6)
    v_mfma_f32_32x32x16_bf16 v[48:63], v[96:99], v[80:83], v[48:63]
    ds_read_b128 v[116:119], v12 offset:2048
    s_waitcnt lgkmcnt(6)
    v_mfma_f32_32x32x16_bf16 v[64:79], v[100:103], v[80:83], v[64:79]
    ds_read_b128 v[120:123], v12 offset:6144
    ds_read_b128 v[124:127], v12 offset:10240
    s_waitcnt lgkmcnt(6)
    v_mfma_f32_32x32x16_bf16 v[32:47], v[104:107], v[84:87], v[32:47]
    ds_read_b128 v[80:83], v8 offset:3072
    s_waitcnt lgkmcnt(6)
    v_mfma_f32_32x32x16_bf16 v[48:63], v[108:111], v[84:87], v[48:63]
    ds_read_b128 v[92:95], v12 offset:3072
    s_waitcnt lgkmcnt(6)
    v_mfma_f32_32x32x16_bf16 v[64:79], v[112:115], v[84:87], v[64:79]
    ds_read_b128 v[96:99], v12 offset:7168
    ds_read_b128 v[100:103], v12 offset:11264
    s_waitcnt vmcnt(6)
    s_barrier
    s_waitcnt lgkmcnt(6)
    v_mfma_f32_32x32x16_bf16 v[32:47], v[116:119], v[88:91], v[32:47]
    ds_read_b128 v[84:87], v9 offset:0
    s_waitcnt lgkmcnt(6)
    v_mfma_f32_32x32x16_bf16 v[48:63], v[120:123], v[88:91], v[48:63]
    ds_read_b128 v[104:107], v13 offset:0
    ds_read_b128 v[108:111], v13 offset:4096
    s_waitcnt lgkmcnt(7)
    v_mfma_f32_32x32x16_bf16 v[64:79], v[124:127], v[88:91], v[64:79]
    ds_read_b128 v[112:115], v13 offset:8192
    s_lshr_b32 s38, s2, 3
    s_mul_i32 s38, s38, 61440
    s_add_u32 s38, s38, 23265280
    v_lshlrev_b32 v26, 3, v2
    v_add_u32 v26, s24, v26
    v_lshlrev_b32 v26, 7, v26
    v_mov_b32 v27, 0x7ffffff0
    v_cmp_gt_u32 vcc, 10, v2
    s_nop 1
    v_cndmask_b32 v26, v27, v26, vcc
    buffer_load_dword v30, v26, s[12:15], s38 offen
    s_waitcnt lgkmcnt(6)
    v_mfma_f32_32x32x16_bf16 v[32:47], v[92:95], v[80:83], v[32:47]
    ds_read_b128 v[88:91], v9 offset:1024
    s_waitcnt lgkmcnt(6)
    v_mfma_f32_32x32x16_bf16 v[48:63], v[96:99], v[80:83], v[48:63]
    ds_read_b128 v[116:119], v13 offset:1024
    s_waitcnt lgkmcnt(6)
    v_mfma_f32_32x32x16_bf16 v[64:79], v[100:103], v[80:83], v[64:79]
    ds_read_b128 v[120:123], v13 offset:5120
    ds_read_b128 v[124:127], v13 offset:9216
    s_waitcnt lgkmcnt(6)
    v_mfma_f32_32x32x16_bf16 v[32:47], v[104:107], v[84:87], v[32:47]
    ds_read_b128 v[80:83], v9 offset:2048
    s_waitcnt lgkmcnt(6)
    v_mfma_f32_32x32x16_bf16 v[48:63], v[108:111], v[84:87], v[48:63]
    ds_read_b128 v[92:95], v13 offset:2048
    s_waitcnt lgkmcnt(6)
    v_mfma_f32_32x32x16_bf16 v[64:79], v[112:115], v[84:87], v[64:79]
    ds_read_b128 v[96:99], v13 offset:6144
    ds_read_b128 v[100:103], v13 offset:10240
    s_waitcnt lgkmcnt(6)
    v_mfma_f32_32x32x16_bf16 v[32:47], v[116:119], v[88:91], v[32:47]
    ds_read_b128 v[84:87], v9 offset:3072
    s_waitcnt lgkmcnt(6)
    v_mfma_f32_32x32x16_bf16 v[48:63], v[120:123], v[88:91], v[48:63]
    ds_read_b128 v[104:107], v13 offset:3072
    s_waitcnt lgkmcnt(6)
    v_mfma_f32_32x32x16_bf16 v[64:79], v[124:127], v[88:91], v[64:79]
    ds_read_b128 v[108:111], v13 offset:7168
    ds_read_b128 v[112:115], v13 offset:11264
    s_waitcnt vmcnt(3)
    s_barrier
    s_waitcnt lgkmcnt(6)
    v_mfma_f32_32x32x16_bf16 v[32:47], v[92:95], v[80:83], v[32:47]
    ds_read_b128 v[88:91], v10 offset:0
    ds_read_b128 v[116:119], v14 offset:0
    s_waitcnt lgkmcnt(7)
    v_mfma_f32_32x32x16_bf16 v[48:63], v[96:99], v[80:83], v[48:63]
    ds_read_b128 v[120:123], v14 offset:4096
    ds_read_b128 v[124:127], v14 offset:8192
    s_waitcnt lgkmcnt(8)
    v_mfma_f32_32x32x16_bf16 v[64:79], v[100:103], v[80:83], v[64:79]
    s_add_u32 m0, s28, 0
    s_add_u32 s33, s27, 16384
    buffer_load_dwordx4 v5, s[12:15], s33 offen sc1 lds
    buffer_load_dwordx4 v5, s[12:15], s33 offen offset:1024 sc1 lds
    s_add_u32 m0, s29, 0
    s_add_u32 s33, s40, 16384
    buffer_load_dwordx4 v5, s[12:15], s33 offen sc1 lds
    s_waitcnt lgkmcnt(6)
    v_mfma_f32_32x32x16_bf16 v[32:47], v[104:107], v[84:87], v[32:47]
    ds_read_b128 v[80:83], v10 offset:1024
    ds_read_b128 v[92:95], v14 offset:1024
    s_waitcnt lgkmcnt(7)
    v_mfma_f32_32x32x16_bf16 v[48:63], v[108:111], v[84:87], v[48:63]
    ds_read_b128 v[96:99], v14 offset:5120
    ds_read_b128 v[100:103], v14 offset:9216
    s_waitcnt lgkmcnt(8)
    v_mfma_f32_32x32x16_bf16 v[64:79], v[112:115], v[84:87], v[64:79]
    s_add_u32 m0, s29, 1024
    s_add_u32 s33, s41, 16384
    buffer_load_dwordx4 v5, s[12:15], s33 offen sc1 lds
    s_add_u32 m0, s29, 2048
    s_add_u32 s33, s42, 16384
    buffer_load_dwordx4 v5, s[12:15], s33 offen sc1 lds
    s_waitcnt lgkmcnt(6)
    v_mfma_f32_32x32x16_bf16 v[32:47], v[116:119], v[88:91], v[32:47]
    ds_read_b128 v[84:87], v10 offset:2048
    s_waitcnt lgkmcnt(6)
    v_mfma_f32_32x32x16_bf16 v[48:63], v[120:123], v[88:91], v[48:63]
    ds_read_b128 v[104:107], v14 offset:2048
    ds_read_b128 v[108:111], v14 offset:6144
    s_waitcnt lgkmcnt(7)
    v_mfma_f32_32x32x16_bf16 v[64:79], v[124:127], v[88:91], v[64:79]
    ds_read_b128 v[112:115], v14 offset:10240
    s_add_u32 s38, s38, 10240
    buffer_load_dword v30, v26, s[12:15], s38 offen
    s_waitcnt lgkmcnt(6)
    v_mfma_f32_32x32x16_bf16 v[32:47], v[92:95], v[80:83], v[32:47]
    ds_read_b128 v[88:91], v10 offset:3072
    s_waitcnt lgkmcnt(6)
    v_mfma_f32_32x32x16_bf16 v[48:63], v[96:99], v[80:83], v[48:63]
    ds_read_b128 v[116:119], v14 offset:3072
    s_waitcnt lgkmcnt(6)
    v_mfma_f32_32x32x16_bf16 v[64:79], v[100:103], v[80:83], v[64:79]
    ds_read_b128 v[120:123], v14 offset:7168
    ds_read_b128 v[124:127], v14 offset:11264
    s_waitcnt vmcnt(7)
    s_barrier
    s_waitcnt lgkmcnt(6)
    v_mfma_f32_32x32x16_bf16 v[32:47], v[104:107], v[84:87], v[32:47]
    ds_read_b128 v[80:83], v11 offset:0
    ds_read_b128 v[92:95], v15 offset:0
    s_waitcnt lgkmcnt(7)
    v_mfma_f32_32x32x16_bf16 v[48:63], v[108:111], v[84:87], v[48:63]
    ds_read_b128 v[96:99], v15 offset:4096
    ds_read_b128 v[100:103], v15 offset:8192
    s_waitcnt lgkmcnt(8)
    v_mfma_f32_32x32x16_bf16 v[64:79], v[112:115], v[84:87], v[64:79]
    s_add_u32 m0, s28, 40960
    s_add_u32 s33, s27, 20480
    buffer_load_dwordx4 v5, s[12:15], s33 offen sc1 lds
    buffer_load_dwordx4 v5, s[12:15], s33 offen offset:1024 sc1 lds
    s_add_u32 m0, s29, 40960
    s_add_u32 s33, s40, 20480
    buffer_load_dwordx4 v5, s[12:15], s33 offen sc1 lds
    s_waitcnt lgkmcnt(6)
    v_mfma_f32_32x32x16_bf16 v[32:47], v[116:119], v[88:91], v[32:47]
    ds_read_b128 v[84:87], v11 offset:1024
    ds_read_b128 v[104:107], v15 offset:1024
    s_waitcnt lgkmcnt(7)
    v_mfma_f32_32x32x16_bf16 v[48:63], v[120:123], v[88:91], v[48:63]
    ds_read_b128 v[108:111], v15 offset:5120
    ds_read_b128 v[112:115], v15 offset:9216
    s_waitcnt lgkmcnt(8)
    v_mfma_f32_32x32x16_bf16 v[64:79], v[124:127], v[88:91], v[64:79]
    s_add_u32 m0, s29, 41984
    s_add_u32 s33, s41, 20480
    buffer_load_dwordx4 v5, s[12:15], s33 offen sc1 lds
    s_add_u32 m0, s29, 43008
    s_add_u32 s33, s42, 20480
    buffer_load_dwordx4 v5, s[12:15], s33 offen sc1 lds
    s_waitcnt lgkmcnt(6)
    v_mfma_f32_32x32x16_bf16 v[32:47], v[92:95], v[80:83], v[32:47]
    ds_read_b128 v[88:91], v11 offset:2048
    s_waitcnt lgkmcnt(6)
    v_mfma_f32_32x32x16_bf16 v[48:63], v[96:99], v[80:83], v[48:63]
    ds_read_b128 v[116:119], v15 offset:2048
    ds_read_b128 v[120:123], v15 offset:6144
    s_waitcnt lgkmcnt(7)
    v_mfma_f32_32x32x16_bf16 v[64:79], v[100:103], v[80:83], v[64:79]
    ds_read_b128 v[124:127], v15 offset:10240
    s_add_u32 s38, s38, 10240
    buffer_load_dword v30, v26, s[12:15], s38 offen
    s_waitcnt lgkmcnt(6)
    v_mfma_f32_32x32x16_bf16 v[32:47], v[104:107], v[84:87], v[32:47]
    ds_read_b128 v[80:83], v11 offset:3072
    s_waitcnt lgkmcnt(6)
    v_mfma_f32_32x32x16_bf16 v[48:63], v[108:111], v[84:87], v[48:63]
    ds_read_b128 v[92:95], v15 offset:3072
    s_waitcnt lgkmcnt(6)
    v_mfma_f32_32x32x16_bf16 v[64:79], v[112:115], v[84:87], v[64:79]
    ds_read_b128 v[96:99], v15 offset:7168
    ds_read_b128 v[100:103], v15 offset:11264
    s_waitcnt vmcnt(7)
    s_barrier
    s_waitcnt lgkmcnt(6)
    v_mfma_f32_32x32x16_bf16 v[32:47], v[116:119], v[88:91], v[32:47]
    ds_read_b128 v[84:87], v8 offset:0
    ds_read_b128 v[104:107], v12 offset:0
    s_waitcnt lgkmcnt(7)
    v_mfma_f32_32x32x16_bf16 v[48:63], v[120:123], v[88:91], v[48:63]
    ds_read_b128 v[108:111], v12 offset:4096
    ds_read_b128 v[112:115], v12 offset:8192
    s_waitcnt lgkmcnt(8)
    v_mfma_f32_32x32x16_bf16 v[64:79], v[124:127], v[88:91], v[64:79]
    s_add_u32 m0, s28, 81920
    s_add_u32 s33, s27, 24576
    buffer_load_dwordx4 v5, s[12:15], s33 offen sc1 lds
    buffer_load_dwordx4 v5, s[12:15], s33 offen offset:1024 sc1 lds
    s_add_u32 m0, s29, 81920
    s_add_u32 s33, s40, 24576
    buffer_load_dwordx4 v5, s[12:15], s33 offen sc1 lds
    s_waitcnt lgkmcnt(6)
    v_mfma_f32_32x32x16_bf16 v[32:47], v[92:95], v[80:83], v[32:47]
    ds_read_b128 v[88:91], v8 offset:1024
    ds_read_b128 v[116:119], v12 offset:1024
    s_waitcnt lgkmcnt(7)
    v_mfma_f32_32x32x16_bf16 v[48:63], v[96:99], v[80:83], v[48:63]
    ds_read_b128 v[120:123], v12 offset:5120
    ds_read_b128 v[124:127], v12 offset:9216
    s_waitcnt lgkmcnt(8)
    v_mfma_f32_32x32x16_bf16 v[64:79], v[100:103], v[80:83], v[64:79]
    s_add_u32 m0, s29, 82944
    s_add_u32 s33, s41, 24576
    buffer_load_dwordx4 v5, s[12:15], s33 offen sc1 lds
    s_add_u32 m0, s29, 83968
    s_add_u32 s33, s42, 24576
    buffer_load_dwordx4 v5, s[12:15], s33 offen sc1 lds
    s_waitcnt lgkmcnt(6)
    v_mfma_f32_32x32x16_bf16 v[32:47], v[104:107], v[84:87], v[32:47]
    ds_read_b128 v[80:83], v8 offset:2048
    s_waitcnt lgkmcnt(6)
    v_mfma_f32_32x32x16_bf16 v[48:63], v[108:111], v[84:87], v[48:63]
    ds_read_b128 v[92:95], v12 offset:2048
    ds_read_b128 v[96:99], v12 offset:6144
    s_waitcnt lgkmcnt(7)
    v_mfma_f32_32x32x16_bf16 v[64:79], v[112:115], v[84:87], v[64:79]
    ds_read_b128 v[100:103], v12 offset:10240
    s_add_u32 s38, s38, 10240
    buffer_load_dword v30, v26, s[12:15], s38 offen
    s_waitcnt lgkmcnt(6)
    v_mfma_f32_32x32x16_bf16 v[32:47], v[116:119], v[88:91], v[32:47]
    ds_read_b128 v[84:87], v8 offset:3072
    s_waitcnt lgkmcnt(6)
    v_mfma_f32_32x32x16_bf16 v[48:63], v[120:123], v[88:91], v[48:63]
    ds_read_b128 v[104:107], v12 offset:3072
    s_waitcnt lgkmcnt(6)
    v_mfma_f32_32x32x16_bf16 v[64:79], v[124:127], v[88:91], v[64:79]
    ds_read_b128 v[108:111], v12 offset:7168
    ds_read_b128 v[112:115], v12 offset:11264
    s_waitcnt vmcnt(7)
    s_barrier
    s_waitcnt lgkmcnt(6)
    v_mfma_f32_32x32x16_bf16 v[32:47], v[92:95], v[80:83], v[32:47]
    ds_read_b128 v[88:91], v9 offset:0
    ds_read_b128 v[116:119], v13 offset:0
    s_waitcnt lgkmcnt(7)
    v_mfma_f32_32x32x16_bf16 v[48:63], v[96:99], v[80:83], v[48:63]
    ds_read_b128 v[120:123], v13 offset:4096
    ds_read_b128 v[124:127], v13 offset:8192
    s_waitcnt lgkmcnt(8)
    v_mfma_f32_32x32x16_bf16 v[64:79], v[100:103], v[80:83], v[64:79]
    s_add_u32 m0, s28, 122880
    s_add_u32 s33, s27, 28672
    buffer_load_dwordx4 v5, s[12:15], s33 offen sc1 lds
    buffer_load_dwordx4 v5, s[12:15], s33 offen offset:1024 sc1 lds
    s_add_u32 m0, s29, 122880
    s_add_u32 s33, s40, 28672
    buffer_load_dwordx4 v5, s[12:15], s33 offen sc1 lds
    s_waitcnt lgkmcnt(6)
    v_mfma_f32_32x32x16_bf16 v[32:47], v[104:107], v[84:87], v[32:47]
    ds_read_b128 v[80:83], v9 offset:1024
    ds_read_b128 v[92:95], v13 offset:1024
    s_waitcnt lgkmcnt(7)
    v_mfma_f32_32x32x16_bf16 v[48:63], v[108:111], v[84:87], v[48:63]
    ds_read_b128 v[96:99], v13 offset:5120
    ds_read_b128 v[100:103], v13 offset:9216
    s_waitcnt lgkmcnt(8)
    v_mfma_f32_32x32x16_bf16 v[64:79], v[112:115], v[84:87], v[64:79]
    s_add_u32 m0, s29, 123904
    s_add_u32 s33, s41, 28672
    buffer_load_dwordx4 v5, s[12:15], s33 offen sc1 lds
    s_add_u32 m0, s29, 124928
    s_add_u32 s33, s42, 28672
    buffer_load_dwordx4 v5, s[12:15], s33 offen sc1 lds
    s_waitcnt lgkmcnt(6)
    v_mfma_f32_32x32x16_bf16 v[32:47], v[116:119], v[88:91], v[32:47]
    ds_read_b128 v[84:87], v9 offset:2048
    s_waitcnt lgkmcnt(6)
    v_mfma_f32_32x32x16_bf16 v[48:63], v[120:123], v[88:91], v[48:63]
    ds_read_b128 v[104:107], v13 offset:2048
    ds_read_b128 v[108:111], v13 offset:6144
    s_waitcnt lgkmcnt(7)
    v_mfma_f32_32x32x16_bf16 v[64:79], v[124:127], v[88:91], v[64:79]
    ds_read_b128 v[112:115], v13 offset:10240
    s_add_u32 s38, s38, 10240
    buffer_load_dword v30, v26, s[12:15], s38 offen
    s_waitcnt lgkmcnt(6)
    v_mfma_f32_32x32x16_bf16 v[32:47], v[92:95], v[80:83], v[32:47]
    ds_read_b128 v[88:91], v9 offset:3072
    s_waitcnt lgkmcnt(6)
    v_mfma_f32_32x32x16_bf16 v[48:63], v[96:99], v[80:83], v[48:63]
    ds_read_b128 v[116:119], v13 offset:3072
    s_waitcnt lgkmcnt(6)
    v_mfma_f32_32x32x16_bf16 v[64:79], v[100:103], v[80:83], v[64:79]
    ds_read_b128 v[120:123], v13 offset:7168
    ds_read_b128 v[124:127], v13 offset:11264
    s_waitcnt vmcnt(7)
    s_barrier
    s_waitcnt lgkmcnt(6)
    v_mfma_f32_32x32x16_bf16 v[32:47], v[104:107], v[84:87], v[32:47]
    ds_read_b128 v[80:83], v10 offset:0
    ds_read_b128 v[92:95], v14 offset:0
    s_waitcnt lgkmcnt(7)
    v_mfma_f32_32x32x16_bf16 v[48:63], v[108:111], v[84:87], v[48:63]
    ds_read_b128 v[96:99], v14 offset:4096
    ds_read_b128 v[100:103], v14 offset:8192
    s_waitcnt lgkmcnt(8)
    v_mfma_f32_32x32x16_bf16 v[64:79], v[112:115], v[84:87], v[64:79]
    s_add_u32 m0, s28, 0
    s_add_u32 s33, s27, 32768
    buffer_load_dwordx4 v5, s[12:15], s33 offen sc1 lds
    buffer_load_dwordx4 v5, s[12:15], s33 offen offset:1024 sc1 lds
    s_add_u32 m0, s29, 0
    s_add_u32 s33, s40, 32768
    buffer_load_dwordx4 v5, s[12:15], s33 offen sc1 lds
    s_waitcnt lgkmcnt(6)
    v_mfma_f32_32x32x16_bf16 v[32:47], v[116:119], v[88:91], v[32:47]
    ds_read_b128 v[84:87], v10 offset:1024
    ds_read_b128 v[104:107], v14 offset:1024
    s_waitcnt lgkmcnt(7)
    v_mfma_f32_32x32x16_bf16 v[48:63], v[120:123], v[88:91], v[48:63]
    ds_read_b128 v[108:111], v14 offset:5120
    ds_read_b128 v[112:115], v14 offset:9216
    s_waitcnt lgkmcnt(8)
    v_mfma_f32_32x32x16_bf16 v[64:79], v[124:127], v[88:91], v[64:79]
    s_add_u32 m0, s29, 1024
    s_add_u32 s33, s41, 32768
    buffer_load_dwordx4 v5, s[12:15], s33 offen sc1 lds
    s_add_u32 m0, s29, 2048
    s_add_u32 s33, s42, 32768
    buffer_load_dwordx4 v5, s[12:15], s33 offen sc1 lds
    s_waitcnt lgkmcnt(6)
    v_mfma_f32_32x32x16_bf16 v[32:47], v[92:95], v[80:83], v[32:47]
    ds_read_b128 v[88:91], v10 offset:2048
    s_waitcnt lgkmcnt(6)
    v_mfma_f32_32x32x16_bf16 v[48:63], v[96:99], v[80:83], v[48:63]
    ds_read_b128 v[116:119], v14 offset:2048
    ds_read_b128 v[120:123], v14 offset:6144
    s_waitcnt lgkmcnt(7)
    v_mfma_f32_32x32x16_bf16 v[64:79], v[100:103], v[80:83], v[64:79]
    ds_read_b128 v[124:127], v14 offset:10240
    s_add_u32 s38, s38, 10240
    buffer_load_dword v30, v26, s[12:15], s38 offen
    s_waitcnt lgkmcnt(6)
    v_mfma_f32_32x32x16_bf16 v[32:47], v[104:107], v[84:87], v[32:47]
    ds_read_b128 v[80:83], v10 offset:3072
    s_waitcnt lgkmcnt(6)
    v_mfma_f32_32x32x16_bf16 v[48:63], v[108:111], v[84:87], v[48:63]
    ds_read_b128 v[92:95], v14 offset:3072
    s_waitcnt lgkmcnt(6)
    v_mfma_f32_32x32x16_bf16 v[64:79], v[112:115], v[84:87], v[64:79]
    ds_read_b128 v[96:99], v14 offset:7168
    ds_read_b128 v[100:103], v14 offset:11264
    s_waitcnt vmcnt(7)
    s_barrier
    s_waitcnt lgkmcnt(6)
    v_mfma_f32_32x32x16_bf16 v[32:47], v[116:119], v[88:91], v[32:47]
    ds_read_b128 v[84:87], v11 offset:0
    ds_read_b128 v[104:107], v15 offset:0
    s_waitcnt lgkmcnt(7)
    v_mfma_f32_32x32x16_bf16 v[48:63], v[120:123], v[88:91], v[48:63]
    ds_read_b128 v[108:111], v15 offset:4096
    ds_read_b128 v[112:115], v15 offset:8192
    s_waitcnt lgkmcnt(8)
    v_mfma_f32_32x32x16_bf16 v[64:79], v[124:127], v[88:91], v[64:79]
    s_add_u32 m0, s28, 40960
    s_add_u32 s33, s27, 36864
    buffer_load_dwordx4 v5, s[12:15], s33 offen sc1 lds
    buffer_load_dwordx4 v5, s[12:15], s33 offen offset:1024 sc1 lds
    s_add_u32 m0, s29, 40960
    s_add_u32 s33, s40, 36864
    buffer_load_dwordx4 v5, s[12:15], s33 offen sc1 lds
    s_waitcnt lgkmcnt(6)
    v_mfma_f32_32x32x16_bf16 v[32:47], v[92:95], v[80:83], v[32:47]
    ds_read_b128 v[88:91], v11 offset:1024
    ds_read_b128 v[116:119], v15 offset:1024
    s_waitcnt lgkmcnt(7)
    v_mfma_f32_32x32x16_bf16 v[48:63], v[96:99], v[80:83], v[48:63]
    ds_read_b128 v[120:123], v15 offset:5120
    ds_read_b128 v[124:127], v15 offset:9216
    s_waitcnt lgkmcnt(8)
    v_mfma_f32_32x32x16_bf16 v[64:79], v[100:103], v[80:83], v[64:79]
    s_add_u32 m0, s29, 41984
    s_add_u32 s33, s41, 36864
    buffer_load_dwordx4 v5, s[12:15], s33 offen sc1 lds
    s_add_u32 m0, s29, 43008
    s_add_u32 s33, s42, 36864
    buffer_load_dwordx4 v5, s[12:15], s33 offen sc1 lds
    s_waitcnt lgkmcnt(6)
    v_mfma_f32_32x32x16_bf16 v[32:47], v[104:107], v[84:87], v[32:47]
    ds_read_b128 v[80:83], v11 offset:2048
    s_waitcnt lgkmcnt(6)
    v_mfma_f32_32x32x16_bf16 v[48:63], v[108:111], v[84:87], v[48:63]
    ds_read_b128 v[92:95], v15 offset:2048
    s_waitcnt lgkmcnt(6)
    v_mfma_f32_32x32x16_bf16 v[64:79], v[112:115], v[84:87], v[64:79]
    ds_read_b128 v[96:99], v15 offset:6144
    ds_read_b128 v[100:103], v15 offset:10240
    s_waitcnt lgkmcnt(6)
    v_mfma_f32_32x32x16_bf16 v[32:47], v[116:119], v[88:91], v[32:47]
    ds_read_b128 v[84:87], v11 offset:3072
    s_waitcnt lgkmcnt(6)
    v_mfma_f32_32x32x16_bf16 v[48:63], v[120:123], v[88:91], v[48:63]
    ds_read_b128 v[104:107], v15 offset:3072
    s_waitcnt lgkmcnt(6)
    v_mfma_f32_32x32x16_bf16 v[64:79], v[124:127], v[88:91], v[64:79]
    ds_read_b128 v[108:111], v15 offset:7168
    ds_read_b128 v[112:115], v15 offset:11264
    s_waitcnt vmcnt(6)
    s_barrier
    s_waitcnt lgkmcnt(6)
    v_mfma_f32_32x32x16_bf16 v[32:47], v[92:95], v[80:83], v[32:47]
    ds_read_b128 v[88:91], v8 offset:0
    s_waitcnt lgkmcnt(6)
    v_mfma_f32_32x32x16_bf16 v[48:63], v[96:99], v[80:83], v[48:63]
    ds_read_b128 v[116:119], v12 offset:0
    ds_read_b128 v[120:123], v12 offset:4096
    s_waitcnt lgkmcnt(7)
    v_mfma_f32_32x32x16_bf16 v[64:79], v[100:103], v[80:83], v[64:79]
    ds_read_b128 v[124:127], v12 offset:8192
    v_add_f32 v128, v128, v129
    v_add_f32 v128, v128, v130
    v_add_f32 v128, v128, v131
    v_add_f32 v128, v128, v132
    v_add_f32 v128, v128, v133
    v_add_f32 v128, v128, v134
    v_add_f32 v128, v128, v135
    v_add_f32 v128, v128, v136
    v_add_f32 v128, v128, v137
    v_cmp_gt_u32 vcc, 192, v0
    v_mov_b32 v21, 82176
    v_mov_b32 v22, 81920
    v_cndmask_b32 v21, v21, v22, vcc
    v_lshl_add_u32 v21, v0, 2, v21
    ds_write_b32 v21, v128
    s_waitcnt lgkmcnt(7)
    v_mfma_f32_32x32x16_bf16 v[32:47], v[104:107], v[84:87], v[32:47]
    ds_read_b128 v[80:83], v8 offset:1024
    s_waitcnt lgkmcnt(7)
    v_mfma_f32_32x32x16_bf16 v[48:63], v[108:111], v[84:87], v[48:63]
    ds_read_b128 v[92:95], v12 offset:1024
    s_waitcnt lgkmcnt(7)
    v_mfma_f32_32x32x16_bf16 v[64:79], v[112:115], v[84:87], v[64:79]
    ds_read_b128 v[96:99], v12 offset:5120
    ds_read_b128 v[100:103], v12 offset:9216
    s_waitcnt lgkmcnt(7)
    v_mfma_f32_32x32x16_bf16 v[32:47], v[116:119], v[88:91], v[32:47]
    ds_read_b128 v[84:87], v8 offset:2048
    s_waitcnt lgkmcnt(7)
    v_mfma_f32_32x32x16_bf16 v[48:63], v[120:123], v[88:91], v[48:63]
    ds_read_b128 v[104:107], v12 offset:2048
    s_waitcnt lgkmcnt(7)
    v_mfma_f32_32x32x16_bf16 v[64:79], v[124:127], v[88:91], v[64:79]
    ds_read_b128 v[108:111], v12 offset:6144
    ds_read_b128 v[112:115], v12 offset:10240
    s_waitcnt lgkmcnt(6)
    v_mfma_f32_32x32x16_bf16 v[32:47], v[92:95], v[80:83], v[32:47]
    ds_read_b128 v[88:91], v8 offset:3072
    s_waitcnt lgkmcnt(6)
    v_mfma_f32_32x32x16_bf16 v[48:63], v[96:99], v[80:83], v[48:63]
    ds_read_b128 v[116:119], v12 offset:3072
    s_waitcnt lgkmcnt(6)
    v_mfma_f32_32x32x16_bf16 v[64:79], v[100:103], v[80:83], v[64:79]
    ds_read_b128 v[120:123], v12 offset:7168
    ds_read_b128 v[124:127], v12 offset:11264
    s_waitcnt vmcnt(0)
    s_barrier
    s_waitcnt lgkmcnt(6)
    v_mfma_f32_32x32x16_bf16 v[32:47], v[104:107], v[84:87], v[32:47]
    ds_read_b128 v[80:83], v9 offset:0
    s_waitcnt lgkmcnt(6)
    v_mfma_f32_32x32x16_bf16 v[48:63], v[108:111], v[84:87], v[48:63]
    ds_read_b128 v[92:95], v13 offset:0
    ds_read_b128 v[96:99], v13 offset:4096
    s_waitcnt lgkmcnt(7)
    v_mfma_f32_32x32x16_bf16 v[64:79], v[112:115], v[84:87], v[64:79]
    ds_read_b128 v[100:103], v13 offset:8192
    v_add_f32 v224, v224, v226
    v_add_f32 v225, v225, v227
    v_add_f32 v228, v228, v230
    v_add_f32 v229, v229, v231
    v_add_f32 v224, v224, v228
    v_add_f32 v225, v225, v229
    v_mov_b32 v226, v224
    v_mov_b32 v227, v225
    s_nop 0
    v_permlane32_swap_b32 v224, v226
    v_permlane32_swap_b32 v225, v227
    v_add_f32 v224, v224, v226
    v_add_f32 v225, v225, v227
    v_mul_f32 v224, 0x3acccccd, v224
    v_mul_f32 v225, 0x3acccccd, v225
    v_fma_f32 v225, -v224, v224, v225
    v_max_f32 v225, 0, v225
    v_cvt_pk_bf16_f32 v224, v224, v224
    v_and_b32 v224, 0xffff0000, v224
    v_cvt_pk_bf16_f32 v225, v225, v225
    v_and_b32 v225, 0xffff0000, v225
    v_add_f32 v225, 0x3727c5ac, v225
    v_cvt_pk_bf16_f32 v225, v225, v225
    v_and_b32 v225, 0xffff0000, v225
    v_sqrt_f32 v225, v225
    s_nop 0
    v_cvt_pk_bf16_f32 v225, v225, v225
    v_and_b32 v225, 0xffff0000, v225
    v_rcp_f32 v24, v225
    v_sub_f32 v25, 0, v224
    s_waitcnt lgkmcnt(6)
    v_mfma_f32_32x32x16_bf16 v[32:47], v[116:119], v[88:91], v[32:47]
    ds_read_b128 v[84:87], v9 offset:1024
    s_waitcnt lgkmcnt(6)
    v_mfma_f32_32x32x16_bf16 v[48:63], v[120:123], v[88:91], v[48:63]
    ds_read_b128 v[104:107], v13 offset:1024
    s_waitcnt lgkmcnt(6)
    v_mfma_f32_32x32x16_bf16 v[64:79], v[124:127], v[88:91], v[64:79]
    ds_read_b128 v[108:111], v13 offset:5120
    ds_read_b128 v[112:115], v13 offset:9216
    s_waitcnt lgkmcnt(6)
    v_mfma_f32_32x32x16_bf16 v[32:47], v[92:95], v[80:83], v[32:47]
    ds_read_b128 v[88:91], v9 offset:2048
    s_waitcnt lgkmcnt(6)
    v_mfma_f32_32x32x16_bf16 v[48:63], v[96:99], v[80:83], v[48:63]
    ds_read_b128 v[116:119], v13 offset:2048
    s_waitcnt lgkmcnt(6)
    v_mfma_f32_32x32x16_bf16 v[64:79], v[100:103], v[80:83], v[64:79]
    ds_read_b128 v[120:123], v13 offset:6144
    ds_read_b128 v[124:127], v13 offset:10240
    s_waitcnt lgkmcnt(6)
    v_mfma_f32_32x32x16_bf16 v[32:47], v[104:107], v[84:87], v[32:47]
    ds_read_b128 v[80:83], v9 offset:3072
    s_waitcnt lgkmcnt(6)
    v_mfma_f32_32x32x16_bf16 v[48:63], v[108:111], v[84:87], v[48:63]
    ds_read_b128 v[92:95], v13 offset:3072
    s_waitcnt lgkmcnt(6)
    v_mfma_f32_32x32x16_bf16 v[64:79], v[112:115], v[84:87], v[64:79]
    ds_read_b128 v[96:99], v13 offset:7168
    ds_read_b128 v[100:103], v13 offset:11264
    s_waitcnt lgkmcnt(0)
    s_barrier
    s_mul_i32 s33, s26, 384
    s_add_u32 s33, s33, 81920
    v_lshlrev_b32 v16, 4, v20
    v_add_u32 v16, s33, v16
    v_mfma_f32_32x32x16_bf16 v[32:47], v[116:119], v[88:91], v[32:47]
    ds_read_b128 v[128:131], v16 offset:0
    ds_read_b128 v[176:179], v16 offset:1024
    ds_read_b128 v[144:147], v16 offset:128
    ds_read_b128 v[192:195], v16 offset:1152
    v_mfma_f32_32x32x16_bf16 v[48:63], v[120:123], v[88:91], v[48:63]
    ds_read_b128 v[160:163], v16 offset:256
    ds_read_b128 v[208:211], v16 offset:1280
    ds_read_b128 v[132:135], v16 offset:32
    ds_read_b128 v[180:183], v16 offset:1056
    v_mfma_f32_32x32x16_bf16 v[64:79], v[124:127], v[88:91], v[64:79]
    ds_read_b128 v[148:151], v16 offset:160
    ds_read_b128 v[196:199], v16 offset:1184
    ds_read_b128 v[164:167], v16 offset:288
    ds_read_b128 v[212:215], v16 offset:1312
    v_mfma_f32_32x32x16_bf16 v[32:47], v[92:95], v[80:83], v[32:47]
    ds_read_b128 v[136:139], v16 offset:64
    ds_read_b128 v[184:187], v16 offset:1088
    ds_read_b128 v[152:155], v16 offset:192
    ds_read_b128 v[200:203], v16 offset:1216
    v_mfma_f32_32x32x16_bf16 v[48:63], v[96:99], v[80:83], v[48:63]
    ds_read_b128 v[168:171], v16 offset:320
    ds_read_b128 v[216:219], v16 offset:1344
    ds_read_b128 v[140:143], v16 offset:96
    ds_read_b128 v[188:191], v16 offset:1120
    v_mfma_f32_32x32x16_bf16 v[64:79], v[100:103], v[80:83], v[64:79]
    ds_read_b128 v[156:159], v16 offset:224
    ds_read_b128 v[204:207], v16 offset:1248
    ds_read_b128 v[172:175], v16 offset:352
    ds_read_b128 v[220:223], v16 offset:1376
    s_mul_i32 s31, s23, 6
    s_mul_i32 s32, s26, 3
    s_add_u32 s31, s31, s32
    s_mul_i32 s32, s34, 98304
    s_add_u32 s29, s32, 16121856
    v_bfe_u32 v3, v2, 4, 1
    v_mul_u32_u24 v4, 49152, v3
    v_and_b32 v3, 15, v2
    v_lshl_add_u32 v4, v3, 4, v4
    v_lshl_add_u32 v4, v20, 8, v4
    s_mov_b32 s35, 0xbfb8aa3b
    s_add_u32 s32, s31, 0
    s_lshl_b32 s33, s32, 9
    s_add_u32 s33, s33, s29
    s_waitcnt lgkmcnt(15)
    v_fmac_f32 v32, v128, v25
    v_fmac_f32 v33, v129, v25
    v_fmac_f32 v34, v130, v25
    v_fmac_f32 v35, v131, v25
    v_fmac_f32 v36, v132, v25
    v_fmac_f32 v37, v133, v25
    v_fmac_f32 v38, v134, v25
    v_fmac_f32 v39, v135, v25
    s_waitcnt lgkmcnt(11)
    v_fmac_f32 v40, v136, v25
    v_fmac_f32 v41, v137, v25
    v_fmac_f32 v42, v138, v25
    v_fmac_f32 v43, v139, v25
    s_waitcnt lgkmcnt(5)
    v_fmac_f32 v44, v140, v25
    v_fmac_f32 v45, v141, v25
    v_fmac_f32 v46, v142, v25
    v_fmac_f32 v47, v143, v25
    v_fmac_f32 v176, v32, v24
    v_fmac_f32 v177, v33, v24
    v_fmac_f32 v178, v34, v24
    v_fmac_f32 v179, v35, v24
    v_fmac_f32 v180, v36, v24
    v_fmac_f32 v181, v37, v24
    v_fmac_f32 v182, v38, v24
    v_fmac_f32 v183, v39, v24
    v_fmac_f32 v184, v40, v24
    v_fmac_f32 v185, v41, v24
    v_fmac_f32 v186, v42, v24
    v_fmac_f32 v187, v43, v24
    s_waitcnt lgkmcnt(4)
    v_fmac_f32 v188, v44, v24
    v_fmac_f32 v189, v45, v24
    v_fmac_f32 v190, v46, v24
    v_fmac_f32 v191, v47, v24
    v_mul_f32 v80, s35, v176
    v_mul_f32 v81, s35, v177
    v_mul_f32 v82, s35, v178
    v_mul_f32 v83, s35, v179
    v_mul_f32 v84, s35, v180
    v_mul_f32 v85, s35, v181
    v_mul_f32 v86, s35, v182
    v_mul_f32 v87, s35, v183
    v_exp_f32 v80, v80
    v_exp_f32 v81, v81
    v_exp_f32 v82, v82
    v_exp_f32 v83, v83
    v_exp_f32 v84, v84
    v_exp_f32 v85, v85
    v_exp_f32 v86, v86
    v_exp_f32 v87, v87
    v_add_f32 v80, 1.0, v80
    v_add_f32 v81, 1.0, v81
    v_add_f32 v82, 1.0, v82
    v_add_f32 v83, 1.0, v83
    v_add_f32 v84, 1.0, v84
    v_add_f32 v85, 1.0, v85
    v_add_f32 v86, 1.0, v86
    v_add_f32 v87, 1.0, v87
    v_rcp_f32 v80, v80
    v_rcp_f32 v81, v81
    v_rcp_f32 v82, v82
    v_rcp_f32 v83, v83
    v_rcp_f32 v84, v84
    v_rcp_f32 v85, v85
    v_rcp_f32 v86, v86
    v_rcp_f32 v87, v87
    v_mul_f32 v176, v176, v184
    v_mul_f32 v177, v177, v185
    v_mul_f32 v178, v178, v186
    v_mul_f32 v179, v179, v187
    v_mul_f32 v180, v180, v188
    v_mul_f32 v181, v181, v189
    v_mul_f32 v182, v182, v190
    v_mul_f32 v183, v183, v191
    v_mul_f32 v176, v176, v80
    v_mul_f32 v177, v177, v81
    v_mul_f32 v178, v178, v82
    v_mul_f32 v179, v179, v83
    v_mul_f32 v180, v180, v84
    v_mul_f32 v181, v181, v85
    v_mul_f32 v182, v182, v86
    v_mul_f32 v183, v183, v87
    v_cvt_pk_bf16_f32 v96, v176, v177
    v_cvt_pk_bf16_f32 v97, v178, v179
    v_cvt_pk_bf16_f32 v98, v180, v181
    v_cvt_pk_bf16_f32 v99, v182, v183
    buffer_store_dwordx4 v[96:99], v4, s[12:15], s33 offen sc1
    s_add_u32 s32, s31, 1
    s_lshl_b32 s33, s32, 9
    s_add_u32 s33, s33, s29
    v_fmac_f32 v48, v144, v25
    v_fmac_f32 v49, v145, v25
    v_fmac_f32 v50, v146, v25
    v_fmac_f32 v51, v147, v25
    v_fmac_f32 v52, v148, v25
    v_fmac_f32 v53, v149, v25
    v_fmac_f32 v54, v150, v25
    v_fmac_f32 v55, v151, v25
    v_fmac_f32 v56, v152, v25
    v_fmac_f32 v57, v153, v25
    v_fmac_f32 v58, v154, v25
    v_fmac_f32 v59, v155, v25
    s_waitcnt lgkmcnt(3)
    v_fmac_f32 v60, v156, v25
    v_fmac_f32 v61, v157, v25
    v_fmac_f32 v62, v158, v25
    v_fmac_f32 v63, v159, v25
    v_fmac_f32 v192, v48, v24
    v_fmac_f32 v193, v49, v24
    v_fmac_f32 v194, v50, v24
    v_fmac_f32 v195, v51, v24
    v_fmac_f32 v196, v52, v24
    v_fmac_f32 v197, v53, v24
    v_fmac_f32 v198, v54, v24
    v_fmac_f32 v199, v55, v24
    v_fmac_f32 v200, v56, v24
    v_fmac_f32 v201, v57, v24
    v_fmac_f32 v202, v58, v24
    v_fmac_f32 v203, v59, v24
    s_waitcnt lgkmcnt(2)
    v_fmac_f32 v204, v60, v24
    v_fmac_f32 v205, v61, v24
    v_fmac_f32 v206, v62, v24
    v_fmac_f32 v207, v63, v24
    v_mul_f32 v88, s35, v192
    v_mul_f32 v89, s35, v193
    v_mul_f32 v90, s35, v194
    v_mul_f32 v91, s35, v195
    v_mul_f32 v92, s35, v196
    v_mul_f32 v93, s35, v197
    v_mul_f32 v94, s35, v198
    v_mul_f32 v95, s35, v199
    v_exp_f32 v88, v88
    v_exp_f32 v89, v89
    v_exp_f32 v90, v90
    v_exp_f32 v91, v91
    v_exp_f32 v92, v92
    v_exp_f32 v93, v93
    v_exp_f32 v94, v94
    v_exp_f32 v95, v95
    v_add_f32 v88, 1.0, v88
    v_add_f32 v89, 1.0, v89
    v_add_f32 v90, 1.0, v90
    v_add_f32 v91, 1.0, v91
    v_add_f32 v92, 1.0, v92
    v_add_f32 v93, 1.0, v93
    v_add_f32 v94, 1.0, v94
    v_add_f32 v95, 1.0, v95
    v_rcp_f32 v88, v88
    v_rcp_f32 v89, v89
    v_rcp_f32 v90, v90
    v_rcp_f32 v91, v91
    v_rcp_f32 v92, v92
    v_rcp_f32 v93, v93
    v_rcp_f32 v94, v94
    v_rcp_f32 v95, v95
    v_mul_f32 v192, v192, v200
    v_mul_f32 v193, v193, v201
    v_mul_f32 v194, v194, v202
    v_mul_f32 v195, v195, v203
    v_mul_f32 v196, v196, v204
    v_mul_f32 v197, v197, v205
    v_mul_f32 v198, v198, v206
    v_mul_f32 v199, v199, v207
    v_mul_f32 v192, v192, v88
    v_mul_f32 v193, v193, v89
    v_mul_f32 v194, v194, v90
    v_mul_f32 v195, v195, v91
    v_mul_f32 v196, v196, v92
    v_mul_f32 v197, v197, v93
    v_mul_f32 v198, v198, v94
    v_mul_f32 v199, v199, v95
    v_cvt_pk_bf16_f32 v100, v192, v193
    v_cvt_pk_bf16_f32 v101, v194, v195
    v_cvt_pk_bf16_f32 v102, v196, v197
    v_cvt_pk_bf16_f32 v103, v198, v199
    buffer_store_dwordx4 v[100:103], v4, s[12:15], s33 offen sc1
    s_add_u32 s32, s31, 2
    s_lshl_b32 s33, s32, 9
    s_add_u32 s33, s33, s29
    v_fmac_f32 v64, v160, v25
    v_fmac_f32 v65, v161, v25
    v_fmac_f32 v66, v162, v25
    v_fmac_f32 v67, v163, v25
    v_fmac_f32 v68, v164, v25
    v_fmac_f32 v69, v165, v25
    v_fmac_f32 v70, v166, v25
    v_fmac_f32 v71, v167, v25
    v_fmac_f32 v72, v168, v25
    v_fmac_f32 v73, v169, v25
    v_fmac_f32 v74, v170, v25
    v_fmac_f32 v75, v171, v25
    s_waitcnt lgkmcnt(1)
    v_fmac_f32 v76, v172, v25
    v_fmac_f32 v77, v173, v25
    v_fmac_f32 v78, v174, v25
    v_fmac_f32 v79, v175, v25
    v_fmac_f32 v208, v64, v24
    v_fmac_f32 v209, v65, v24
    v_fmac_f32 v210, v66, v24
    v_fmac_f32 v211, v67, v24
    v_fmac_f32 v212, v68, v24
    v_fmac_f32 v213, v69, v24
    v_fmac_f32 v214, v70, v24
    v_fmac_f32 v215, v71, v24
    v_fmac_f32 v216, v72, v24
    v_fmac_f32 v217, v73, v24
    v_fmac_f32 v218, v74, v24
    v_fmac_f32 v219, v75, v24
    s_waitcnt lgkmcnt(0)
    v_fmac_f32 v220, v76, v24
    v_fmac_f32 v221, v77, v24
    v_fmac_f32 v222, v78, v24
    v_fmac_f32 v223, v79, v24
    v_mul_f32 v80, s35, v208
    v_mul_f32 v81, s35, v209
    v_mul_f32 v82, s35, v210
    v_mul_f32 v83, s35, v211
    v_mul_f32 v84, s35, v212
    v_mul_f32 v85, s35, v213
    v_mul_f32 v86, s35, v214
    v_mul_f32 v87, s35, v215
    v_exp_f32 v80, v80
    v_exp_f32 v81, v81
    v_exp_f32 v82, v82
    v_exp_f32 v83, v83
    v_exp_f32 v84, v84
    v_exp_f32 v85, v85
    v_exp_f32 v86, v86
    v_exp_f32 v87, v87
    v_add_f32 v80, 1.0, v80
    v_add_f32 v81, 1.0, v81
    v_add_f32 v82, 1.0, v82
    v_add_f32 v83, 1.0, v83
    v_add_f32 v84, 1.0, v84
    v_add_f32 v85, 1.0, v85
    v_add_f32 v86, 1.0, v86
    v_add_f32 v87, 1.0, v87
    v_rcp_f32 v80, v80
    v_rcp_f32 v81, v81
    v_rcp_f32 v82, v82
    v_rcp_f32 v83, v83
    v_rcp_f32 v84, v84
    v_rcp_f32 v85, v85
    v_rcp_f32 v86, v86
    v_rcp_f32 v87, v87
    v_mul_f32 v208, v208, v216
    v_mul_f32 v209, v209, v217
    v_mul_f32 v210, v210, v218
    v_mul_f32 v211, v211, v219
    v_mul_f32 v212, v212, v220
    v_mul_f32 v213, v213, v221
    v_mul_f32 v214, v214, v222
    v_mul_f32 v215, v215, v223
    v_mul_f32 v208, v208, v80
    v_mul_f32 v209, v209, v81
    v_mul_f32 v210, v210, v82
    v_mul_f32 v211, v211, v83
    v_mul_f32 v212, v212, v84
    v_mul_f32 v213, v213, v85
    v_mul_f32 v214, v214, v86
    v_mul_f32 v215, v215, v87
    v_cvt_pk_bf16_f32 v104, v208, v209
    v_cvt_pk_bf16_f32 v105, v210, v211
    v_cvt_pk_bf16_f32 v106, v212, v213
    v_cvt_pk_bf16_f32 v107, v214, v215
    buffer_store_dwordx4 v[104:107], v4, s[12:15], s33 offen sc1
    s_lshl_b32 s22, s22, 7
    s_lshl_b32 s23, s23, 2
    s_add_u32 s22, s22, s23
    s_add_u32 s22, s22, 12288
    s_waitcnt vmcnt(0) lgkmcnt(0)
L_sigb_p4:
    s_barrier
    s_cmp_lg_u32 s3, 0
    s_cbranch_scc1 L_sig_p4
    s_add_u32 s22, s22, 29622272
    v_lshlrev_b32 v250, 14, v2
    v_add_u32 v250, s22, v250
    v_mov_b32 v251, s83
    s_mov_b64 exec, 0xffff
    global_store_dword v250, v251, s[84:85] sc1
    s_mov_b64 exec, -1
L_sig_p4:
    s_nop 1
    s_and_b32 s20, s2, 7
    s_lshr_b32 s21, s2, 3
    s_lshl_b32 s22, s20, 2
    s_and_b32 s23, s21, 3
    s_add_u32 s22, s22, s23
    s_lshr_b32 s23, s21, 2
    v_lshlrev_b32 v5, 4, v2
    v_add_u32 v6, 4096, v5
    s_mul_i32 s37, s20, 12
    s_lshr_b32 s37, s37, 3
    s_cmp_lt_u32 s3, 4
    s_cbranch_scc1 L_p5_comp
    s_sub_u32 s24, s3, 4
    s_mul_i32 s25, s23, 245760
    s_mul_i32 s26, s24, 5120
    s_add_u32 s25, s25, s26
    s_add_u32 s25, s25, 23265280
    s_mul_i32 s29, s37, 20480
    s_add_u32 s29, s29, s25
    s_add_u32 s37, s37, 1
    s_cmp_ge_u32 s37, 12
    s_cselect_b32 s37, 0, s37
    s_add_u32 m0, s26, 0
    s_nop 0
    buffer_load_dwordx4 v5, s[12:15], s29 offen offset:0 sc1 lds
    buffer_load_dwordx4 v5, s[12:15], s29 offen offset:1024 sc1 lds
    buffer_load_dwordx4 v5, s[12:15], s29 offen offset:2048 sc1 lds
    buffer_load_dwordx4 v5, s[12:15], s29 offen offset:3072 sc1 lds
    s_add_u32 m0, s26, 4096
    s_nop 0
    buffer_load_dwordx4 v6, s[12:15], s29 offen sc1 lds
    s_mul_i32 s29, s37, 20480
    s_add_u32 s29, s29, s25
    s_add_u32 s37, s37, 1
    s_cmp_ge_u32 s37, 12
    s_cselect_b32 s37, 0, s37
    s_add_u32 m0, s26, 20480
    s_nop 0
    buffer_load_dwordx4 v5, s[12:15], s29 offen offset:0 sc1 lds
    buffer_load_dwordx4 v5, s[12:15], s29 offen offset:1024 sc1 lds
    buffer_load_dwordx4 v5, s[12:15], s29 offen offset:2048 sc1 lds
    buffer_load_dwordx4 v5, s[12:15], s29 offen offset:3072 sc1 lds
    s_add_u32 m0, s26, 24576
    s_nop 0
    buffer_load_dwordx4 v6, s[12:15], s29 offen sc1 lds
    s_mul_i32 s29, s37, 20480
    s_add_u32 s29, s29, s25
    s_add_u32 s37, s37, 1
    s_cmp_ge_u32 s37, 12
    s_cselect_b32 s37, 0, s37
    s_add_u32 m0, s26, 40960
    s_nop 0
    buffer_load_dwordx4 v5, s[12:15], s29 offen offset:0 sc1 lds
    buffer_load_dwordx4 v5, s[12:15], s29 offen offset:1024 sc1 lds
    buffer_load_dwordx4 v5, s[12:15], s29 offen offset:2048 sc1 lds
    buffer_load_dwordx4 v5, s[12:15], s29 offen offset:3072 sc1 lds
    s_add_u32 m0, s26, 45056
    s_nop 0
    buffer_load_dwordx4 v6, s[12:15], s29 offen sc1 lds
    s_mul_i32 s29, s37, 20480
    s_add_u32 s29, s29, s25
    s_add_u32 s37, s37, 1
    s_cmp_ge_u32 s37, 12
    s_cselect_b32 s37, 0, s37
    s_add_u32 m0, s26, 61440
    s_nop 0
    buffer_load_dwordx4 v5, s[12:15], s29 offen offset:0 sc1 lds
    buffer_load_dwordx4 v5, s[12:15], s29 offen offset:1024 sc1 lds
    buffer_load_dwordx4 v5, s[12:15], s29 offen offset:2048 sc1 lds
    buffer_load_dwordx4 v5, s[12:15], s29 offen offset:3072 sc1 lds
    s_add_u32 m0, s26, 65536
    s_nop 0
    buffer_load_dwordx4 v6, s[12:15], s29 offen sc1 lds
    s_mul_i32 s29, s37, 20480
    s_add_u32 s29, s29, s25
    s_add_u32 s37, s37, 1
    s_cmp_ge_u32 s37, 12
    s_cselect_b32 s37, 0, s37
    s_add_u32 m0, s26, 81920
    s_nop 0
    buffer_load_dwordx4 v5, s[12:15], s29 offen offset:0 sc1 lds
    buffer_load_dwordx4 v5, s[12:15], s29 offen offset:1024 sc1 lds
    buffer_load_dwordx4 v5, s[12:15], s29 offen offset:2048 sc1 lds
    buffer_load_dwordx4 v5, s[12:15], s29 offen offset:3072 sc1 lds
    s_add_u32 m0, s26, 86016
    s_nop 0
    buffer_load_dwordx4 v6, s[12:15], s29 offen sc1 lds
    s_mul_i32 s29, s37, 20480
    s_add_u32 s29, s29, s25
    s_add_u32 s37, s37, 1
    s_cmp_ge_u32 s37, 12
    s_cselect_b32 s37, 0, s37
    s_add_u32 m0, s26, 102400
    s_nop 0
    buffer_load_dwordx4 v5, s[12:15], s29 offen offset:0 sc1 lds
    buffer_load_dwordx4 v5, s[12:15], s29 offen offset:1024 sc1 lds
    buffer_load_dwordx4 v5, s[12:15], s29 offen offset:2048 sc1 lds
    buffer_load_dwordx4 v5, s[12:15], s29 offen offset:3072 sc1 lds
    s_add_u32 m0, s26, 106496
    s_nop 0
    buffer_load_dwordx4 v6, s[12:15], s29 offen sc1 lds
    s_mul_i32 s29, s37, 20480
    s_add_u32 s29, s29, s25
    s_add_u32 s37, s37, 1
    s_cmp_ge_u32 s37, 12
    s_cselect_b32 s37, 0, s37
    s_add_u32 m0, s26, 122880
    s_nop 0
    buffer_load_dwordx4 v5, s[12:15], s29 offen offset:0 sc1 lds
    buffer_load_dwordx4 v5, s[12:15], s29 offen offset:1024 sc1 lds
    buffer_load_dwordx4 v5, s[12:15], s29 offen offset:2048 sc1 lds
    buffer_load_dwordx4 v5, s[12:15], s29 offen offset:3072 sc1 lds
    s_add_u32 m0, s26, 126976
    s_nop 0
    buffer_load_dwordx4 v6, s[12:15], s29 offen sc1 lds
    s_barrier
    s_waitcnt vmcnt(30)
    s_barrier
    s_waitcnt vmcnt(25)
    s_barrier
    s_waitcnt vmcnt(20)
    s_barrier
    s_mul_i32 s29, s37, 20480
    s_add_u32 s29, s29, s25
    s_add_u32 s37, s37, 1
    s_cmp_ge_u32 s37, 12
    s_cselect_b32 s37, 0, s37
    s_add_u32 m0, s26, 0
    s_nop 0
    buffer_load_dwordx4 v5, s[12:15], s29 offen offset:0 sc1 lds
    buffer_load_dwordx4 v5, s[12:15], s29 offen offset:1024 sc1 lds
    buffer_load_dwordx4 v5, s[12:15], s29 offen offset:2048 sc1 lds
    buffer_load_dwordx4 v5, s[12:15], s29 offen offset:3072 sc1 lds
    s_add_u32 m0, s26, 4096
    s_nop 0
    buffer_load_dwordx4 v6, s[12:15], s29 offen sc1 lds
    s_waitcnt vmcnt(20)
    s_barrier
    s_mul_i32 s29, s37, 20480
    s_add_u32 s29, s29, s25
    s_add_u32 s37, s37, 1
    s_cmp_ge_u32 s37, 12
    s_cselect_b32 s37, 0, s37
    s_add_u32 m0, s26, 20480
    s_nop 0
    buffer_load_dwordx4 v5, s[12:15], s29 offen offset:0 sc1 lds
    buffer_load_dwordx4 v5, s[12:15], s29 offen offset:1024 sc1 lds
    buffer_load_dwordx4 v5, s[12:15], s29 offen offset:2048 sc1 lds
    buffer_load_dwordx4 v5, s[12:15], s29 offen offset:3072 sc1 lds
    s_add_u32 m0, s26, 24576
    s_nop 0
    buffer_load_dwordx4 v6, s[12:15], s29 offen sc1 lds
    s_waitcnt vmcnt(20)
    s_barrier
    s_mul_i32 s29, s37, 20480
    s_add_u32 s29, s29, s25
    s_add_u32 s37, s37, 1
    s_cmp_ge_u32 s37, 12
    s_cselect_b32 s37, 0, s37
    s_add_u32 m0, s26, 40960
    s_nop 0
    buffer_load_dwordx4 v5, s[12:15], s29 offen offset:0 sc1 lds
    buffer_load_dwordx4 v5, s[12:15], s29 offen offset:1024 sc1 lds
    buffer_load_dwordx4 v5, s[12:15], s29 offen offset:2048 sc1 lds
    buffer_load_dwordx4 v5, s[12:15], s29 offen offset:3072 sc1 lds
    s_add_u32 m0, s26, 45056
    s_nop 0
    buffer_load_dwordx4 v6, s[12:15], s29 offen sc1 lds
    s_waitcnt vmcnt(20)
    s_barrier
    s_mul_i32 s29, s37, 20480
    s_add_u32 s29, s29, s25
    s_add_u32 s37, s37, 1
    s_cmp_ge_u32 s37, 12
    s_cselect_b32 s37, 0, s37
    s_add_u32 m0, s26, 61440
    s_nop 0
    buffer_load_dwordx4 v5, s[12:15], s29 offen offset:0 sc1 lds
    buffer_load_dwordx4 v5, s[12:15], s29 offen offset:1024 sc1 lds
    buffer_load_dwordx4 v5, s[12:15], s29 offen offset:2048 sc1 lds
    buffer_load_dwordx4 v5, s[12:15], s29 offen offset:3072 sc1 lds
    s_add_u32 m0, s26, 65536
    s_nop 0
    buffer_load_dwordx4 v6, s[12:15], s29 offen sc1 lds
    s_waitcnt vmcnt(20)
    s_barrier
    s_mul_i32 s29, s37, 20480
    s_add_u32 s29, s29, s25
    s_add_u32 s37, s37, 1
    s_cmp_ge_u32 s37, 12
    s_cselect_b32 s37, 0, s37
    s_add_u32 m0, s26, 81920
    s_nop 0
    buffer_load_dwordx4 v5, s[12:15], s29 offen offset:0 sc1 lds
    buffer_load_dwordx4 v5, s[12:15], s29 offen offset:1024 sc1 lds
    buffer_load_dwordx4 v5, s[12:15], s29 offen offset:2048 sc1 lds
    buffer_load_dwordx4 v5, s[12:15], s29 offen offset:3072 sc1 lds
    s_add_u32 m0, s26, 86016
    s_nop 0
    buffer_load_dwordx4 v6, s[12:15], s29 offen sc1 lds
    s_waitcnt vmcnt(20)
    s_barrier
    s_waitcnt vmcnt(15)
    s_barrier
    s_waitcnt vmcnt(10)
    s_barrier
    s_waitcnt vmcnt(5)
    s_barrier
    s_waitcnt vmcnt(0)
    s_barrier
    s_endpgm
L_p5_comp:
    s_mov_b32 s16, s98
    s_and_b32 s17, s99, 0xffff
    s_mov_b32 s18, 2621440
    s_mov_b32 s19, 0x00020000
    s_mov_b32 s24, s3
    v_and_b32 v3, 15, v2
    v_lshrrev_b32 v4, 4, v2
    s_lshl_b32 s31, s22, 2
    s_add_u32 s31, s31, s24
    s_mul_i32 s27, s31, 49152
    s_add_u32 s27, s27, 16121856
    s_mul_i32 s32, s23, 320
    s_add_u32 s32, s32, 12800
    v_lshlrev_b32 v13, 4, v4
    s_lshr_b32 s33, s31, 1
    s_mul_i32 s33, s33, 40960
    s_mul_i32 s34, s23, 5120
    s_add_u32 s33, s33, s34
    s_add_u32 s33, s33, 13369344
    s_and_b32 s34, s31, 1
    s_lshl_b32 s34, s34, 8
    v_lshl_add_u32 v14, v3, 4, s34
    v_lshrrev_b32 v15, 1, v4
    v_lshl_add_u32 v14, v15, 9, v14
    v_and_b32 v15, 1, v4
    v_lshl_add_u32 v14, v15, 3, v14
    s_mul_i32 s34, s31, 20480
    s_mul_i32 s35, s23, 160
    s_add_u32 s34, s34, s35
    v_mul_u32_u24 v15, 1280, v3
    v_lshl_add_u32 v15, v4, 3, v15
    v_add_u32 v21, 4096, v14
    v_add_u32 v7, 61440, v5
    v_add_u32 v8, 122880, v5
    s_lshr_b32 s36, s22, 1
    s_lshl_b32 s36, s36, 7
    s_add_u32 s36, s36, 12288
    buffer_load_dwordx4 v[132:135], v13, s[12:15], s32 offen offset:0 sc1
    v_mov_b32 v152, v236
    v_mov_b32 v153, v237
    buffer_load_dwordx4 v[136:139], v13, s[12:15], s32 offen offset:64 sc1
    v_mov_b32 v154, v238
    v_mov_b32 v155, v239
    buffer_load_dwordx4 v[140:143], v13, s[12:15], s32 offen offset:128 sc1
    v_mov_b32 v156, v240
    v_mov_b32 v157, v241
    buffer_load_dwordx4 v[144:147], v13, s[12:15], s32 offen offset:192 sc1
    v_mov_b32 v158, v242
    v_mov_b32 v159, v243
    buffer_load_dwordx4 v[148:151], v13, s[12:15], s32 offen offset:256 sc1
    v_mov_b32 v160, v244
    v_mov_b32 v161, v245
    s_cmp_lg_u32 s3, 0
    s_cbranch_scc1 L_wt_p5
    s_and_b32 s82, s2, 15
    s_lshl_b32 s82, s82, 14
    s_add_u32 s82, s82, 29622272
    s_add_u32 s4, s84, s82
    s_addc_u32 s5, s85, 0
    s_mov_b32 s6, s83
    s_mov_b32 s7, s83
    s_mov_b32 s82, 0x200000
L_wl_p5:
    s_load_dwordx16 s[48:63], s[4:5], s36 glc
    s_waitcnt lgkmcnt(0)
    s_xor_b64 s[48:49], s[48:49], s[6:7]
    s_xor_b64 s[50:51], s[50:51], s[6:7]
    s_xor_b64 s[52:53], s[52:53], s[6:7]
    s_xor_b64 s[54:55], s[54:55], s[6:7]
    s_xor_b64 s[56:57], s[56:57], s[6:7]
    s_xor_b64 s[58:59], s[58:59], s[6:7]
    s_xor_b64 s[60:61], s[60:61], s[6:7]
    s_xor_b64 s[62:63], s[62:63], s[6:7]
    s_or_b64 s[48:49], s[48:49], s[50:51]
    s_or_b64 s[48:49], s[48:49], s[52:53]
    s_or_b64 s[48:49], s[48:49], s[54:55]
    s_or_b64 s[48:49], s[48:49], s[56:57]
    s_or_b64 s[48:49], s[48:49], s[58:59]
    s_or_b64 s[48:49], s[48:49], s[60:61]
    s_or_b64 s[48:49], s[48:49], s[62:63]
    s_cbranch_scc0 L_wt_p5
    s_sleep 1
    s_sub_u32 s82, s82, 1
    s_cmp_lg_u32 s82, 0
    s_cbranch_scc1 L_wl_p5
L_wt_p5:
    s_nop 1
    s_barrier
    s_lshl_b32 s30, s37, 12
    s_add_u32 s30, s30, s27
    s_add_u32 s37, s37, 1
    s_cmp_ge_u32 s37, 12
    s_cselect_b32 s37, 0, s37
    buffer_load_dwordx4 v[164:167], v5, s[12:15], s30 offen offset:0 sc1
    buffer_load_dwordx4 v[168:171], v5, s[12:15], s30 offen offset:1024 sc1
    buffer_load_dwordx4 v[172:175], v5, s[12:15], s30 offen offset:2048 sc1
    buffer_load_dwordx4 v[176:179], v5, s[12:15], s30 offen offset:3072 sc1
    s_lshl_b32 s30, s37, 12
    s_add_u32 s30, s30, s27
    s_add_u32 s37, s37, 1
    s_cmp_ge_u32 s37, 12
    s_cselect_b32 s37, 0, s37
    buffer_load_dwordx4 v[180:183], v5, s[12:15], s30 offen offset:0 sc1
    buffer_load_dwordx4 v[184:187], v5, s[12:15], s30 offen offset:1024 sc1
    buffer_load_dwordx4 v[188:191], v5, s[12:15], s30 offen offset:2048 sc1
    buffer_load_dwordx4 v[192:195], v5, s[12:15], s30 offen offset:3072 sc1
    s_lshl_b32 s30, s37, 12
    s_add_u32 s30, s30, s27
    s_add_u32 s37, s37, 1
    s_cmp_ge_u32 s37, 12
    s_cselect_b32 s37, 0, s37
    buffer_load_dwordx4 v[196:199], v5, s[12:15], s30 offen offset:0 sc1
    buffer_load_dwordx4 v[200:203], v5, s[12:15], s30 offen offset:1024 sc1
    buffer_load_dwordx4 v[204:207], v5, s[12:15], s30 offen offset:2048 sc1
    buffer_load_dwordx4 v[208:211], v5, s[12:15], s30 offen offset:3072 sc1
    s_lshl_b32 s30, s37, 12
    s_add_u32 s30, s30, s27
    s_add_u32 s37, s37, 1
    s_cmp_ge_u32 s37, 12
    s_cselect_b32 s37, 0, s37
    buffer_load_dwordx4 v[212:215], v5, s[12:15], s30 offen offset:0 sc1
    buffer_load_dwordx4 v[216:219], v5, s[12:15], s30 offen offset:1024 sc1
    buffer_load_dwordx4 v[220:223], v5, s[12:15], s30 offen offset:2048 sc1
    buffer_load_dwordx4 v[224:227], v5, s[12:15], s30 offen offset:3072 sc1
    s_barrier
    ds_read_b128 v[52:55], v5 offset:0
    ds_read_b128 v[56:59], v5 offset:1024
    ds_read_b128 v[60:63], v5 offset:2048
    ds_read_b128 v[64:67], v5 offset:3072
    ds_read_b128 v[68:71], v5 offset:4096
    ds_read_b128 v[72:75], v5 offset:5120
    ds_read_b128 v[76:79], v5 offset:6144
    ds_read_b128 v[80:83], v5 offset:7168
    ds_read_b128 v[84:87], v5 offset:8192
    ds_read_b128 v[88:91], v5 offset:9216
    ds_read_b128 v[92:95], v5 offset:10240
    ds_read_b128 v[96:99], v5 offset:11264
    ds_read_b128 v[100:103], v5 offset:12288
    ds_read_b128 v[104:107], v5 offset:13312
    ds_read_b128 v[108:111], v5 offset:14336
    s_waitcnt vmcnt(15) lgkmcnt(14)
    v_mfma_f32_16x16x32_bf16 v[32:35], v[52:55], v[164:167], 0
    ds_read_b128 v[112:115], v5 offset:15360
    s_waitcnt lgkmcnt(14)
    v_mfma_f32_16x16x32_bf16 v[36:39], v[56:59], v[164:167], 0
    ds_read_b128 v[116:119], v5 offset:16384
    s_waitcnt lgkmcnt(14)
    v_mfma_f32_16x16x32_bf16 v[40:43], v[60:63], v[164:167], 0
    ds_read_b128 v[120:123], v5 offset:17408
    s_waitcnt lgkmcnt(14)
    v_mfma_f32_16x16x32_bf16 v[44:47], v[64:67], v[164:167], 0
    ds_read_b128 v[124:127], v5 offset:18432
    s_waitcnt lgkmcnt(14)
    v_mfma_f32_16x16x32_bf16 v[48:51], v[68:71], v[164:167], 0
    ds_read_b128 v[128:131], v5 offset:19456
    s_lshl_b32 s30, s37, 12
    s_add_u32 s30, s30, s27
    s_add_u32 s37, s37, 1
    s_cmp_ge_u32 s37, 12
    s_cselect_b32 s37, 0, s37
    buffer_load_dwordx4 v[228:231], v5, s[12:15], s30 offen offset:0 sc1
    buffer_load_dwordx4 v[232:235], v5, s[12:15], s30 offen offset:1024 sc1
    buffer_load_dwordx4 v[236:239], v5, s[12:15], s30 offen offset:2048 sc1
    buffer_load_dwordx4 v[240:243], v5, s[12:15], s30 offen offset:3072 sc1
    s_barrier
    s_waitcnt vmcnt(18) lgkmcnt(14)
    v_mfma_f32_16x16x32_bf16 v[32:35], v[72:75], v[168:171], v[32:35]
    ds_read_b128 v[52:55], v5 offset:20480
    s_waitcnt lgkmcnt(14)
    v_mfma_f32_16x16x32_bf16 v[36:39], v[76:79], v[168:171], v[36:39]
    ds_read_b128 v[56:59], v5 offset:21504
    s_waitcnt lgkmcnt(14)
    v_mfma_f32_16x16x32_bf16 v[40:43], v[80:83], v[168:171], v[40:43]
    ds_read_b128 v[60:63], v5 offset:22528
    s_waitcnt lgkmcnt(14)
    v_mfma_f32_16x16x32_bf16 v[44:47], v[84:87], v[168:171], v[44:47]
    ds_read_b128 v[64:67], v5 offset:23552
    s_waitcnt lgkmcnt(14)
    v_mfma_f32_16x16x32_bf16 v[48:51], v[88:91], v[168:171], v[48:51]
    ds_read_b128 v[68:71], v5 offset:24576
    s_waitcnt vmcnt(17) lgkmcnt(14)
    v_mfma_f32_16x16x32_bf16 v[32:35], v[92:95], v[172:175], v[32:35]
    ds_read_b128 v[72:75], v5 offset:25600
    s_waitcnt lgkmcnt(14)
    v_mfma_f32_16x16x32_bf16 v[36:39], v[96:99], v[172:175], v[36:39]
    ds_read_b128 v[76:79], v5 offset:26624
    s_waitcnt lgkmcnt(14)
    v_mfma_f32_16x16x32_bf16 v[40:43], v[100:103], v[172:175], v[40:43]
    ds_read_b128 v[80:83], v5 offset:27648
    s_waitcnt lgkmcnt(14)
    v_mfma_f32_16x16x32_bf16 v[44:47], v[104:107], v[172:175], v[44:47]
    ds_read_b128 v[84:87], v5 offset:28672
    s_waitcnt lgkmcnt(14)
    v_mfma_f32_16x16x32_bf16 v[48:51], v[108:111], v[172:175], v[48:51]
    ds_read_b128 v[88:91], v5 offset:29696
    s_waitcnt vmcnt(16) lgkmcnt(14)
    v_mfma_f32_16x16x32_bf16 v[32:35], v[112:115], v[176:179], v[32:35]
    ds_read_b128 v[92:95], v5 offset:30720
    s_waitcnt lgkmcnt(14)
    v_mfma_f32_16x16x32_bf16 v[36:39], v[116:119], v[176:179], v[36:39]
    ds_read_b128 v[96:99], v5 offset:31744
    s_waitcnt lgkmcnt(14)
    v_mfma_f32_16x16x32_bf16 v[40:43], v[120:123], v[176:179], v[40:43]
    ds_read_b128 v[100:103], v5 offset:32768
    s_waitcnt lgkmcnt(14)
    v_mfma_f32_16x16x32_bf16 v[44:47], v[124:127], v[176:179], v[44:47]
    ds_read_b128 v[104:107], v5 offset:33792
    s_waitcnt lgkmcnt(14)
    v_mfma_f32_16x16x32_bf16 v[48:51], v[128:131], v[176:179], v[48:51]
    ds_read_b128 v[108:111], v5 offset:34816
    s_waitcnt vmcnt(15) lgkmcnt(14)
    v_mfma_f32_16x16x32_bf16 v[32:35], v[52:55], v[180:183], v[32:35]
    ds_read_b128 v[112:115], v5 offset:35840
    s_waitcnt lgkmcnt(14)
    v_mfma_f32_16x16x32_bf16 v[36:39], v[56:59], v[180:183], v[36:39]
    ds_read_b128 v[116:119], v5 offset:36864
    s_waitcnt lgkmcnt(14)
    v_mfma_f32_16x16x32_bf16 v[40:43], v[60:63], v[180:183], v[40:43]
    ds_read_b128 v[120:123], v5 offset:37888
    s_waitcnt lgkmcnt(14)
    v_mfma_f32_16x16x32_bf16 v[44:47], v[64:67], v[180:183], v[44:47]
    ds_read_b128 v[124:127], v5 offset:38912
    s_waitcnt lgkmcnt(14)
    v_mfma_f32_16x16x32_bf16 v[48:51], v[68:71], v[180:183], v[48:51]
    ds_read_b128 v[128:131], v5 offset:39936
    s_lshl_b32 s30, s37, 12
    s_add_u32 s30, s30, s27
    s_add_u32 s37, s37, 1
    s_cmp_ge_u32 s37, 12
    s_cselect_b32 s37, 0, s37
    buffer_load_dwordx4 v[164:167], v5, s[12:15], s30 offen offset:0 sc1
    buffer_load_dwordx4 v[168:171], v5, s[12:15], s30 offen offset:1024 sc1
    buffer_load_dwordx4 v[172:175], v5, s[12:15], s30 offen offset:2048 sc1
    buffer_load_dwordx4 v[176:179], v5, s[12:15], s30 offen offset:3072 sc1
    s_barrier
    s_waitcnt vmcnt(18) lgkmcnt(14)
    v_mfma_f32_16x16x32_bf16 v[32:35], v[72:75], v[184:187], v[32:35]
    ds_read_b128 v[52:55], v5 offset:40960
    s_waitcnt lgkmcnt(14)
    v_mfma_f32_16x16x32_bf16 v[36:39], v[76:79], v[184:187], v[36:39]
    ds_read_b128 v[56:59], v5 offset:41984
    s_waitcnt lgkmcnt(14)
    v_mfma_f32_16x16x32_bf16 v[40:43], v[80:83], v[184:187], v[40:43]
    ds_read_b128 v[60:63], v5 offset:43008
    s_waitcnt lgkmcnt(14)
    v_mfma_f32_16x16x32_bf16 v[44:47], v[84:87], v[184:187], v[44:47]
    ds_read_b128 v[64:67], v5 offset:44032
    s_waitcnt lgkmcnt(14)
    v_mfma_f32_16x16x32_bf16 v[48:51], v[88:91], v[184:187], v[48:51]
    ds_read_b128 v[68:71], v5 offset:45056
    s_waitcnt vmcnt(17) lgkmcnt(14)
    v_mfma_f32_16x16x32_bf16 v[32:35], v[92:95], v[188:191], v[32:35]
    ds_read_b128 v[72:75], v5 offset:46080
    s_waitcnt lgkmcnt(14)
    v_mfma_f32_16x16x32_bf16 v[36:39], v[96:99], v[188:191], v[36:39]
    ds_read_b128 v[76:79], v5 offset:47104
    s_waitcnt lgkmcnt(14)
    v_mfma_f32_16x16x32_bf16 v[40:43], v[100:103], v[188:191], v[40:43]
    ds_read_b128 v[80:83], v5 offset:48128
    s_waitcnt lgkmcnt(14)
    v_mfma_f32_16x16x32_bf16 v[44:47], v[104:107], v[188:191], v[44:47]
    ds_read_b128 v[84:87], v5 offset:49152
    s_waitcnt lgkmcnt(14)
    v_mfma_f32_16x16x32_bf16 v[48:51], v[108:111], v[188:191], v[48:51]
    ds_read_b128 v[88:91], v5 offset:50176
    s_waitcnt vmcnt(16) lgkmcnt(14)
    v_mfma_f32_16x16x32_bf16 v[32:35], v[112:115], v[192:195], v[32:35]
    ds_read_b128 v[92:95], v5 offset:51200
    s_waitcnt lgkmcnt(14)
    v_mfma_f32_16x16x32_bf16 v[36:39], v[116:119], v[192:195], v[36:39]
    ds_read_b128 v[96:99], v5 offset:52224
    s_waitcnt lgkmcnt(14)
    v_mfma_f32_16x16x32_bf16 v[40:43], v[120:123], v[192:195], v[40:43]
    ds_read_b128 v[100:103], v5 offset:53248
    s_waitcnt lgkmcnt(14)
    v_mfma_f32_16x16x32_bf16 v[44:47], v[124:127], v[192:195], v[44:47]
    ds_read_b128 v[104:107], v5 offset:54272
    s_waitcnt lgkmcnt(14)
    v_mfma_f32_16x16x32_bf16 v[48:51], v[128:131], v[192:195], v[48:51]
    ds_read_b128 v[108:111], v5 offset:55296
    s_waitcnt vmcnt(15) lgkmcnt(14)
    v_mfma_f32_16x16x32_bf16 v[32:35], v[52:55], v[196:199], v[32:35]
    ds_read_b128 v[112:115], v5 offset:56320
    s_waitcnt lgkmcnt(14)
    v_mfma_f32_16x16x32_bf16 v[36:39], v[56:59], v[196:199], v[36:39]
    ds_read_b128 v[116:119], v5 offset:57344
    s_waitcnt lgkmcnt(14)
    v_mfma_f32_16x16x32_bf16 v[40:43], v[60:63], v[196:199], v[40:43]
    ds_read_b128 v[120:123], v5 offset:58368
    s_waitcnt lgkmcnt(14)
    v_mfma_f32_16x16x32_bf16 v[44:47], v[64:67], v[196:199], v[44:47]
    ds_read_b128 v[124:127], v5 offset:59392
    s_waitcnt lgkmcnt(14)
    v_mfma_f32_16x16x32_bf16 v[48:51], v[68:71], v[196:199], v[48:51]
    ds_read_b128 v[128:131], v5 offset:60416
    s_lshl_b32 s30, s37, 12
    s_add_u32 s30, s30, s27
    s_add_u32 s37, s37, 1
    s_cmp_ge_u32 s37, 12
    s_cselect_b32 s37, 0, s37
    buffer_load_dwordx4 v[180:183], v5, s[12:15], s30 offen offset:0 sc1
    buffer_load_dwordx4 v[184:187], v5, s[12:15], s30 offen offset:1024 sc1
    buffer_load_dwordx4 v[188:191], v5, s[12:15], s30 offen offset:2048 sc1
    buffer_load_dwordx4 v[192:195], v5, s[12:15], s30 offen offset:3072 sc1
    s_barrier
    s_waitcnt vmcnt(18) lgkmcnt(14)
    v_mfma_f32_16x16x32_bf16 v[32:35], v[72:75], v[200:203], v[32:35]
    ds_read_b128 v[52:55], v7 offset:0
    s_waitcnt lgkmcnt(14)
    v_mfma_f32_16x16x32_bf16 v[36:39], v[76:79], v[200:203], v[36:39]
    ds_read_b128 v[56:59], v7 offset:1024
    s_waitcnt lgkmcnt(14)
    v_mfma_f32_16x16x32_bf16 v[40:43], v[80:83], v[200:203], v[40:43]
    ds_read_b128 v[60:63], v7 offset:2048
    s_waitcnt lgkmcnt(14)
    v_mfma_f32_16x16x32_bf16 v[44:47], v[84:87], v[200:203], v[44:47]
    ds_read_b128 v[64:67], v7 offset:3072
    s_waitcnt lgkmcnt(14)
    v_mfma_f32_16x16x32_bf16 v[48:51], v[88:91], v[200:203], v[48:51]
    ds_read_b128 v[68:71], v7 offset:4096
    s_waitcnt vmcnt(17) lgkmcnt(14)
    v_mfma_f32_16x16x32_bf16 v[32:35], v[92:95], v[204:207], v[32:35]
    ds_read_b128 v[72:75], v7 offset:5120
    s_waitcnt lgkmcnt(14)
    v_mfma_f32_16x16x32_bf16 v[36:39], v[96:99], v[204:207], v[36:39]
    ds_read_b128 v[76:79], v7 offset:6144
    s_waitcnt lgkmcnt(14)
    v_mfma_f32_16x16x32_bf16 v[40:43], v[100:103], v[204:207], v[40:43]
    ds_read_b128 v[80:83], v7 offset:7168
    s_waitcnt lgkmcnt(14)
    v_mfma_f32_16x16x32_bf16 v[44:47], v[104:107], v[204:207], v[44:47]
    ds_read_b128 v[84:87], v7 offset:8192
    s_waitcnt lgkmcnt(14)
    v_mfma_f32_16x16x32_bf16 v[48:51], v[108:111], v[204:207], v[48:51]
    ds_read_b128 v[88:91], v7 offset:9216
    s_waitcnt vmcnt(16) lgkmcnt(14)
    v_mfma_f32_16x16x32_bf16 v[32:35], v[112:115], v[208:211], v[32:35]
    ds_read_b128 v[92:95], v7 offset:10240
    s_waitcnt lgkmcnt(14)
    v_mfma_f32_16x16x32_bf16 v[36:39], v[116:119], v[208:211], v[36:39]
    ds_read_b128 v[96:99], v7 offset:11264
    s_waitcnt lgkmcnt(14)
    v_mfma_f32_16x16x32_bf16 v[40:43], v[120:123], v[208:211], v[40:43]
    ds_read_b128 v[100:103], v7 offset:12288
    s_waitcnt lgkmcnt(14)
    v_mfma_f32_16x16x32_bf16 v[44:47], v[124:127], v[208:211], v[44:47]
    ds_read_b128 v[104:107], v7 offset:13312
    s_waitcnt lgkmcnt(14)
    v_mfma_f32_16x16x32_bf16 v[48:51], v[128:131], v[208:211], v[48:51]
    ds_read_b128 v[108:111], v7 offset:14336
    s_waitcnt vmcnt(15) lgkmcnt(14)
    v_mfma_f32_16x16x32_bf16 v[32:35], v[52:55], v[212:215], v[32:35]
    ds_read_b128 v[112:115], v7 offset:15360
    s_waitcnt lgkmcnt(14)
    v_mfma_f32_16x16x32_bf16 v[36:39], v[56:59], v[212:215], v[36:39]
    ds_read_b128 v[116:119], v7 offset:16384
    s_waitcnt lgkmcnt(14)
    v_mfma_f32_16x16x32_bf16 v[40:43], v[60:63], v[212:215], v[40:43]
    ds_read_b128 v[120:123], v7 offset:17408
    s_waitcnt lgkmcnt(14)
    v_mfma_f32_16x16x32_bf16 v[44:47], v[64:67], v[212:215], v[44:47]
    ds_read_b128 v[124:127], v7 offset:18432
    s_waitcnt lgkmcnt(14)
    v_mfma_f32_16x16x32_bf16 v[48:51], v[68:71], v[212:215], v[48:51]
    ds_read_b128 v[128:131], v7 offset:19456
    s_lshl_b32 s30, s37, 12
    s_add_u32 s30, s30, s27
    s_add_u32 s37, s37, 1
    s_cmp_ge_u32 s37, 12
    s_cselect_b32 s37, 0, s37
    buffer_load_dwordx4 v[196:199], v5, s[12:15], s30 offen offset:0 sc1
    buffer_load_dwordx4 v[200:203], v5, s[12:15], s30 offen offset:1024 sc1
    buffer_load_dwordx4 v[204:207], v5, s[12:15], s30 offen offset:2048 sc1
    buffer_load_dwordx4 v[208:211], v5, s[12:15], s30 offen offset:3072 sc1
    s_barrier
    s_waitcnt vmcnt(18) lgkmcnt(14)
    v_mfma_f32_16x16x32_bf16 v[32:35], v[72:75], v[216:219], v[32:35]
    ds_read_b128 v[52:55], v7 offset:20480
    s_waitcnt lgkmcnt(14)
    v_mfma_f32_16x16x32_bf16 v[36:39], v[76:79], v[216:219], v[36:39]
    ds_read_b128 v[56:59], v7 offset:21504
    s_waitcnt lgkmcnt(14)
    v_mfma_f32_16x16x32_bf16 v[40:43], v[80:83], v[216:219], v[40:43]
    ds_read_b128 v[60:63], v7 offset:22528
    s_waitcnt lgkmcnt(14)
    v_mfma_f32_16x16x32_bf16 v[44:47], v[84:87], v[216:219], v[44:47]
    ds_read_b128 v[64:67], v7 offset:23552
    s_waitcnt lgkmcnt(14)
    v_mfma_f32_16x16x32_bf16 v[48:51], v[88:91], v[216:219], v[48:51]
    ds_read_b128 v[68:71], v7 offset:24576
    s_waitcnt vmcnt(17) lgkmcnt(14)
    v_mfma_f32_16x16x32_bf16 v[32:35], v[92:95], v[220:223], v[32:35]
    ds_read_b128 v[72:75], v7 offset:25600
    s_waitcnt lgkmcnt(14)
    v_mfma_f32_16x16x32_bf16 v[36:39], v[96:99], v[220:223], v[36:39]
    ds_read_b128 v[76:79], v7 offset:26624
    s_waitcnt lgkmcnt(14)
    v_mfma_f32_16x16x32_bf16 v[40:43], v[100:103], v[220:223], v[40:43]
    ds_read_b128 v[80:83], v7 offset:27648
    s_waitcnt lgkmcnt(14)
    v_mfma_f32_16x16x32_bf16 v[44:47], v[104:107], v[220:223], v[44:47]
    ds_read_b128 v[84:87], v7 offset:28672
    s_waitcnt lgkmcnt(14)
    v_mfma_f32_16x16x32_bf16 v[48:51], v[108:111], v[220:223], v[48:51]
    ds_read_b128 v[88:91], v7 offset:29696
    s_waitcnt vmcnt(16) lgkmcnt(14)
    v_mfma_f32_16x16x32_bf16 v[32:35], v[112:115], v[224:227], v[32:35]
    ds_read_b128 v[92:95], v7 offset:30720
    s_waitcnt lgkmcnt(14)
    v_mfma_f32_16x16x32_bf16 v[36:39], v[116:119], v[224:227], v[36:39]
    ds_read_b128 v[96:99], v7 offset:31744
    s_waitcnt lgkmcnt(14)
    v_mfma_f32_16x16x32_bf16 v[40:43], v[120:123], v[224:227], v[40:43]
    ds_read_b128 v[100:103], v7 offset:32768
    s_waitcnt lgkmcnt(14)
    v_mfma_f32_16x16x32_bf16 v[44:47], v[124:127], v[224:227], v[44:47]
    ds_read_b128 v[104:107], v7 offset:33792
    s_waitcnt lgkmcnt(14)
    v_mfma_f32_16x16x32_bf16 v[48:51], v[128:131], v[224:227], v[48:51]
    ds_read_b128 v[108:111], v7 offset:34816
    s_waitcnt vmcnt(15) lgkmcnt(14)
    v_mfma_f32_16x16x32_bf16 v[32:35], v[52:55], v[228:231], v[32:35]
    ds_read_b128 v[112:115], v7 offset:35840
    s_waitcnt lgkmcnt(14)
    v_mfma_f32_16x16x32_bf16 v[36:39], v[56:59], v[228:231], v[36:39]
    ds_read_b128 v[116:119], v7 offset:36864
    s_waitcnt lgkmcnt(14)
    v_mfma_f32_16x16x32_bf16 v[40:43], v[60:63], v[228:231], v[40:43]
    ds_read_b128 v[120:123], v7 offset:37888
    s_waitcnt lgkmcnt(14)
    v_mfma_f32_16x16x32_bf16 v[44:47], v[64:67], v[228:231], v[44:47]
    ds_read_b128 v[124:127], v7 offset:38912
    s_waitcnt lgkmcnt(14)
    v_mfma_f32_16x16x32_bf16 v[48:51], v[68:71], v[228:231], v[48:51]
    ds_read_b128 v[128:131], v7 offset:39936
    s_lshl_b32 s30, s37, 12
    s_add_u32 s30, s30, s27
    s_add_u32 s37, s37, 1
    s_cmp_ge_u32 s37, 12
    s_cselect_b32 s37, 0, s37
    buffer_load_dwordx4 v[212:215], v5, s[12:15], s30 offen offset:0 sc1
    buffer_load_dwordx4 v[216:219], v5, s[12:15], s30 offen offset:1024 sc1
    buffer_load_dwordx4 v[220:223], v5, s[12:15], s30 offen offset:2048 sc1
    buffer_load_dwordx4 v[224:227], v5, s[12:15], s30 offen offset:3072 sc1
    s_barrier
    s_waitcnt vmcnt(18) lgkmcnt(14)
    v_mfma_f32_16x16x32_bf16 v[32:35], v[72:75], v[232:235], v[32:35]
    ds_read_b128 v[52:55], v7 offset:40960
    s_waitcnt lgkmcnt(14)
    v_mfma_f32_16x16x32_bf16 v[36:39], v[76:79], v[232:235], v[36:39]
    ds_read_b128 v[56:59], v7 offset:41984
    s_waitcnt lgkmcnt(14)
    v_mfma_f32_16x16x32_bf16 v[40:43], v[80:83], v[232:235], v[40:43]
    ds_read_b128 v[60:63], v7 offset:43008
    s_waitcnt lgkmcnt(14)
    v_mfma_f32_16x16x32_bf16 v[44:47], v[84:87], v[232:235], v[44:47]
    ds_read_b128 v[64:67], v7 offset:44032
    s_waitcnt lgkmcnt(14)
    v_mfma_f32_16x16x32_bf16 v[48:51], v[88:91], v[232:235], v[48:51]
    ds_read_b128 v[68:71], v7 offset:45056
    s_waitcnt vmcnt(17) lgkmcnt(14)
    v_mfma_f32_16x16x32_bf16 v[32:35], v[92:95], v[236:239], v[32:35]
    ds_read_b128 v[72:75], v7 offset:46080
    s_waitcnt lgkmcnt(14)
    v_mfma_f32_16x16x32_bf16 v[36:39], v[96:99], v[236:239], v[36:39]
    ds_read_b128 v[76:79], v7 offset:47104
    s_waitcnt lgkmcnt(14)
    v_mfma_f32_16x16x32_bf16 v[40:43], v[100:103], v[236:239], v[40:43]
    ds_read_b128 v[80:83], v7 offset:48128
    s_waitcnt lgkmcnt(14)
    v_mfma_f32_16x16x32_bf16 v[44:47], v[104:107], v[236:239], v[44:47]
    ds_read_b128 v[84:87], v7 offset:49152
    s_waitcnt lgkmcnt(14)
    v_mfma_f32_16x16x32_bf16 v[48:51], v[108:111], v[236:239], v[48:51]
    ds_read_b128 v[88:91], v7 offset:50176
    s_waitcnt vmcnt(16) lgkmcnt(14)
    v_mfma_f32_16x16x32_bf16 v[32:35], v[112:115], v[240:243], v[32:35]
    ds_read_b128 v[92:95], v7 offset:51200
    s_waitcnt lgkmcnt(14)
    v_mfma_f32_16x16x32_bf16 v[36:39], v[116:119], v[240:243], v[36:39]
    ds_read_b128 v[96:99], v7 offset:52224
    s_waitcnt lgkmcnt(14)
    v_mfma_f32_16x16x32_bf16 v[40:43], v[120:123], v[240:243], v[40:43]
    ds_read_b128 v[100:103], v7 offset:53248
    s_waitcnt lgkmcnt(14)
    v_mfma_f32_16x16x32_bf16 v[44:47], v[124:127], v[240:243], v[44:47]
    ds_read_b128 v[104:107], v7 offset:54272
    s_waitcnt lgkmcnt(14)
    v_mfma_f32_16x16x32_bf16 v[48:51], v[128:131], v[240:243], v[48:51]
    ds_read_b128 v[108:111], v7 offset:55296
    s_waitcnt vmcnt(15) lgkmcnt(14)
    v_mfma_f32_16x16x32_bf16 v[32:35], v[52:55], v[164:167], v[32:35]
    ds_read_b128 v[112:115], v7 offset:56320
    s_waitcnt lgkmcnt(14)
    v_mfma_f32_16x16x32_bf16 v[36:39], v[56:59], v[164:167], v[36:39]
    ds_read_b128 v[116:119], v7 offset:57344
    s_waitcnt lgkmcnt(14)
    v_mfma_f32_16x16x32_bf16 v[40:43], v[60:63], v[164:167], v[40:43]
    ds_read_b128 v[120:123], v7 offset:58368
    s_waitcnt lgkmcnt(14)
    v_mfma_f32_16x16x32_bf16 v[44:47], v[64:67], v[164:167], v[44:47]
    ds_read_b128 v[124:127], v7 offset:59392
    s_waitcnt lgkmcnt(14)
    v_mfma_f32_16x16x32_bf16 v[48:51], v[68:71], v[164:167], v[48:51]
    ds_read_b128 v[128:131], v7 offset:60416
    s_lshl_b32 s30, s37, 12
    s_add_u32 s30, s30, s27
    s_add_u32 s37, s37, 1
    s_cmp_ge_u32 s37, 12
    s_cselect_b32 s37, 0, s37
    buffer_load_dwordx4 v[228:231], v5, s[12:15], s30 offen offset:0 sc1
    buffer_load_dwordx4 v[232:235], v5, s[12:15], s30 offen offset:1024 sc1
    buffer_load_dwordx4 v[236:239], v5, s[12:15], s30 offen offset:2048 sc1
    buffer_load_dwordx4 v[240:243], v5, s[12:15], s30 offen offset:3072 sc1
    s_barrier
    s_waitcnt vmcnt(18) lgkmcnt(14)
    v_mfma_f32_16x16x32_bf16 v[32:35], v[72:75], v[168:171], v[32:35]
    ds_read_b128 v[52:55], v8 offset:0
    s_waitcnt lgkmcnt(14)
    v_mfma_f32_16x16x32_bf16 v[36:39], v[76:79], v[168:171], v[36:39]
    ds_read_b128 v[56:59], v8 offset:1024
    s_waitcnt lgkmcnt(14)
    v_mfma_f32_16x16x32_bf16 v[40:43], v[80:83], v[168:171], v[40:43]
    ds_read_b128 v[60:63], v8 offset:2048
    s_waitcnt lgkmcnt(14)
    v_mfma_f32_16x16x32_bf16 v[44:47], v[84:87], v[168:171], v[44:47]
    ds_read_b128 v[64:67], v8 offset:3072
    s_waitcnt lgkmcnt(14)
    v_mfma_f32_16x16x32_bf16 v[48:51], v[88:91], v[168:171], v[48:51]
    ds_read_b128 v[68:71], v8 offset:4096
    s_waitcnt vmcnt(17) lgkmcnt(14)
    v_mfma_f32_16x16x32_bf16 v[32:35], v[92:95], v[172:175], v[32:35]
    ds_read_b128 v[72:75], v8 offset:5120
    s_waitcnt lgkmcnt(14)
    v_mfma_f32_16x16x32_bf16 v[36:39], v[96:99], v[172:175], v[36:39]
    ds_read_b128 v[76:79], v8 offset:6144
    s_waitcnt lgkmcnt(14)
    v_mfma_f32_16x16x32_bf16 v[40:43], v[100:103], v[172:175], v[40:43]
    ds_read_b128 v[80:83], v8 offset:7168
    s_waitcnt lgkmcnt(14)
    v_mfma_f32_16x16x32_bf16 v[44:47], v[104:107], v[172:175], v[44:47]
    ds_read_b128 v[84:87], v8 offset:8192
    s_waitcnt lgkmcnt(14)
    v_mfma_f32_16x16x32_bf16 v[48:51], v[108:111], v[172:175], v[48:51]
    ds_read_b128 v[88:91], v8 offset:9216
    s_waitcnt vmcnt(16) lgkmcnt(14)
    v_mfma_f32_16x16x32_bf16 v[32:35], v[112:115], v[176:179], v[32:35]
    ds_read_b128 v[92:95], v8 offset:10240
    s_waitcnt lgkmcnt(14)
    v_mfma_f32_16x16x32_bf16 v[36:39], v[116:119], v[176:179], v[36:39]
    ds_read_b128 v[96:99], v8 offset:11264
    s_waitcnt lgkmcnt(14)
    v_mfma_f32_16x16x32_bf16 v[40:43], v[120:123], v[176:179], v[40:43]
    ds_read_b128 v[100:103], v8 offset:12288
    s_waitcnt lgkmcnt(14)
    v_mfma_f32_16x16x32_bf16 v[44:47], v[124:127], v[176:179], v[44:47]
    ds_read_b128 v[104:107], v8 offset:13312
    s_waitcnt lgkmcnt(14)
    v_mfma_f32_16x16x32_bf16 v[48:51], v[128:131], v[176:179], v[48:51]
    ds_read_b128 v[108:111], v8 offset:14336
    s_waitcnt vmcnt(15) lgkmcnt(14)
    v_mfma_f32_16x16x32_bf16 v[32:35], v[52:55], v[180:183], v[32:35]
    ds_read_b128 v[112:115], v8 offset:15360
    s_waitcnt lgkmcnt(14)
    v_mfma_f32_16x16x32_bf16 v[36:39], v[56:59], v[180:183], v[36:39]
    ds_read_b128 v[116:119], v8 offset:16384
    s_waitcnt lgkmcnt(14)
    v_mfma_f32_16x16x32_bf16 v[40:43], v[60:63], v[180:183], v[40:43]
    ds_read_b128 v[120:123], v8 offset:17408
    s_waitcnt lgkmcnt(14)
    v_mfma_f32_16x16x32_bf16 v[44:47], v[64:67], v[180:183], v[44:47]
    ds_read_b128 v[124:127], v8 offset:18432
    s_waitcnt lgkmcnt(14)
    v_mfma_f32_16x16x32_bf16 v[48:51], v[68:71], v[180:183], v[48:51]
    ds_read_b128 v[128:131], v8 offset:19456
    s_lshl_b32 s30, s37, 12
    s_add_u32 s30, s30, s27
    s_add_u32 s37, s37, 1
    s_cmp_ge_u32 s37, 12
    s_cselect_b32 s37, 0, s37
    buffer_load_dwordx4 v[164:167], v5, s[12:15], s30 offen offset:0 sc1
    buffer_load_dwordx4 v[168:171], v5, s[12:15], s30 offen offset:1024 sc1
    buffer_load_dwordx4 v[172:175], v5, s[12:15], s30 offen offset:2048 sc1
    buffer_load_dwordx4 v[176:179], v5, s[12:15], s30 offen offset:3072 sc1
    s_barrier
    s_waitcnt vmcnt(18) lgkmcnt(14)
    v_mfma_f32_16x16x32_bf16 v[32:35], v[72:75], v[184:187], v[32:35]
    ds_read_b128 v[52:55], v5 offset:0
    s_waitcnt lgkmcnt(14)
    v_mfma_f32_16x16x32_bf16 v[36:39], v[76:79], v[184:187], v[36:39]
    ds_read_b128 v[56:59], v5 offset:1024
    s_waitcnt lgkmcnt(14)
    v_mfma_f32_16x16x32_bf16 v[40:43], v[80:83], v[184:187], v[40:43]
    ds_read_b128 v[60:63], v5 offset:2048
    s_waitcnt lgkmcnt(14)
    v_mfma_f32_16x16x32_bf16 v[44:47], v[84:87], v[184:187], v[44:47]
    ds_read_b128 v[64:67], v5 offset:3072
    s_waitcnt lgkmcnt(14)
    v_mfma_f32_16x16x32_bf16 v[48:51], v[88:91], v[184:187], v[48:51]
    ds_read_b128 v[68:71], v5 offset:4096
    s_waitcnt vmcnt(17) lgkmcnt(14)
    v_mfma_f32_16x16x32_bf16 v[32:35], v[92:95], v[188:191], v[32:35]
    ds_read_b128 v[72:75], v5 offset:5120
    s_waitcnt lgkmcnt(14)
    v_mfma_f32_16x16x32_bf16 v[36:39], v[96:99], v[188:191], v[36:39]
    ds_read_b128 v[76:79], v5 offset:6144
    s_waitcnt lgkmcnt(14)
    v_mfma_f32_16x16x32_bf16 v[40:43], v[100:103], v[188:191], v[40:43]
    ds_read_b128 v[80:83], v5 offset:7168
    s_waitcnt lgkmcnt(14)
    v_mfma_f32_16x16x32_bf16 v[44:47], v[104:107], v[188:191], v[44:47]
    ds_read_b128 v[84:87], v5 offset:8192
    s_waitcnt lgkmcnt(14)
    v_mfma_f32_16x16x32_bf16 v[48:51], v[108:111], v[188:191], v[48:51]
    ds_read_b128 v[88:91], v5 offset:9216
    s_waitcnt vmcnt(16) lgkmcnt(14)
    v_mfma_f32_16x16x32_bf16 v[32:35], v[112:115], v[192:195], v[32:35]
    ds_read_b128 v[92:95], v5 offset:10240
    s_waitcnt lgkmcnt(14)
    v_mfma_f32_16x16x32_bf16 v[36:39], v[116:119], v[192:195], v[36:39]
    ds_read_b128 v[96:99], v5 offset:11264
    s_waitcnt lgkmcnt(14)
    v_mfma_f32_16x16x32_bf16 v[40:43], v[120:123], v[192:195], v[40:43]
    ds_read_b128 v[100:103], v5 offset:12288
    s_waitcnt lgkmcnt(14)
    v_mfma_f32_16x16x32_bf16 v[44:47], v[124:127], v[192:195], v[44:47]
    ds_read_b128 v[104:107], v5 offset:13312
    s_waitcnt lgkmcnt(14)
    v_mfma_f32_16x16x32_bf16 v[48:51], v[128:131], v[192:195], v[48:51]
    ds_read_b128 v[108:111], v5 offset:14336
    s_waitcnt vmcnt(15) lgkmcnt(14)
    v_mfma_f32_16x16x32_bf16 v[32:35], v[52:55], v[196:199], v[32:35]
    ds_read_b128 v[112:115], v5 offset:15360
    s_waitcnt lgkmcnt(14)
    v_mfma_f32_16x16x32_bf16 v[36:39], v[56:59], v[196:199], v[36:39]
    ds_read_b128 v[116:119], v5 offset:16384
    s_waitcnt lgkmcnt(14)
    v_mfma_f32_16x16x32_bf16 v[40:43], v[60:63], v[196:199], v[40:43]
    ds_read_b128 v[120:123], v5 offset:17408
    s_waitcnt lgkmcnt(14)
    v_mfma_f32_16x16x32_bf16 v[44:47], v[64:67], v[196:199], v[44:47]
    ds_read_b128 v[124:127], v5 offset:18432
    s_waitcnt lgkmcnt(14)
    v_mfma_f32_16x16x32_bf16 v[48:51], v[68:71], v[196:199], v[48:51]
    ds_read_b128 v[128:131], v5 offset:19456
    s_lshl_b32 s30, s37, 12
    s_add_u32 s30, s30, s27
    s_add_u32 s37, s37, 1
    s_cmp_ge_u32 s37, 12
    s_cselect_b32 s37, 0, s37
    buffer_load_dwordx4 v[180:183], v5, s[12:15], s30 offen offset:0 sc1
    buffer_load_dwordx4 v[184:187], v5, s[12:15], s30 offen offset:1024 sc1
    buffer_load_dwordx4 v[188:191], v5, s[12:15], s30 offen offset:2048 sc1
    buffer_load_dwordx4 v[192:195], v5, s[12:15], s30 offen offset:3072 sc1
    s_barrier
    s_waitcnt vmcnt(18) lgkmcnt(14)
    v_mfma_f32_16x16x32_bf16 v[32:35], v[72:75], v[200:203], v[32:35]
    ds_read_b128 v[52:55], v5 offset:20480
    s_waitcnt lgkmcnt(14)
    v_mfma_f32_16x16x32_bf16 v[36:39], v[76:79], v[200:203], v[36:39]
    ds_read_b128 v[56:59], v5 offset:21504
    s_waitcnt lgkmcnt(14)
    v_mfma_f32_16x16x32_bf16 v[40:43], v[80:83], v[200:203], v[40:43]
    ds_read_b128 v[60:63], v5 offset:22528
    s_waitcnt lgkmcnt(14)
    v_mfma_f32_16x16x32_bf16 v[44:47], v[84:87], v[200:203], v[44:47]
    ds_read_b128 v[64:67], v5 offset:23552
    s_waitcnt lgkmcnt(14)
    v_mfma_f32_16x16x32_bf16 v[48:51], v[88:91], v[200:203], v[48:51]
    ds_read_b128 v[68:71], v5 offset:24576
    s_waitcnt vmcnt(17) lgkmcnt(14)
    v_mfma_f32_16x16x32_bf16 v[32:35], v[92:95], v[204:207], v[32:35]
    ds_read_b128 v[72:75], v5 offset:25600
    s_waitcnt lgkmcnt(14)
    v_mfma_f32_16x16x32_bf16 v[36:39], v[96:99], v[204:207], v[36:39]
    ds_read_b128 v[76:79], v5 offset:26624
    s_waitcnt lgkmcnt(14)
    v_mfma_f32_16x16x32_bf16 v[40:43], v[100:103], v[204:207], v[40:43]
    ds_read_b128 v[80:83], v5 offset:27648
    s_waitcnt lgkmcnt(14)
    v_mfma_f32_16x16x32_bf16 v[44:47], v[104:107], v[204:207], v[44:47]
    ds_read_b128 v[84:87], v5 offset:28672
    s_waitcnt lgkmcnt(14)
    v_mfma_f32_16x16x32_bf16 v[48:51], v[108:111], v[204:207], v[48:51]
    ds_read_b128 v[88:91], v5 offset:29696
    s_waitcnt vmcnt(16) lgkmcnt(14)
    v_mfma_f32_16x16x32_bf16 v[32:35], v[112:115], v[208:211], v[32:35]
    ds_read_b128 v[92:95], v5 offset:30720
    s_waitcnt lgkmcnt(14)
    v_mfma_f32_16x16x32_bf16 v[36:39], v[116:119], v[208:211], v[36:39]
    ds_read_b128 v[96:99], v5 offset:31744
    s_waitcnt lgkmcnt(14)
    v_mfma_f32_16x16x32_bf16 v[40:43], v[120:123], v[208:211], v[40:43]
    ds_read_b128 v[100:103], v5 offset:32768
    s_waitcnt lgkmcnt(14)
    v_mfma_f32_16x16x32_bf16 v[44:47], v[124:127], v[208:211], v[44:47]
    ds_read_b128 v[104:107], v5 offset:33792
    s_waitcnt lgkmcnt(14)
    v_mfma_f32_16x16x32_bf16 v[48:51], v[128:131], v[208:211], v[48:51]
    ds_read_b128 v[108:111], v5 offset:34816
    s_waitcnt vmcnt(15) lgkmcnt(14)
    v_mfma_f32_16x16x32_bf16 v[32:35], v[52:55], v[212:215], v[32:35]
    ds_read_b128 v[112:115], v5 offset:35840
    s_waitcnt lgkmcnt(14)
    v_mfma_f32_16x16x32_bf16 v[36:39], v[56:59], v[212:215], v[36:39]
    ds_read_b128 v[116:119], v5 offset:36864
    s_waitcnt lgkmcnt(14)
    v_mfma_f32_16x16x32_bf16 v[40:43], v[60:63], v[212:215], v[40:43]
    ds_read_b128 v[120:123], v5 offset:37888
    s_waitcnt lgkmcnt(14)
    v_mfma_f32_16x16x32_bf16 v[44:47], v[64:67], v[212:215], v[44:47]
    ds_read_b128 v[124:127], v5 offset:38912
    s_waitcnt lgkmcnt(14)
    v_mfma_f32_16x16x32_bf16 v[48:51], v[68:71], v[212:215], v[48:51]
    ds_read_b128 v[128:131], v5 offset:39936
    s_barrier
    s_waitcnt vmcnt(14) lgkmcnt(14)
    v_mfma_f32_16x16x32_bf16 v[32:35], v[72:75], v[216:219], v[32:35]
    ds_read_b128 v[52:55], v5 offset:40960
    s_waitcnt lgkmcnt(14)
    v_mfma_f32_16x16x32_bf16 v[36:39], v[76:79], v[216:219], v[36:39]
    ds_read_b128 v[56:59], v5 offset:41984
    s_waitcnt lgkmcnt(14)
    v_mfma_f32_16x16x32_bf16 v[40:43], v[80:83], v[216:219], v[40:43]
    ds_read_b128 v[60:63], v5 offset:43008
    s_waitcnt lgkmcnt(14)
    v_mfma_f32_16x16x32_bf16 v[44:47], v[84:87], v[216:219], v[44:47]
    ds_read_b128 v[64:67], v5 offset:44032
    s_waitcnt lgkmcnt(14)
    v_mfma_f32_16x16x32_bf16 v[48:51], v[88:91], v[216:219], v[48:51]
    ds_read_b128 v[68:71], v5 offset:45056
    s_waitcnt vmcnt(13) lgkmcnt(14)
    v_mfma_f32_16x16x32_bf16 v[32:35], v[92:95], v[220:223], v[32:35]
    ds_read_b128 v[72:75], v5 offset:46080
    s_waitcnt lgkmcnt(14)
    v_mfma_f32_16x16x32_bf16 v[36:39], v[96:99], v[220:223], v[36:39]
    ds_read_b128 v[76:79], v5 offset:47104
    s_waitcnt lgkmcnt(14)
    v_mfma_f32_16x16x32_bf16 v[40:43], v[100:103], v[220:223], v[40:43]
    ds_read_b128 v[80:83], v5 offset:48128
    s_waitcnt lgkmcnt(14)
    v_mfma_f32_16x16x32_bf16 v[44:47], v[104:107], v[220:223], v[44:47]
    ds_read_b128 v[84:87], v5 offset:49152
    s_waitcnt lgkmcnt(14)
    v_mfma_f32_16x16x32_bf16 v[48:51], v[108:111], v[220:223], v[48:51]
    ds_read_b128 v[88:91], v5 offset:50176
    s_waitcnt vmcnt(12) lgkmcnt(14)
    v_mfma_f32_16x16x32_bf16 v[32:35], v[112:115], v[224:227], v[32:35]
    ds_read_b128 v[92:95], v5 offset:51200
    s_waitcnt lgkmcnt(14)
    v_mfma_f32_16x16x32_bf16 v[36:39], v[116:119], v[224:227], v[36:39]
    ds_read_b128 v[96:99], v5 offset:52224
    s_waitcnt lgkmcnt(14)
    v_mfma_f32_16x16x32_bf16 v[40:43], v[120:123], v[224:227], v[40:43]
    ds_read_b128 v[100:103], v5 offset:53248
    s_waitcnt lgkmcnt(14)
    v_mfma_f32_16x16x32_bf16 v[44:47], v[124:127], v[224:227], v[44:47]
    ds_read_b128 v[104:107], v5 offset:54272
    s_waitcnt lgkmcnt(14)
    v_mfma_f32_16x16x32_bf16 v[48:51], v[128:131], v[224:227], v[48:51]
    ds_read_b128 v[108:111], v5 offset:55296
    s_waitcnt vmcnt(11) lgkmcnt(14)
    v_mfma_f32_16x16x32_bf16 v[32:35], v[52:55], v[228:231], v[32:35]
    ds_read_b128 v[112:115], v5 offset:56320
    s_waitcnt lgkmcnt(14)
    v_mfma_f32_16x16x32_bf16 v[36:39], v[56:59], v[228:231], v[36:39]
    ds_read_b128 v[116:119], v5 offset:57344
    s_waitcnt lgkmcnt(14)
    v_mfma_f32_16x16x32_bf16 v[40:43], v[60:63], v[228:231], v[40:43]
    ds_read_b128 v[120:123], v5 offset:58368
    s_waitcnt lgkmcnt(14)
    v_mfma_f32_16x16x32_bf16 v[44:47], v[64:67], v[228:231], v[44:47]
    ds_read_b128 v[124:127], v5 offset:59392
    s_waitcnt lgkmcnt(14)
    v_mfma_f32_16x16x32_bf16 v[48:51], v[68:71], v[228:231], v[48:51]
    ds_read_b128 v[128:131], v5 offset:60416
    s_barrier
    s_waitcnt vmcnt(10) lgkmcnt(14)
    v_mfma_f32_16x16x32_bf16 v[32:35], v[72:75], v[232:235], v[32:35]
    ds_read_b128 v[52:55], v7 offset:0
    s_waitcnt lgkmcnt(14)
    v_mfma_f32_16x16x32_bf16 v[36:39], v[76:79], v[232:235], v[36:39]
    ds_read_b128 v[56:59], v7 offset:1024
    s_waitcnt lgkmcnt(14)
    v_mfma_f32_16x16x32_bf16 v[40:43], v[80:83], v[232:235], v[40:43]
    ds_read_b128 v[60:63], v7 offset:2048
    s_waitcnt lgkmcnt(14)
    v_mfma_f32_16x16x32_bf16 v[44:47], v[84:87], v[232:235], v[44:47]
    ds_read_b128 v[64:67], v7 offset:3072
    s_waitcnt lgkmcnt(14)
    v_mfma_f32_16x16x32_bf16 v[48:51], v[88:91], v[232:235], v[48:51]
    ds_read_b128 v[68:71], v7 offset:4096
    s_waitcnt vmcnt(9) lgkmcnt(14)
    v_mfma_f32_16x16x32_bf16 v[32:35], v[92:95], v[236:239], v[32:35]
    ds_read_b128 v[72:75], v7 offset:5120
    s_waitcnt lgkmcnt(14)
    v_mfma_f32_16x16x32_bf16 v[36:39], v[96:99], v[236:239], v[36:39]
    ds_read_b128 v[76:79], v7 offset:6144
    s_waitcnt lgkmcnt(14)
    v_mfma_f32_16x16x32_bf16 v[40:43], v[100:103], v[236:239], v[40:43]
    ds_read_b128 v[80:83], v7 offset:7168
    s_waitcnt lgkmcnt(14)
    v_mfma_f32_16x16x32_bf16 v[44:47], v[104:107], v[236:239], v[44:47]
    ds_read_b128 v[84:87], v7 offset:8192
    s_waitcnt lgkmcnt(14)
    v_mfma_f32_16x16x32_bf16 v[48:51], v[108:111], v[236:239], v[48:51]
    ds_read_b128 v[88:91], v7 offset:9216
    s_waitcnt vmcnt(8) lgkmcnt(14)
    v_mfma_f32_16x16x32_bf16 v[32:35], v[112:115], v[240:243], v[32:35]
    ds_read_b128 v[92:95], v7 offset:10240
    s_waitcnt lgkmcnt(14)
    v_mfma_f32_16x16x32_bf16 v[36:39], v[116:119], v[240:243], v[36:39]
    ds_read_b128 v[96:99], v7 offset:11264
    s_waitcnt lgkmcnt(14)
    v_mfma_f32_16x16x32_bf16 v[40:43], v[120:123], v[240:243], v[40:43]
    ds_read_b128 v[100:103], v7 offset:12288
    s_waitcnt lgkmcnt(14)
    v_mfma_f32_16x16x32_bf16 v[44:47], v[124:127], v[240:243], v[44:47]
    ds_read_b128 v[104:107], v7 offset:13312
    s_waitcnt lgkmcnt(14)
    v_mfma_f32_16x16x32_bf16 v[48:51], v[128:131], v[240:243], v[48:51]
    ds_read_b128 v[108:111], v7 offset:14336
    s_waitcnt vmcnt(7) lgkmcnt(14)
    v_mfma_f32_16x16x32_bf16 v[32:35], v[52:55], v[164:167], v[32:35]
    ds_read_b128 v[112:115], v7 offset:15360
    s_waitcnt lgkmcnt(14)
    v_mfma_f32_16x16x32_bf16 v[36:39], v[56:59], v[164:167], v[36:39]
    ds_read_b128 v[116:119], v7 offset:16384
    s_waitcnt lgkmcnt(14)
    v_mfma_f32_16x16x32_bf16 v[40:43], v[60:63], v[164:167], v[40:43]
    ds_read_b128 v[120:123], v7 offset:17408
    s_waitcnt lgkmcnt(14)
    v_mfma_f32_16x16x32_bf16 v[44:47], v[64:67], v[164:167], v[44:47]
    ds_read_b128 v[124:127], v7 offset:18432
    s_waitcnt lgkmcnt(14)
    v_mfma_f32_16x16x32_bf16 v[48:51], v[68:71], v[164:167], v[48:51]
    ds_read_b128 v[128:131], v7 offset:19456
    s_barrier
    s_waitcnt vmcnt(6) lgkmcnt(14)
    v_mfma_f32_16x16x32_bf16 v[32:35], v[72:75], v[168:171], v[32:35]
    ds_read_b128 v[52:55], v7 offset:20480
    s_waitcnt lgkmcnt(14)
    v_mfma_f32_16x16x32_bf16 v[36:39], v[76:79], v[168:171], v[36:39]
    ds_read_b128 v[56:59], v7 offset:21504
    s_waitcnt lgkmcnt(14)
    v_mfma_f32_16x16x32_bf16 v[40:43], v[80:83], v[168:171], v[40:43]
    ds_read_b128 v[60:63], v7 offset:22528
    s_waitcnt lgkmcnt(14)
    v_mfma_f32_16x16x32_bf16 v[44:47], v[84:87], v[168:171], v[44:47]
    ds_read_b128 v[64:67], v7 offset:23552
    s_waitcnt lgkmcnt(14)
    v_mfma_f32_16x16x32_bf16 v[48:51], v[88:91], v[168:171], v[48:51]
    ds_read_b128 v[68:71], v7 offset:24576
    s_waitcnt vmcnt(5) lgkmcnt(14)
    v_mfma_f32_16x16x32_bf16 v[32:35], v[92:95], v[172:175], v[32:35]
    ds_read_b128 v[72:75], v7 offset:25600
    s_waitcnt lgkmcnt(14)
    v_mfma_f32_16x16x32_bf16 v[36:39], v[96:99], v[172:175], v[36:39]
    ds_read_b128 v[76:79], v7 offset:26624
    s_waitcnt lgkmcnt(14)
    v_mfma_f32_16x16x32_bf16 v[40:43], v[100:103], v[172:175], v[40:43]
    ds_read_b128 v[80:83], v7 offset:27648
    s_waitcnt lgkmcnt(14)
    v_mfma_f32_16x16x32_bf16 v[44:47], v[104:107], v[172:175], v[44:47]
    ds_read_b128 v[84:87], v7 offset:28672
    s_waitcnt lgkmcnt(14)
    v_mfma_f32_16x16x32_bf16 v[48:51], v[108:111], v[172:175], v[48:51]
    ds_read_b128 v[88:91], v7 offset:29696
    s_waitcnt vmcnt(4) lgkmcnt(14)
    v_mfma_f32_16x16x32_bf16 v[32:35], v[112:115], v[176:179], v[32:35]
    ds_read_b128 v[92:95], v7 offset:30720
    s_waitcnt lgkmcnt(14)
    v_mfma_f32_16x16x32_bf16 v[36:39], v[116:119], v[176:179], v[36:39]
    ds_read_b128 v[96:99], v7 offset:31744
    s_waitcnt lgkmcnt(14)
    v_mfma_f32_16x16x32_bf16 v[40:43], v[120:123], v[176:179], v[40:43]
    ds_read_b128 v[100:103], v7 offset:32768
    s_waitcnt lgkmcnt(14)
    v_mfma_f32_16x16x32_bf16 v[44:47], v[124:127], v[176:179], v[44:47]
    ds_read_b128 v[104:107], v7 offset:33792
    s_waitcnt lgkmcnt(14)
    v_mfma_f32_16x16x32_bf16 v[48:51], v[128:131], v[176:179], v[48:51]
    ds_read_b128 v[108:111], v7 offset:34816
    s_waitcnt vmcnt(3) lgkmcnt(14)
    v_mfma_f32_16x16x32_bf16 v[32:35], v[52:55], v[180:183], v[32:35]
    ds_read_b128 v[112:115], v7 offset:35840
    s_waitcnt lgkmcnt(14)
    v_mfma_f32_16x16x32_bf16 v[36:39], v[56:59], v[180:183], v[36:39]
    ds_read_b128 v[116:119], v7 offset:36864
    s_waitcnt lgkmcnt(14)
    v_mfma_f32_16x16x32_bf16 v[40:43], v[60:63], v[180:183], v[40:43]
    ds_read_b128 v[120:123], v7 offset:37888
    s_waitcnt lgkmcnt(14)
    v_mfma_f32_16x16x32_bf16 v[44:47], v[64:67], v[180:183], v[44:47]
    ds_read_b128 v[124:127], v7 offset:38912
    s_waitcnt lgkmcnt(14)
    v_mfma_f32_16x16x32_bf16 v[48:51], v[68:71], v[180:183], v[48:51]
    ds_read_b128 v[128:131], v7 offset:39936
    s_waitcnt vmcnt(2) lgkmcnt(14)
    v_mfma_f32_16x16x32_bf16 v[32:35], v[72:75], v[184:187], v[32:35]
    s_waitcnt lgkmcnt(13)
    v_mfma_f32_16x16x32_bf16 v[36:39], v[76:79], v[184:187], v[36:39]
    s_waitcnt lgkmcnt(12)
    v_mfma_f32_16x16x32_bf16 v[40:43], v[80:83], v[184:187], v[40:43]
    s_waitcnt lgkmcnt(11)
    v_mfma_f32_16x16x32_bf16 v[44:47], v[84:87], v[184:187], v[44:47]
    s_waitcnt lgkmcnt(10)
    v_mfma_f32_16x16x32_bf16 v[48:51], v[88:91], v[184:187], v[48:51]
    s_waitcnt vmcnt(1) lgkmcnt(9)
    v_mfma_f32_16x16x32_bf16 v[32:35], v[92:95], v[188:191], v[32:35]
    s_waitcnt lgkmcnt(8)
    v_mfma_f32_16x16x32_bf16 v[36:39], v[96:99], v[188:191], v[36:39]
    s_waitcnt lgkmcnt(7)
    v_mfma_f32_16x16x32_bf16 v[40:43], v[100:103], v[188:191], v[40:43]
    s_waitcnt lgkmcnt(6)
    v_mfma_f32_16x16x32_bf16 v[44:47], v[104:107], v[188:191], v[44:47]
    s_waitcnt lgkmcnt(5)
    v_mfma_f32_16x16x32_bf16 v[48:51], v[108:111], v[188:191], v[48:51]
    s_waitcnt vmcnt(0) lgkmcnt(4)
    v_mfma_f32_16x16x32_bf16 v[32:35], v[112:115], v[192:195], v[32:35]
    s_waitcnt lgkmcnt(3)
    v_mfma_f32_16x16x32_bf16 v[36:39], v[116:119], v[192:195], v[36:39]
    s_waitcnt lgkmcnt(2)
    v_mfma_f32_16x16x32_bf16 v[40:43], v[120:123], v[192:195], v[40:43]
    s_waitcnt lgkmcnt(1)
    v_mfma_f32_16x16x32_bf16 v[44:47], v[124:127], v[192:195], v[44:47]
    s_waitcnt lgkmcnt(0)
    v_mfma_f32_16x16x32_bf16 v[48:51], v[128:131], v[192:195], v[48:51]
    s_mov_b32 s30, 0xffff0000
    v_and_b32 v22, 1, v4
    v_lshlrev_b32 v23, 3, v22
    v_sub_u32 v23, v15, v23
    v_lshl_add_u32 v22, v22, 5, v23
    v_cvt_pk_bf16_f32 v52, v32, v33
    v_cvt_pk_bf16_f32 v53, v34, v35
    v_lshlrev_b32 v32, 16, v52
    v_and_b32 v33, s30, v52
    v_lshlrev_b32 v34, 16, v53
    v_and_b32 v35, s30, v53
    v_mul_f32 v32, v32, v132
    v_mul_f32 v33, v33, v133
    v_mul_f32 v34, v34, v134
    v_mul_f32 v35, v35, v135
    v_cvt_pk_bf16_f32 v52, v32, v33
    v_cvt_pk_bf16_f32 v53, v34, v35
    v_lshlrev_b32 v32, 16, v52
    v_and_b32 v33, s30, v52
    v_lshlrev_b32 v34, 16, v53
    v_and_b32 v35, s30, v53
    v_lshlrev_b32 v54, 16, v152
    v_and_b32 v55, s30, v152
    v_lshlrev_b32 v56, 16, v153
    v_and_b32 v57, s30, v153
    v_add_f32 v32, v32, v54
    v_add_f32 v33, v33, v55
    v_add_f32 v34, v34, v56
    v_add_f32 v35, v35, v57
    v_cvt_pk_bf16_f32 v68, v32, v33
    v_cvt_pk_bf16_f32 v69, v34, v35
    v_cvt_pk_bf16_f32 v60, v36, v37
    v_cvt_pk_bf16_f32 v61, v38, v39
    v_lshlrev_b32 v36, 16, v60
    v_and_b32 v37, s30, v60
    v_lshlrev_b32 v38, 16, v61
    v_and_b32 v39, s30, v61
    v_mul_f32 v36, v36, v136
    v_mul_f32 v37, v37, v137
    v_mul_f32 v38, v38, v138
    v_mul_f32 v39, v39, v139
    v_cvt_pk_bf16_f32 v60, v36, v37
    v_cvt_pk_bf16_f32 v61, v38, v39
    v_lshlrev_b32 v36, 16, v60
    v_and_b32 v37, s30, v60
    v_lshlrev_b32 v38, 16, v61
    v_and_b32 v39, s30, v61
    v_lshlrev_b32 v62, 16, v154
    v_and_b32 v63, s30, v154
    v_lshlrev_b32 v64, 16, v155
    v_and_b32 v65, s30, v155
    v_add_f32 v36, v36, v62
    v_add_f32 v37, v37, v63
    v_add_f32 v38, v38, v64
    v_add_f32 v39, v39, v65
    v_cvt_pk_bf16_f32 v70, v36, v37
    v_cvt_pk_bf16_f32 v71, v38, v39
    s_nop 0
    v_permlane16_swap_b32 v68, v70
    v_permlane16_swap_b32 v69, v71
    buffer_store_dwordx4 v[68:71], v22, s[16:19], s34 offen offset:0
    v_cvt_pk_bf16_f32 v52, v40, v41
    v_cvt_pk_bf16_f32 v53, v42, v43
    v_lshlrev_b32 v40, 16, v52
    v_and_b32 v41, s30, v52
    v_lshlrev_b32 v42, 16, v53
    v_and_b32 v43, s30, v53
    v_mul_f32 v40, v40, v140
    v_mul_f32 v41, v41, v141
    v_mul_f32 v42, v42, v142
    v_mul_f32 v43, v43, v143
    v_cvt_pk_bf16_f32 v52, v40, v41
    v_cvt_pk_bf16_f32 v53, v42, v43
    v_lshlrev_b32 v40, 16, v52
    v_and_b32 v41, s30, v52
    v_lshlrev_b32 v42, 16, v53
    v_and_b32 v43, s30, v53
    v_lshlrev_b32 v54, 16, v156
    v_and_b32 v55, s30, v156
    v_lshlrev_b32 v56, 16, v157
    v_and_b32 v57, s30, v157
    v_add_f32 v40, v40, v54
    v_add_f32 v41, v41, v55
    v_add_f32 v42, v42, v56
    v_add_f32 v43, v43, v57
    v_cvt_pk_bf16_f32 v72, v40, v41
    v_cvt_pk_bf16_f32 v73, v42, v43
    v_cvt_pk_bf16_f32 v60, v44, v45
    v_cvt_pk_bf16_f32 v61, v46, v47
    v_lshlrev_b32 v44, 16, v60
    v_and_b32 v45, s30, v60
    v_lshlrev_b32 v46, 16, v61
    v_and_b32 v47, s30, v61
    v_mul_f32 v44, v44, v144
    v_mul_f32 v45, v45, v145
    v_mul_f32 v46, v46, v146
    v_mul_f32 v47, v47, v147
    v_cvt_pk_bf16_f32 v60, v44, v45
    v_cvt_pk_bf16_f32 v61, v46, v47
    v_lshlrev_b32 v44, 16, v60
    v_and_b32 v45, s30, v60
    v_lshlrev_b32 v46, 16, v61
    v_and_b32 v47, s30, v61
    v_lshlrev_b32 v62, 16, v158
    v_and_b32 v63, s30, v158
    v_lshlrev_b32 v64, 16, v159
    v_and_b32 v65, s30, v159
    v_add_f32 v44, v44, v62
    v_add_f32 v45, v45, v63
    v_add_f32 v46, v46, v64
    v_add_f32 v47, v47, v65
    v_cvt_pk_bf16_f32 v74, v44, v45
    v_cvt_pk_bf16_f32 v75, v46, v47
    s_nop 0
    v_permlane16_swap_b32 v72, v74
    v_permlane16_swap_b32 v73, v75
    buffer_store_dwordx4 v[72:75], v22, s[16:19], s34 offen offset:64
    v_cvt_pk_bf16_f32 v52, v48, v49
    v_cvt_pk_bf16_f32 v53, v50, v51
    v_lshlrev_b32 v48, 16, v52
    v_and_b32 v49, s30, v52
    v_lshlrev_b32 v50, 16, v53
    v_and_b32 v51, s30, v53
    v_mul_f32 v48, v48, v148
    v_mul_f32 v49, v49, v149
    v_mul_f32 v50, v50, v150
    v_mul_f32 v51, v51, v151
    v_cvt_pk_bf16_f32 v52, v48, v49
    v_cvt_pk_bf16_f32 v53, v50, v51
    v_lshlrev_b32 v48, 16, v52
    v_and_b32 v49, s30, v52
    v_lshlrev_b32 v50, 16, v53
    v_and_b32 v51, s30, v53
    v_lshlrev_b32 v54, 16, v160
    v_and_b32 v55, s30, v160
    v_lshlrev_b32 v56, 16, v161
    v_and_b32 v57, s30, v161
    v_add_f32 v48, v48, v54
    v_add_f32 v49, v49, v55
    v_add_f32 v50, v50, v56
    v_add_f32 v51, v51, v57
    v_cvt_pk_bf16_f32 v76, v48, v49
    v_cvt_pk_bf16_f32 v77, v50, v51
    v_mov_b32 v78, v76
    v_mov_b32 v79, v77
    s_nop 0
    v_permlane16_swap_b32 v76, v78
    v_permlane16_swap_b32 v77, v79
    buffer_store_dwordx4 v[76:79], v23, s[16:19], s34 offen offset:128
L_p5_done:
    s_nop 11
L_mega_end:
    s_endpgm
.section .rodata,"a"
.p2align 6
.amdhsa_kernel adaLN_cond__sliding_block__swiglu_ffn__prompt_kernel
  .amdhsa_next_free_vgpr 252
  .amdhsa_next_free_sgpr 100
  .amdhsa_accum_offset 252
  .amdhsa_group_segment_fixed_size 0
  .amdhsa_kernarg_size 96
  .amdhsa_user_sgpr_count 2
  .amdhsa_user_sgpr_kernarg_segment_ptr 1
  .amdhsa_system_sgpr_workgroup_id_x 1
.end_amdhsa_kernel
```
